```python
import torch

def _softmax(x, axis=-1):
    return torch.softmax(x, dim=axis)
def _gelu(x):
    return torch.nn.functional.gelu(x, approximate="tanh")
def _silu(x):
    return torch.nn.functional.silu(x)
def _sigmoid(x):
    return torch.sigmoid(x)
def _layernorm(x, axis=-1, eps=1e-5):
    m = x.mean(dim=axis, keepdim=True)
    v = x.var(dim=axis, keepdim=True, unbiased=False)
    return (x - m) / torch.sqrt(v + eps)
def _scatter_add(tgt, idx, src, axis=0):
    return tgt.clone().index_add_(axis, idx, src)
def _segment_sum(src, seg, n):
    out = torch.zeros((n,) + src.shape[1:], dtype=src.dtype)
    return out.index_add_(0, seg, src)
def _pad(x, pw):
    flat = tuple(v for pair in reversed(pw) for v in pair)
    return torch.nn.functional.pad(x, flat)

kernel_name = 'interleave_layers__ssm_conv_h3__glu_gated_reglu__prompt'

def setup_inputs():

    _w = (lambda a: (lambda t: t.to(torch.bfloat16) if t.is_floating_point() else t)(torch.as_tensor(a)))
    def _A_setup():
        B, S, D = 1, 2048, 576
        ks = 4
        return {
            "q": _w((lambda *s: torch.randn(*s, dtype=torch.bfloat16) * 0.05)(B, S, D)),
            "k": _w((lambda *s: torch.randn(*s, dtype=torch.bfloat16) * 0.2)(B, S, D)),
            "v": _w((lambda *s: torch.randn(*s, dtype=torch.bfloat16) * 0.2)(B, S, D)),
            "shift_k": _w((lambda *s: torch.randn(*s, dtype=torch.bfloat16) * 0.2)(D, ks) * 0.5),
            "ssm_k": _w((lambda *s: torch.randn(*s, dtype=torch.bfloat16) * 0.4)(D, S) * (1.0 / S ** 0.5)),
            "ssm_D": _w((lambda *s: torch.randn(*s, dtype=torch.bfloat16) * 0.2)(D)),
        }
    _A_in = _A_setup()

    def _B_setup():
        B, S, D, F = 1, 2048, 576, 4608
        return {
            "x": _w((lambda *s: torch.randn(*s, dtype=torch.bfloat16) * 0.05)(B, S, D)),
            "W_gate": _w((lambda *s: torch.randn(*s, dtype=torch.bfloat16) * 0.2)(D, F) * (2.0 / D) ** 0.5),
            "W_up": _w((lambda *s: torch.randn(*s, dtype=torch.bfloat16) * 0.2)(D, F) * (2.0 / D) ** 0.5),
            "W_down": _w((lambda *s: torch.randn(*s, dtype=torch.bfloat16) * 0.2)(F, D) * (1.0 / F) ** 0.5),
        }
    _B_in = _B_setup()

    return {
        "A_q": _A_in["q"],
        "A_k": _A_in["k"],
        "A_v": _A_in["v"],
        "A_shift_k": _A_in["shift_k"],
        "A_ssm_k": _A_in["ssm_k"],
        "A_ssm_D": _A_in["ssm_D"],
        "B_x": _B_in["x"],
        "B_W_gate": _B_in["W_gate"],
        "B_W_up": _B_in["W_up"],
        "B_W_down": _B_in["W_down"],
    }

def reference(A_q, A_k, A_v, A_shift_k, A_ssm_k, A_ssm_D, B_x, B_W_gate, B_W_up, B_W_down):
    def _A_ref(q, k, v, shift_k, ssm_k, ssm_D):
        B, S, D = q.shape
        ks = shift_k.shape[-1]
        k_pad = _pad(k, ((0, 0), (ks - 1, 0), (0, 0)))
        k_shift = torch.zeros_like(k)
        for t in range(ks):
            k_shift = k_shift + k_pad[:, t:t + S, :] * shift_k[:, ks - 1 - t][None, None, :]
        kv = k_shift * v
        L = 2 * S
        kv_pad = _pad(kv, ((0, 0), (0, S), (0, 0)))
        kf_pad = _pad(ssm_k, ((0, 0), (0, S)))
        kv_f = (lambda x, axes=(-2,-1): torch.fft.rfft2(x.float(), dim=axes))(kv_pad[:, None, :, :], axes=(1, 2))
        kf_f = (lambda x, axes=(-2,-1): torch.fft.rfft2(x.float(), dim=axes))(kf_pad[:, None, :], axes=(1, 2))
        kf_f = (lambda x, *d: x.permute(*d))(kf_f, 1, 2, 0)
        y_f = kv_f * kf_f[None, :, :, :]
        y = (lambda x, s, axes=(-2,-1): torch.fft.irfft2(x, s=s, dim=axes).to(torch.bfloat16))(y_f, (1, L), axes=(1, 2))[:, 0, :S, :]
        y = y + kv * ssm_D[None, None, :]
        return q * y

    def _B_ref(x, W_gate, W_up, W_down):
        gate = torch.einsum("bsd,df->bsf", x, W_gate)
        up = torch.einsum("bsd,df->bsf", x, W_up)
        gate = gate * (lambda x, dt: x.to(dt))(gate > 0, gate.dtype)
        h = gate * up
        return torch.einsum("bsf,fd->bsd", h, W_down)

    x = A_q
    x = x + _A_ref(_layernorm(x, axis=-1), A_k, A_v, A_shift_k, A_ssm_k, A_ssm_D)
    x = x + _B_ref(_layernorm(x, axis=-1), B_W_gate, B_W_up, B_W_down)
    x = x + _A_ref(_layernorm(x, axis=-1), A_k, A_v, A_shift_k, A_ssm_k, A_ssm_D)
    x = x + _B_ref(_layernorm(x, axis=-1), B_W_gate, B_W_up, B_W_down)
    return x
```

```asm
; @launch grid=(256,1,1) block=(256,1,1) lds=163840
.amdgcn_target "amdgcn-amd-amdhsa--gfx950"
.text
.globl interleave_layers__ssm_conv_h3__glu_gated_reglu__prompt_kernel
.p2align 8
.type interleave_layers__ssm_conv_h3__glu_gated_reglu__prompt_kernel,@function
interleave_layers__ssm_conv_h3__glu_gated_reglu__prompt_kernel:
code_start:
    s_cmp_ge_u32 s2, 256
    s_cbranch_scc1 f_end
    s_sub_u32 s3, s2, 144
    s_cmp_ge_u32 s3, 8
    s_cbranch_scc1 cpf_code_starte
    s_getpc_b64 s[52:53]
cpf_code_starte_pc:
    s_sub_u32 s52, s52, cpf_code_starte_pc-code_start
    s_subb_u32 s53, s53, 0
    v_lshlrev_b32 v245, 7, v0
    v_min_u32 v246, m_join-code_start-4, v245
    global_load_dword v247, v246, s[52:53]
cpf_code_starte:
    s_load_dwordx2 s[22:23], s[0:1], 96
    s_load_dwordx2 s[96:97], s[0:1], 0
    s_load_dwordx4 s[44:47], s[0:1], 32
    s_load_dwordx2 s[50:51], s[0:1], 72
    s_load_dwordx2 s[62:63], s[0:1], 40
    v_lshrrev_b32 v1, 6, v0
    s_nop 0
    v_readfirstlane_b32 s24, v1
    s_mov_b32 s55, 2000000
    v_mov_b32 v242, 0
    s_cmp_ge_u32 s2, 144
    s_cbranch_scc1 m_pp0
    s_load_dwordx4 s[16:19], s[0:1], 8
    s_load_dwordx2 s[20:21], s[0:1], 24
    s_and_b32 s25, s2, 15
    s_lshr_b32 s26, s2, 4
    v_and_b32 v1, 15, v0
    v_lshrrev_b32 v2, 4, v0
    s_lshl_b32 s27, s25, 4
    v_add_u32 v3, s27, v2
    s_lshl_b32 s27, s26, 6
    v_lshl_add_u32 v4, v1, 2, s27
    v_mul_u32_u24 v5, 9216, v3
    v_lshl_add_u32 v5, v4, 1, v5
    v_subrev_u32 v6, 4608, v5
    v_mov_b32 v7, 0x80000000
    v_cmp_eq_u32 vcc, 0, v3
    s_nop 1
    v_cndmask_b32 v6, v6, v7, vcc
    v_lshlrev_b32 v7, 3, v4
    s_mov_b32 s28, 4608
    s_waitcnt lgkmcnt(0)
    s_mov_b32 s8, s16
    s_mov_b32 s9, s17
    s_mov_b32 s10, 0x240000
    s_mov_b32 s11, 0x20000
    s_mov_b32 s32, s20
    s_mov_b32 s33, s21
    s_mov_b32 s34, 0x1200
    s_mov_b32 s35, 0x20000
    buffer_load_dwordx4 v[60:63], v7, s[32:35], 0 offen
    buffer_load_dwordx4 v[64:67], v7, s[32:35], 0 offen offset:16
    buffer_load_dwordx2 v[18:19], v6, s[8:11], 0 offen offset:1152 nt
    buffer_load_dwordx2 v[20:21], v6, s[8:11], 0 offen offset:2304 nt
    buffer_load_dwordx2 v[22:23], v6, s[8:11], 0 offen offset:3456 nt
    buffer_load_dwordx2 v[24:25], v5, s[8:11], 0 offen offset:0 nt
    buffer_load_dwordx2 v[26:27], v5, s[8:11], 0 offen offset:1152 nt
    buffer_load_dwordx2 v[28:29], v5, s[8:11], 0 offen offset:2304 nt
    buffer_load_dwordx2 v[30:31], v5, s[8:11], 0 offen offset:3456 nt
    buffer_load_dwordx2 v[32:33], v5, s[8:11], s28 offen offset:0 nt
    buffer_load_dwordx2 v[34:35], v5, s[8:11], s28 offen offset:1152 nt
    buffer_load_dwordx2 v[36:37], v5, s[8:11], s28 offen offset:2304 nt
    buffer_load_dwordx2 v[38:39], v5, s[8:11], s28 offen offset:3456 nt
    s_mov_b32 s12, s18
    s_mov_b32 s13, s19
    s_mov_b32 s14, 0x240000
    s_mov_b32 s15, 0x20000
    buffer_load_dwordx2 v[42:43], v5, s[12:15], 0 offen offset:0 nt
    buffer_load_dwordx2 v[44:45], v5, s[12:15], 0 offen offset:1152 nt
    buffer_load_dwordx2 v[46:47], v5, s[12:15], 0 offen offset:2304 nt
    buffer_load_dwordx2 v[48:49], v5, s[12:15], 0 offen offset:3456 nt
    buffer_load_dwordx2 v[50:51], v5, s[12:15], s28 offen offset:0 nt
    buffer_load_dwordx2 v[52:53], v5, s[12:15], s28 offen offset:1152 nt
    buffer_load_dwordx2 v[54:55], v5, s[12:15], s28 offen offset:2304 nt
    buffer_load_dwordx2 v[56:57], v5, s[12:15], s28 offen offset:3456 nt
    s_add_u32 s36, s22, 0x1000000
    s_addc_u32 s37, s23, 0
    s_mov_b32 s38, 0x252000
    s_mov_b32 s39, 0x20000
    s_add_u32 s56, s22, 0x1a60000
    s_addc_u32 s57, s23, 0
    s_mov_b32 s58, 0x10000
    s_mov_b32 s59, 0x20000
    s_load_dword s54, s[56:57], 0
    s_lshl_b32 s40, s2, 2
    s_add_u32 s40, s40, s24
    s_lshl_b32 s48, s40, 12
    s_mul_i32 s49, s24, 4608
    v_and_b32 v11, 63, v0
    v_lshlrev_b32 v12, 3, v11
    v_add_u32 v12, s49, v12
    v_mov_b32 v14, 0
    v_mov_b32 v15, 0
    ds_write_b64 v12, v[14:15]
    v_lshlrev_b32 v11, 4, v11
    s_mov_b32 s40, s44
    s_mov_b32 s41, s45
    s_mov_b32 s42, 0x240000
    s_mov_b32 s43, 0x20000
    s_add_u32 m0, s49, 512
    s_nop 0
    buffer_load_dwordx4 v11, s[40:43], s48 offen offset:0 nt lds
    buffer_load_dwordx4 v11, s[40:43], s48 offen offset:1024 nt lds
    buffer_load_dwordx4 v11, s[40:43], s48 offen offset:2048 nt lds
    buffer_load_dwordx4 v11, s[40:43], s48 offen offset:3072 nt lds
    s_mov_b32 s98, 0x240000
    s_mov_b32 s99, 0x20000
    s_and_b32 s3, s2, 4
    s_lshr_b32 s100, s2, 6
    s_add_u32 s3, s3, s100
    s_lshl_b32 s3, s3, 2
    s_and_b32 s100, s2, 3
    s_add_u32 s3, s3, s100
    s_lshl_b32 s3, s3, 3
    s_bfe_u32 s100, s2, 0x30003
    s_add_u32 s3, s3, s100
    s_mul_i32 s3, s3, 9216
    v_and_b32 v241, 7, v0
    v_mul_u32_u24 v241, 1152, v241
    v_add_u32 v241, s3, v241
    s_mul_i32 s100, s24, 384
    v_bfe_u32 v244, v0, 3, 3
    v_lshl_add_u32 v244, v244, 4, v241
    s_cmp_ge_u32 s24, 2
    s_cselect_b32 s3, 128, 0
    s_cselect_b32 s101, 0, 0x100
    s_add_u32 s3, s3, s100
    s_add_u32 s101, s101, s100
    v_add_u32 v248, s101, v244
    v_add_u32 v244, s3, v244
    v_mul_u32_u24 v8, 272, v1
    v_sub_u32 v9, 15, v2
    v_lshl_add_u32 v8, v9, 4, v8
    v_add_u32 v8, 32768, v8
    v_bfe_u32 v10, v0, 4, 2
    v_mul_u32_u24 v58, 272, v10
    v_lshl_add_u32 v58, v1, 4, v58
    s_mul_i32 s29, s24, 4352
    s_add_u32 s29, s29, 32768
    v_add_u32 v58, s29, v58
    v_mul_u32_u24 v9, 16896, v10
    v_lshl_add_u32 v9, v1, 4, v9
    s_add_u32 s27, s27, s24
    s_mul_i32 s27, s27, 4224
    s_lshl_b32 s29, s25, 8
    s_sub_u32 s27, s27, s29
    s_add_u32 s27, s27, 3840
    s_waitcnt vmcnt(23)
    v_lshlrev_b32 v68, 16, v60
    v_and_b32 v70, 0xffff0000, v60
    v_lshlrev_b32 v72, 16, v61
    v_and_b32 v74, 0xffff0000, v61
    v_lshlrev_b32 v69, 16, v62
    v_and_b32 v71, 0xffff0000, v62
    v_lshlrev_b32 v73, 16, v63
    v_and_b32 v75, 0xffff0000, v63
    v_lshlrev_b32 v76, 16, v64
    v_and_b32 v78, 0xffff0000, v64
    v_lshlrev_b32 v80, 16, v65
    v_and_b32 v82, 0xffff0000, v65
    v_lshlrev_b32 v77, 16, v66
    v_and_b32 v79, 0xffff0000, v66
    v_lshlrev_b32 v81, 16, v67
    v_and_b32 v83, 0xffff0000, v67
    s_waitcnt vmcnt(12)
    v_lshlrev_b32 v86, 16, v18
    v_and_b32 v87, 0xffff0000, v18
    v_lshlrev_b32 v88, 16, v20
    v_and_b32 v89, 0xffff0000, v20
    v_lshlrev_b32 v90, 16, v22
    v_and_b32 v91, 0xffff0000, v22
    v_lshlrev_b32 v92, 16, v24
    v_and_b32 v93, 0xffff0000, v24
    v_lshlrev_b32 v94, 16, v26
    v_and_b32 v95, 0xffff0000, v26
    v_lshlrev_b32 v96, 16, v28
    v_and_b32 v97, 0xffff0000, v28
    v_lshlrev_b32 v98, 16, v30
    v_and_b32 v99, 0xffff0000, v30
    v_lshlrev_b32 v100, 16, v32
    v_and_b32 v101, 0xffff0000, v32
    v_lshlrev_b32 v102, 16, v34
    v_and_b32 v103, 0xffff0000, v34
    v_lshlrev_b32 v104, 16, v36
    v_and_b32 v105, 0xffff0000, v36
    v_lshlrev_b32 v106, 16, v38
    v_and_b32 v107, 0xffff0000, v38
    v_pk_mul_f32 v[128:129], v[86:87], v[74:75]
    v_pk_mul_f32 v[130:131], v[88:89], v[74:75]
    v_pk_mul_f32 v[132:133], v[90:91], v[74:75]
    v_pk_mul_f32 v[134:135], v[92:93], v[74:75]
    v_pk_mul_f32 v[136:137], v[94:95], v[74:75]
    v_pk_mul_f32 v[138:139], v[96:97], v[74:75]
    v_pk_mul_f32 v[140:141], v[98:99], v[74:75]
    v_pk_mul_f32 v[142:143], v[100:101], v[74:75]
    v_pk_fma_f32 v[128:129], v[88:89], v[72:73], v[128:129]
    v_pk_fma_f32 v[130:131], v[90:91], v[72:73], v[130:131]
    v_pk_fma_f32 v[132:133], v[92:93], v[72:73], v[132:133]
    v_pk_fma_f32 v[134:135], v[94:95], v[72:73], v[134:135]
    v_pk_fma_f32 v[136:137], v[96:97], v[72:73], v[136:137]
    v_pk_fma_f32 v[138:139], v[98:99], v[72:73], v[138:139]
    v_pk_fma_f32 v[140:141], v[100:101], v[72:73], v[140:141]
    v_pk_fma_f32 v[142:143], v[102:103], v[72:73], v[142:143]
    v_pk_fma_f32 v[128:129], v[90:91], v[70:71], v[128:129]
    v_pk_fma_f32 v[130:131], v[92:93], v[70:71], v[130:131]
    v_pk_fma_f32 v[132:133], v[94:95], v[70:71], v[132:133]
    v_pk_fma_f32 v[134:135], v[96:97], v[70:71], v[134:135]
    v_pk_fma_f32 v[136:137], v[98:99], v[70:71], v[136:137]
    v_pk_fma_f32 v[138:139], v[100:101], v[70:71], v[138:139]
    v_pk_fma_f32 v[140:141], v[102:103], v[70:71], v[140:141]
    v_pk_fma_f32 v[142:143], v[104:105], v[70:71], v[142:143]
    v_pk_fma_f32 v[128:129], v[92:93], v[68:69], v[128:129]
    v_pk_fma_f32 v[130:131], v[94:95], v[68:69], v[130:131]
    v_pk_fma_f32 v[132:133], v[96:97], v[68:69], v[132:133]
    v_pk_fma_f32 v[134:135], v[98:99], v[68:69], v[134:135]
    v_pk_fma_f32 v[136:137], v[100:101], v[68:69], v[136:137]
    v_pk_fma_f32 v[138:139], v[102:103], v[68:69], v[138:139]
    v_pk_fma_f32 v[140:141], v[104:105], v[68:69], v[140:141]
    v_pk_fma_f32 v[142:143], v[106:107], v[68:69], v[142:143]
    v_cvt_pk_bf16_f32 v128, 0, v128
    v_cvt_pk_bf16_f32 v129, 0, v129
    v_cvt_pk_bf16_f32 v130, 0, v130
    v_cvt_pk_bf16_f32 v131, 0, v131
    v_cvt_pk_bf16_f32 v132, 0, v132
    v_cvt_pk_bf16_f32 v133, 0, v133
    v_cvt_pk_bf16_f32 v134, 0, v134
    v_cvt_pk_bf16_f32 v135, 0, v135
    v_cvt_pk_bf16_f32 v136, 0, v136
    v_cvt_pk_bf16_f32 v137, 0, v137
    v_cvt_pk_bf16_f32 v138, 0, v138
    v_cvt_pk_bf16_f32 v139, 0, v139
    v_cvt_pk_bf16_f32 v140, 0, v140
    v_cvt_pk_bf16_f32 v141, 0, v141
    v_cvt_pk_bf16_f32 v142, 0, v142
    v_cvt_pk_bf16_f32 v143, 0, v143
    v_lshlrev_b32 v86, 16, v19
    v_and_b32 v87, 0xffff0000, v19
    v_lshlrev_b32 v88, 16, v21
    v_and_b32 v89, 0xffff0000, v21
    v_lshlrev_b32 v90, 16, v23
    v_and_b32 v91, 0xffff0000, v23
    v_lshlrev_b32 v92, 16, v25
    v_and_b32 v93, 0xffff0000, v25
    v_lshlrev_b32 v94, 16, v27
    v_and_b32 v95, 0xffff0000, v27
    v_lshlrev_b32 v96, 16, v29
    v_and_b32 v97, 0xffff0000, v29
    v_lshlrev_b32 v98, 16, v31
    v_and_b32 v99, 0xffff0000, v31
    v_lshlrev_b32 v100, 16, v33
    v_and_b32 v101, 0xffff0000, v33
    v_lshlrev_b32 v102, 16, v35
    v_and_b32 v103, 0xffff0000, v35
    v_lshlrev_b32 v104, 16, v37
    v_and_b32 v105, 0xffff0000, v37
    v_lshlrev_b32 v106, 16, v39
    v_and_b32 v107, 0xffff0000, v39
    v_pk_mul_f32 v[148:149], v[86:87], v[82:83]
    v_pk_mul_f32 v[150:151], v[88:89], v[82:83]
    v_pk_mul_f32 v[152:153], v[90:91], v[82:83]
    v_pk_mul_f32 v[154:155], v[92:93], v[82:83]
    v_pk_mul_f32 v[156:157], v[94:95], v[82:83]
    v_pk_mul_f32 v[158:159], v[96:97], v[82:83]
    v_pk_mul_f32 v[160:161], v[98:99], v[82:83]
    v_pk_mul_f32 v[162:163], v[100:101], v[82:83]
    v_pk_fma_f32 v[148:149], v[88:89], v[80:81], v[148:149]
    v_pk_fma_f32 v[150:151], v[90:91], v[80:81], v[150:151]
    v_pk_fma_f32 v[152:153], v[92:93], v[80:81], v[152:153]
    v_pk_fma_f32 v[154:155], v[94:95], v[80:81], v[154:155]
    v_pk_fma_f32 v[156:157], v[96:97], v[80:81], v[156:157]
    v_pk_fma_f32 v[158:159], v[98:99], v[80:81], v[158:159]
    v_pk_fma_f32 v[160:161], v[100:101], v[80:81], v[160:161]
    v_pk_fma_f32 v[162:163], v[102:103], v[80:81], v[162:163]
    v_pk_fma_f32 v[148:149], v[90:91], v[78:79], v[148:149]
    v_pk_fma_f32 v[150:151], v[92:93], v[78:79], v[150:151]
    v_pk_fma_f32 v[152:153], v[94:95], v[78:79], v[152:153]
    v_pk_fma_f32 v[154:155], v[96:97], v[78:79], v[154:155]
    v_pk_fma_f32 v[156:157], v[98:99], v[78:79], v[156:157]
    v_pk_fma_f32 v[158:159], v[100:101], v[78:79], v[158:159]
    v_pk_fma_f32 v[160:161], v[102:103], v[78:79], v[160:161]
    v_pk_fma_f32 v[162:163], v[104:105], v[78:79], v[162:163]
    v_pk_fma_f32 v[148:149], v[92:93], v[76:77], v[148:149]
    v_pk_fma_f32 v[150:151], v[94:95], v[76:77], v[150:151]
    v_pk_fma_f32 v[152:153], v[96:97], v[76:77], v[152:153]
    v_pk_fma_f32 v[154:155], v[98:99], v[76:77], v[154:155]
    v_pk_fma_f32 v[156:157], v[100:101], v[76:77], v[156:157]
    v_pk_fma_f32 v[158:159], v[102:103], v[76:77], v[158:159]
    v_pk_fma_f32 v[160:161], v[104:105], v[76:77], v[160:161]
    v_pk_fma_f32 v[162:163], v[106:107], v[76:77], v[162:163]
    v_cvt_pk_bf16_f32 v148, 0, v148
    v_cvt_pk_bf16_f32 v149, 0, v149
    v_cvt_pk_bf16_f32 v150, 0, v150
    v_cvt_pk_bf16_f32 v151, 0, v151
    v_cvt_pk_bf16_f32 v152, 0, v152
    v_cvt_pk_bf16_f32 v153, 0, v153
    v_cvt_pk_bf16_f32 v154, 0, v154
    v_cvt_pk_bf16_f32 v155, 0, v155
    v_cvt_pk_bf16_f32 v156, 0, v156
    v_cvt_pk_bf16_f32 v157, 0, v157
    v_cvt_pk_bf16_f32 v158, 0, v158
    v_cvt_pk_bf16_f32 v159, 0, v159
    v_cvt_pk_bf16_f32 v160, 0, v160
    v_cvt_pk_bf16_f32 v161, 0, v161
    v_cvt_pk_bf16_f32 v162, 0, v162
    v_cvt_pk_bf16_f32 v163, 0, v163
    s_waitcnt vmcnt(4)
    v_lshlrev_b32 v110, 16, v42
    v_and_b32 v111, 0xffff0000, v42
    v_lshlrev_b32 v112, 16, v44
    v_and_b32 v113, 0xffff0000, v44
    v_lshlrev_b32 v114, 16, v46
    v_and_b32 v115, 0xffff0000, v46
    v_lshlrev_b32 v116, 16, v48
    v_and_b32 v117, 0xffff0000, v48
    v_lshlrev_b32 v118, 16, v50
    v_and_b32 v119, 0xffff0000, v50
    v_lshlrev_b32 v120, 16, v52
    v_and_b32 v121, 0xffff0000, v52
    v_lshlrev_b32 v122, 16, v54
    v_and_b32 v123, 0xffff0000, v54
    v_lshlrev_b32 v124, 16, v56
    v_and_b32 v125, 0xffff0000, v56
    v_pk_mul_f32 v[128:129], v[128:129], v[110:111]
    v_pk_mul_f32 v[130:131], v[130:131], v[112:113]
    v_pk_mul_f32 v[132:133], v[132:133], v[114:115]
    v_pk_mul_f32 v[134:135], v[134:135], v[116:117]
    v_pk_mul_f32 v[136:137], v[136:137], v[118:119]
    v_pk_mul_f32 v[138:139], v[138:139], v[120:121]
    v_pk_mul_f32 v[140:141], v[140:141], v[122:123]
    v_pk_mul_f32 v[142:143], v[142:143], v[124:125]
    v_cvt_pk_bf16_f32 v164, v142, v140
    v_cvt_pk_bf16_f32 v165, v138, v136
    v_cvt_pk_bf16_f32 v166, v134, v132
    v_cvt_pk_bf16_f32 v167, v130, v128
    ds_write_b128 v8, v[164:167] offset:0
    v_cvt_pk_bf16_f32 v168, v143, v141
    v_cvt_pk_bf16_f32 v169, v139, v137
    v_cvt_pk_bf16_f32 v170, v135, v133
    v_cvt_pk_bf16_f32 v171, v131, v129
    ds_write_b128 v8, v[168:171] offset:4352
    v_lshlrev_b32 v110, 16, v43
    v_and_b32 v111, 0xffff0000, v43
    v_lshlrev_b32 v112, 16, v45
    v_and_b32 v113, 0xffff0000, v45
    v_lshlrev_b32 v114, 16, v47
    v_and_b32 v115, 0xffff0000, v47
    v_lshlrev_b32 v116, 16, v49
    v_and_b32 v117, 0xffff0000, v49
    v_lshlrev_b32 v118, 16, v51
    v_and_b32 v119, 0xffff0000, v51
    v_lshlrev_b32 v120, 16, v53
    v_and_b32 v121, 0xffff0000, v53
    v_lshlrev_b32 v122, 16, v55
    v_and_b32 v123, 0xffff0000, v55
    v_lshlrev_b32 v124, 16, v57
    v_and_b32 v125, 0xffff0000, v57
    v_pk_mul_f32 v[148:149], v[148:149], v[110:111]
    v_pk_mul_f32 v[150:151], v[150:151], v[112:113]
    v_pk_mul_f32 v[152:153], v[152:153], v[114:115]
    v_pk_mul_f32 v[154:155], v[154:155], v[116:117]
    v_pk_mul_f32 v[156:157], v[156:157], v[118:119]
    v_pk_mul_f32 v[158:159], v[158:159], v[120:121]
    v_pk_mul_f32 v[160:161], v[160:161], v[122:123]
    v_pk_mul_f32 v[162:163], v[162:163], v[124:125]
    v_cvt_pk_bf16_f32 v172, v162, v160
    v_cvt_pk_bf16_f32 v173, v158, v156
    v_cvt_pk_bf16_f32 v174, v154, v152
    v_cvt_pk_bf16_f32 v175, v150, v148
    ds_write_b128 v8, v[172:175] offset:8704
    v_cvt_pk_bf16_f32 v176, v163, v161
    v_cvt_pk_bf16_f32 v177, v159, v157
    v_cvt_pk_bf16_f32 v178, v155, v153
    v_cvt_pk_bf16_f32 v179, v151, v149
    ds_write_b128 v8, v[176:179] offset:13056
    v_and_b32 v10, 7, v0
    v_lshlrev_b32 v10, 4, v10
    v_mov_b32 v12, 0
    v_mov_b32 v13, 0
    v_mov_b32 v14, 0
    v_mov_b32 v15, 0
    s_lshl_b32 s29, s2, 2
    s_add_u32 s29, s29, s24
    s_mul_i32 s29, s29, 4224
    s_add_u32 s29, s29, 4096
    s_mov_b64 exec, 0xff
    buffer_store_dwordx4 v[12:15], v10, s[36:39], s29 offen sc1
    s_mov_b64 exec, -1
    s_waitcnt lgkmcnt(0)
    s_barrier
    ds_read_b128 v[196:199], v58 offset:0
    ds_read_b128 v[200:203], v58 offset:1088
    ds_read_b128 v[204:207], v58 offset:2176
    ds_read_b128 v[208:211], v58 offset:3264
    s_add_u32 s29, s27, 0
    s_waitcnt lgkmcnt(3)
    buffer_store_dwordx4 v[196:199], v9, s[36:39], s29 offen sc1
    s_add_u32 s29, s27, 67584
    s_waitcnt lgkmcnt(2)
    buffer_store_dwordx4 v[200:203], v9, s[36:39], s29 offen sc1
    s_add_u32 s29, s27, 135168
    s_waitcnt lgkmcnt(1)
    buffer_store_dwordx4 v[204:207], v9, s[36:39], s29 offen sc1
    s_add_u32 s29, s27, 202752
    s_waitcnt lgkmcnt(0)
    buffer_store_dwordx4 v[208:211], v9, s[36:39], s29 offen sc1
    s_waitcnt lgkmcnt(0)
    s_add_u32 s54, s54, 1
    v_mov_b32 v249, s54
    s_and_b32 s31, s2, 0xf0
    s_lshl_b32 s31, s31, 7
    s_add_u32 s31, s31, 4096
    s_and_b32 s100, s2, 15
    s_lshl_b32 s100, s100, 7
    s_add_u32 s3, s31, s100
    s_waitcnt vmcnt(0)
    s_barrier
    s_cmp_lg_u32 s24, 0
    s_cbranch_scc1 sig_kv
    v_mov_b32 v250, 0
    s_mov_b64 exec, 1
    buffer_store_dword v249, v250, s[56:59], s3 offen sc1
    s_mov_b64 exec, -1
sig_kv:
    v_and_b32 v2, 63, v0
    v_and_b32 v3, 15, v0
    v_bfe_u32 v4, v0, 4, 2
    s_lshl_b32 s25, s2, 2
    s_add_u32 s25, s25, s24
    s_mul_i32 s26, s24, 4608
    s_mul_i32 s28, s25, 4224
    s_mul_i32 s27, s24, 33280
    s_add_u32 s27, s27, 18432
    v_lshlrev_b32 v7, 4, v2
    v_lshlrev_b32 v8, 5, v3
    v_lshl_add_u32 v8, v4, 4, v8
    v_add_u32 v8, s26, v8
    v_add_u32 v8, 32, v8
    s_add_u32 s12, s22, 0x1000000
    s_addc_u32 s13, s23, 0
    s_mov_b32 s14, 0x252000
    s_mov_b32 s15, 0x20000
    s_add_u32 s32, s22, 0x1800000
    s_addc_u32 s33, s23, 0
    s_mov_b32 s34, 0x240000
    s_mov_b32 s35, 0x20000
    s_mov_b32 s36, s46
    s_mov_b32 s37, s47
    s_mov_b32 s38, 0x480
    s_mov_b32 s39, 0x20000
    s_mul_i32 s30, s24, 147456
    s_lshl_b32 s29, s2, 7
    s_add_u32 s30, s30, s29
    v_lshrrev_b32 v1, 3, v2
    v_mul_u32_u24 v1, 18432, v1
    v_and_b32 v6, 7, v2
    v_lshl_add_u32 v1, v6, 4, v1
    s_lshl_b32 s29, s25, 1
    v_mov_b32 v14, 0
    buffer_load_ushort v15, v14, s[36:39], s29 offen
    s_waitcnt vmcnt(1) lgkmcnt(0)
    v_mov_b32 v20, -1
    v_mov_b32 v21, -1
    v_mov_b32 v22, -1
    v_mov_b32 v23, -1
    s_add_u32 s29, s30, 0
    buffer_store_dwordx4 v[20:23], v1, s[32:35], s29 offen sc1
    s_add_u32 s29, s30, 589824
    buffer_store_dwordx4 v[20:23], v1, s[32:35], s29 offen sc1
    s_add_u32 s29, s30, 1179648
    buffer_store_dwordx4 v[20:23], v1, s[32:35], s29 offen sc1
    s_add_u32 s29, s30, 1769472
    buffer_store_dwordx4 v[20:23], v1, s[32:35], s29 offen sc1
    ds_read_b128 a[252:255], v8 offset:0
    ds_read_b128 a[248:251], v8 offset:64
    ds_read_b128 a[244:247], v8 offset:128
    ds_read_b128 a[240:243], v8 offset:192
    ds_read_b128 a[236:239], v8 offset:256
    ds_read_b128 a[232:235], v8 offset:320
    ds_read_b128 a[228:231], v8 offset:384
    ds_read_b128 a[224:227], v8 offset:448
    ds_read_b128 a[220:223], v8 offset:512
    ds_read_b128 a[216:219], v8 offset:576
    ds_read_b128 a[212:215], v8 offset:640
    ds_read_b128 a[208:211], v8 offset:704
    ds_read_b128 a[204:207], v8 offset:768
    ds_read_b128 a[200:203], v8 offset:832
    ds_read_b128 a[196:199], v8 offset:896
    ds_read_b128 a[192:195], v8 offset:960
    ds_read_b128 a[188:191], v8 offset:1024
    ds_read_b128 a[184:187], v8 offset:1088
    ds_read_b128 a[180:183], v8 offset:1152
    ds_read_b128 a[176:179], v8 offset:1216
    ds_read_b128 a[172:175], v8 offset:1280
    ds_read_b128 a[168:171], v8 offset:1344
    ds_read_b128 a[164:167], v8 offset:1408
    ds_read_b128 a[160:163], v8 offset:1472
    ds_read_b128 a[156:159], v8 offset:1536
    ds_read_b128 a[152:155], v8 offset:1600
    ds_read_b128 a[148:151], v8 offset:1664
    ds_read_b128 a[144:147], v8 offset:1728
    ds_read_b128 a[140:143], v8 offset:1792
    ds_read_b128 a[136:139], v8 offset:1856
    ds_read_b128 a[132:135], v8 offset:1920
    ds_read_b128 a[128:131], v8 offset:1984
    ds_read_b128 a[124:127], v8 offset:2048
    ds_read_b128 a[120:123], v8 offset:2112
    ds_read_b128 a[116:119], v8 offset:2176
    ds_read_b128 a[112:115], v8 offset:2240
    ds_read_b128 a[108:111], v8 offset:2304
    ds_read_b128 a[104:107], v8 offset:2368
    ds_read_b128 a[100:103], v8 offset:2432
    ds_read_b128 a[96:99], v8 offset:2496
    ds_read_b128 a[92:95], v8 offset:2560
    ds_read_b128 a[88:91], v8 offset:2624
    ds_read_b128 a[84:87], v8 offset:2688
    ds_read_b128 a[80:83], v8 offset:2752
    ds_read_b128 a[76:79], v8 offset:2816
    ds_read_b128 a[72:75], v8 offset:2880
    ds_read_b128 a[68:71], v8 offset:2944
    ds_read_b128 a[64:67], v8 offset:3008
    ds_read_b128 a[60:63], v8 offset:3072
    ds_read_b128 a[56:59], v8 offset:3136
    ds_read_b128 a[52:55], v8 offset:3200
    ds_read_b128 a[48:51], v8 offset:3264
    ds_read_b128 a[44:47], v8 offset:3328
    ds_read_b128 a[40:43], v8 offset:3392
    ds_read_b128 a[36:39], v8 offset:3456
    ds_read_b128 a[32:35], v8 offset:3520
    ds_read_b128 a[28:31], v8 offset:3584
    ds_read_b128 a[24:27], v8 offset:3648
    ds_read_b128 a[20:23], v8 offset:3712
    ds_read_b128 a[16:19], v8 offset:3776
    ds_read_b128 a[12:15], v8 offset:3840
    ds_read_b128 a[8:11], v8 offset:3904
    ds_read_b128 a[4:7], v8 offset:3968
    ds_read_b128 a[0:3], v8 offset:4032
    v_sub_u32 v5, 7, v3
    v_and_b32 v5, 7, v5
    v_mul_u32_u24 v5, 4160, v5
    v_lshrrev_b32 v6, 3, v3
    v_sub_u32 v6, v4, v6
    v_lshl_add_u32 v5, v6, 4, v5
    v_add_u32 v5, s27, v5
    v_add_u32 v5, 16, v5
    v_lshlrev_b32 v12, 5, v3
    v_lshl_add_u32 v12, v4, 3, v12
    v_sub_u32 v13, 504, v12
    v_add_u32 v13, s27, v13
    v_mul_u32_u24 v9, 144, v3
    v_lshl_add_u32 v9, v4, 3, v9
    s_lshl_b32 s29, s24, 5
    v_add_u32 v9, s29, v9
    v_lshrrev_b32 v10, 3, v0
    v_mul_u32_u24 v10, 144, v10
    v_and_b32 v6, 7, v2
    v_lshl_add_u32 v10, v6, 4, v10
    v_lshrrev_b32 v6, 3, v2
    v_mul_u32_u24 v6, 4160, v6
    v_and_b32 v11, 7, v2
    v_lshl_add_u32 v6, v11, 3, v6
    v_add_u32 v6, s27, v6
    v_mov_b32 v16, 0
    v_mov_b32 v17, 0
    ds_write_b64 v6, v[16:17] offset:4096
    v_add_u32 v11, s27, v7
    v_and_b32 v250, 15, v0
    v_lshlrev_b32 v250, 7, v250
    s_cmp_lg_u32 s24, 0
    s_cbranch_scc1 m_pkv_ok
    s_mov_b64 exec, 15
m_pkv:
    buffer_load_dword v22, v250, s[56:59], s31 offen sc1
    s_waitcnt vmcnt(0)
    v_cmp_ne_u32 vcc, v249, v22
    s_cbranch_vccz m_pkv_ok
    s_sub_i32 s55, s55, 1
    s_cmp_lt_i32 s55, 0
    s_cbranch_scc1 m_pkv_ok
    s_sleep 1
    s_branch m_pkv
m_pkv_ok:
    s_mov_b64 exec, -1
    s_waitcnt lgkmcnt(0)
    s_barrier
    buffer_load_dwordx4 v[120:123], v7, s[12:15], s28 offen offset:3072 sc1
    buffer_load_dwordx4 v[124:127], v7, s[12:15], s28 offen offset:3088 sc1
    s_add_u32 m0, s27, 0
    s_add_u32 s29, s28, 0
    buffer_load_dwordx4 v7, s[12:15], s29 offen offset:3072 sc1 lds
    s_add_u32 m0, s27, 8320
    s_add_u32 s29, s28, 4
    buffer_load_dwordx4 v7, s[12:15], s29 offen offset:3072 sc1 lds
    s_add_u32 m0, s27, 16640
    s_add_u32 s29, s28, 8
    buffer_load_dwordx4 v7, s[12:15], s29 offen offset:3072 sc1 lds
    s_add_u32 m0, s27, 24960
    s_add_u32 s29, s28, 12
    buffer_load_dwordx4 v7, s[12:15], s29 offen offset:3072 sc1 lds
    s_mov_b32 s48, s31
    buffer_load_dword v251, v250, s[56:59], s48 offen sc1
    s_lshr_b32 s49, s2, 2
    s_lshl_b32 s49, s49, 7
    s_and_b32 s3, s2, 3
    s_lshl_b32 s3, s3, 2
    s_add_u32 s49, s49, s3
    s_lshl_b32 s3, s24, 20
    s_add_u32 s49, s49, s3
    s_add_u32 s49, s49, 40960
    s_waitcnt vmcnt(1)
    v_alignbit_b32 v128, v121, v120, 16
    v_alignbit_b32 v129, v122, v121, 16
    v_alignbit_b32 v130, v123, v122, 16
    v_alignbit_b32 v131, v124, v123, 16
    v_alignbit_b32 v132, v125, v124, 16
    v_alignbit_b32 v133, v126, v125, 16
    ds_write_b128 v11, v[128:131] offset:7232
    ds_write_b128 v11, v[130:133] offset:23872
    v_alignbit_b32 v136, v122, v121, 16
    v_alignbit_b32 v137, v123, v122, 16
    v_alignbit_b32 v138, v124, v123, 16
    v_alignbit_b32 v139, v125, v124, 16
    v_alignbit_b32 v140, v126, v125, 16
    v_alignbit_b32 v141, v127, v126, 16
    ds_write_b128 v11, v[136:139] offset:15552
    ds_write_b128 v11, v[138:141] offset:32192
    s_waitcnt vmcnt(0)
    v_cmp_ne_u32 vcc, v249, v251
    s_cbranch_vccnz cv_slow
cv_back:
    ds_read_b128 v[64:67], v5 offset:4032
    ds_read_b128 v[68:71], v5 offset:3968
    ds_read_b128 v[72:75], v5 offset:3904
    ds_read_b128 v[76:79], v5 offset:3840
    ds_read_b128 v[80:83], v5 offset:3776
    ds_read_b128 v[84:87], v5 offset:3712
    ds_read_b128 v[88:91], v5 offset:3648
    ds_read_b128 v[92:95], v5 offset:3584
    s_waitcnt lgkmcnt(7)
    v_mfma_f32_16x16x32_bf16 v[32:35], v[64:67], a[224:227], 0
    buffer_load_dwordx4 v[112:115], v7, s[12:15], s28 offen offset:2048 sc1
    v_mfma_f32_16x16x32_bf16 v[36:39], v[64:67], a[192:195], 0
    v_mfma_f32_16x16x32_bf16 v[40:43], v[64:67], a[160:163], 0
    v_lshlrev_b32 v15, 16, v15
    v_mfma_f32_16x16x32_bf16 v[44:47], v[64:67], a[128:131], 0
    buffer_load_dwordx4 v[116:119], v7, s[12:15], s28 offen offset:2064 sc1
    v_mfma_f32_16x16x32_bf16 v[48:51], v[64:67], a[96:99], 0
    v_mfma_f32_16x16x32_bf16 v[52:55], v[64:67], a[64:67], 0
    v_mfma_f32_16x16x32_bf16 v[56:59], v[64:67], a[32:35], 0
    buffer_load_dwordx4 v[104:107], v7, s[12:15], s28 offen offset:1024 sc1
    v_mfma_f32_16x16x32_bf16 v[60:63], v[64:67], a[0:3], 0
    ds_read_b128 v[64:67], v5 offset:3520
    s_waitcnt lgkmcnt(7)
    v_mfma_f32_16x16x32_bf16 v[32:35], v[68:71], a[228:231], v[32:35]
    v_mfma_f32_16x16x32_bf16 v[36:39], v[68:71], a[196:199], v[36:39]
    buffer_load_dwordx4 v[108:111], v7, s[12:15], s28 offen offset:1040 sc1
    v_mfma_f32_16x16x32_bf16 v[40:43], v[68:71], a[164:167], v[40:43]
    v_mfma_f32_16x16x32_bf16 v[44:47], v[68:71], a[132:135], v[44:47]
    v_mfma_f32_16x16x32_bf16 v[48:51], v[68:71], a[100:103], v[48:51]
    buffer_load_dwordx4 v[96:99], v7, s[12:15], s28 offen offset:0 sc1
    v_mfma_f32_16x16x32_bf16 v[52:55], v[68:71], a[68:71], v[52:55]
    v_mfma_f32_16x16x32_bf16 v[56:59], v[68:71], a[36:39], v[56:59]
    v_mfma_f32_16x16x32_bf16 v[60:63], v[68:71], a[4:7], v[60:63]
    ds_read_b128 v[68:71], v5 offset:3456
    s_waitcnt lgkmcnt(7)
    v_mfma_f32_16x16x32_bf16 v[32:35], v[72:75], a[232:235], v[32:35]
    buffer_load_dwordx4 v[100:103], v7, s[12:15], s28 offen offset:16 sc1
    v_mfma_f32_16x16x32_bf16 v[36:39], v[72:75], a[200:203], v[36:39]
    v_mfma_f32_16x16x32_bf16 v[40:43], v[72:75], a[168:171], v[40:43]
    v_mfma_f32_16x16x32_bf16 v[44:47], v[72:75], a[136:139], v[44:47]
    s_add_u32 m0, s27, 0
    s_add_u32 s29, s28, 0
    v_mfma_f32_16x16x32_bf16 v[48:51], v[72:75], a[104:107], v[48:51]
    buffer_load_dwordx4 v7, s[12:15], s29 offen offset:2048 sc1 lds
    v_mfma_f32_16x16x32_bf16 v[52:55], v[72:75], a[72:75], v[52:55]
    ds_read_b64 v[16:17], v13 offset:3584
    v_mfma_f32_16x16x32_bf16 v[56:59], v[72:75], a[40:43], v[56:59]
    v_mfma_f32_16x16x32_bf16 v[60:63], v[72:75], a[8:11], v[60:63]
    ds_read_b128 v[72:75], v5 offset:3392
    s_waitcnt lgkmcnt(8)
    v_mfma_f32_16x16x32_bf16 v[32:35], v[76:79], a[236:239], v[32:35]
    buffer_load_dwordx4 v7, s[12:15], s29 offen offset:1024 sc1 lds
    v_mfma_f32_16x16x32_bf16 v[36:39], v[76:79], a[204:207], v[36:39]
    v_mfma_f32_16x16x32_bf16 v[40:43], v[76:79], a[172:175], v[40:43]
    v_mfma_f32_16x16x32_bf16 v[44:47], v[76:79], a[140:143], v[44:47]
    buffer_load_dwordx4 v7, s[12:15], s29 offen offset:0 sc1 lds
    v_mfma_f32_16x16x32_bf16 v[48:51], v[76:79], a[108:111], v[48:51]
    v_mfma_f32_16x16x32_bf16 v[52:55], v[76:79], a[76:79], v[52:55]
    v_mfma_f32_16x16x32_bf16 v[56:59], v[76:79], a[44:47], v[56:59]
    s_add_u32 m0, s27, 8320
    s_add_u32 s29, s28, 4
    v_mfma_f32_16x16x32_bf16 v[60:63], v[76:79], a[12:15], v[60:63]
    ds_read_b128 v[76:79], v5 offset:3328
    s_waitcnt lgkmcnt(8)
    v_mfma_f32_16x16x32_bf16 v[32:35], v[80:83], a[240:243], v[32:35]
    buffer_load_dwordx4 v7, s[12:15], s29 offen offset:2048 sc1 lds
    v_mfma_f32_16x16x32_bf16 v[36:39], v[80:83], a[208:211], v[36:39]
    s_waitcnt lgkmcnt(2)
    v_and_b32 v208, 0xffff0000, v17
    v_mfma_f32_16x16x32_bf16 v[40:43], v[80:83], a[176:179], v[40:43]
    v_lshlrev_b32 v209, 16, v17
    v_and_b32 v210, 0xffff0000, v16
    v_mfma_f32_16x16x32_bf16 v[44:47], v[80:83], a[144:147], v[44:47]
    buffer_load_dwordx4 v7, s[12:15], s29 offen offset:1024 sc1 lds
    v_mfma_f32_16x16x32_bf16 v[48:51], v[80:83], a[112:115], v[48:51]
    v_lshlrev_b32 v211, 16, v16
    v_mul_f32 v208, v208, v15
    v_mfma_f32_16x16x32_bf16 v[52:55], v[80:83], a[80:83], v[52:55]
    v_mul_f32 v209, v209, v15
    v_mul_f32 v210, v210, v15
    v_mfma_f32_16x16x32_bf16 v[56:59], v[80:83], a[48:51], v[56:59]
    buffer_load_dwordx4 v7, s[12:15], s29 offen offset:0 sc1 lds
    v_mfma_f32_16x16x32_bf16 v[60:63], v[80:83], a[16:19], v[60:63]
    ds_read_b128 v[80:83], v5 offset:3264
    v_mfma_f32_16x16x32_bf16 v[32:35], v[84:87], a[244:247], v[32:35]
    v_mul_f32 v211, v211, v15
    v_cvt_pk_bf16_f32 v208, 0, v208
    v_mfma_f32_16x16x32_bf16 v[36:39], v[84:87], a[212:215], v[36:39]
    s_add_u32 m0, s27, 16640
    s_add_u32 s29, s28, 8
    v_mfma_f32_16x16x32_bf16 v[40:43], v[84:87], a[180:183], v[40:43]
    buffer_load_dwordx4 v7, s[12:15], s29 offen offset:2048 sc1 lds
    v_mfma_f32_16x16x32_bf16 v[44:47], v[84:87], a[148:151], v[44:47]
    v_cvt_pk_bf16_f32 v209, 0, v209
    v_cvt_pk_bf16_f32 v210, 0, v210
    v_mfma_f32_16x16x32_bf16 v[48:51], v[84:87], a[116:119], v[48:51]
    v_cvt_pk_bf16_f32 v211, 0, v211
    v_mfma_f32_16x16x32_bf16 v[52:55], v[84:87], a[84:87], v[52:55]
    buffer_load_dwordx4 v7, s[12:15], s29 offen offset:1024 sc1 lds
    v_mfma_f32_16x16x32_bf16 v[56:59], v[84:87], a[52:55], v[56:59]
    ds_read_b64 v[18:19], v13 offset:3072
    v_mfma_f32_16x16x32_bf16 v[60:63], v[84:87], a[20:23], v[60:63]
    ds_read_b128 v[84:87], v5 offset:3200
    v_mfma_f32_16x16x32_bf16 v[32:35], v[88:91], a[248:251], v[32:35]
    buffer_load_dwordx4 v7, s[12:15], s29 offen offset:0 sc1 lds
    v_mfma_f32_16x16x32_bf16 v[36:39], v[88:91], a[216:219], v[36:39]
    v_mfma_f32_16x16x32_bf16 v[40:43], v[88:91], a[184:187], v[40:43]
    v_mfma_f32_16x16x32_bf16 v[44:47], v[88:91], a[152:155], v[44:47]
    s_add_u32 m0, s27, 24960
    s_add_u32 s29, s28, 12
    v_mfma_f32_16x16x32_bf16 v[48:51], v[88:91], a[120:123], v[48:51]
    buffer_load_dwordx4 v7, s[12:15], s29 offen offset:2048 sc1 lds
    v_mfma_f32_16x16x32_bf16 v[52:55], v[88:91], a[88:91], v[52:55]
    v_mfma_f32_16x16x32_bf16 v[56:59], v[88:91], a[56:59], v[56:59]
    v_mfma_f32_16x16x32_bf16 v[60:63], v[88:91], a[24:27], v[60:63]
    ds_read_b128 v[88:91], v5 offset:3136
    v_mfma_f32_16x16x32_bf16 v[32:35], v[92:95], a[252:255], v[32:35]
    buffer_load_dwordx4 v7, s[12:15], s29 offen offset:1024 sc1 lds
    v_mfma_f32_16x16x32_bf16 v[36:39], v[92:95], a[220:223], v[36:39]
    s_waitcnt lgkmcnt(2)
    v_and_b32 v212, 0xffff0000, v19
    v_mfma_f32_16x16x32_bf16 v[40:43], v[92:95], a[188:191], v[40:43]
    v_lshlrev_b32 v213, 16, v19
    v_and_b32 v214, 0xffff0000, v18
    v_mfma_f32_16x16x32_bf16 v[44:47], v[92:95], a[156:159], v[44:47]
    buffer_load_dwordx4 v7, s[12:15], s29 offen offset:0 sc1 lds
    v_mfma_f32_16x16x32_bf16 v[48:51], v[92:95], a[124:127], v[48:51]
    s_waitcnt vmcnt(16)
    v_lshlrev_b32 v215, 16, v18
    v_cvt_pk_bf16_f32 v32, 0, v32
    v_mfma_f32_16x16x32_bf16 v[52:55], v[92:95], a[92:95], v[52:55]
    v_mul_f32 v212, v212, v15
    v_mul_f32 v213, v213, v15
    v_cvt_pk_bf16_f32 v33, 0, v33
    v_mfma_f32_16x16x32_bf16 v[56:59], v[92:95], a[60:63], v[56:59]
    v_alignbit_b32 v128, v113, v112, 16
    v_mul_f32 v214, v214, v15
    v_cvt_pk_bf16_f32 v34, 0, v34
    v_mfma_f32_16x16x32_bf16 v[60:63], v[92:95], a[28:31], v[60:63]
    ds_read_b128 v[92:95], v5 offset:3072
    v_cvt_pk_bf16_f32 v35, 0, v35
    v_mfma_f32_16x16x32_bf16 v[36:39], v[64:67], a[224:227], v[36:39]
    v_alignbit_b32 v129, v114, v113, 16
    v_mul_f32 v215, v215, v15
    v_add_f32 v208, v208, v32
    v_mfma_f32_16x16x32_bf16 v[40:43], v[64:67], a[192:195], v[40:43]
    v_cvt_pk_bf16_f32 v212, 0, v212
    v_cvt_pk_bf16_f32 v213, 0, v213
    v_add_f32 v209, v209, v33
    v_mfma_f32_16x16x32_bf16 v[44:47], v[64:67], a[160:163], v[44:47]
    v_alignbit_b32 v130, v115, v114, 16
    v_cvt_pk_bf16_f32 v214, 0, v214
    v_add_f32 v210, v210, v34
    v_mfma_f32_16x16x32_bf16 v[48:51], v[64:67], a[128:131], v[48:51]
    v_cvt_pk_bf16_f32 v215, 0, v215
    v_add_f32 v211, v211, v35
    v_cvt_pk_bf16_f32 v208, v208, v209
    v_mfma_f32_16x16x32_bf16 v[52:55], v[64:67], a[96:99], v[52:55]
    v_alignbit_b32 v131, v116, v115, 16
    v_cvt_pk_bf16_f32 v209, v210, v211
    ds_write_b64 v9, v[208:209] offset:0
    v_mfma_f32_16x16x32_bf16 v[56:59], v[64:67], a[64:67], v[56:59]
    v_mfma_f32_16x16x32_bf16 v[60:63], v[64:67], a[32:35], v[60:63]
    v_alignbit_b32 v132, v117, v116, 16
    v_mfma_f32_16x16x32_bf16 v[36:39], v[68:71], a[228:231], v[36:39]
    v_mfma_f32_16x16x32_bf16 v[40:43], v[68:71], a[196:199], v[40:43]
    v_alignbit_b32 v133, v118, v117, 16
    v_mfma_f32_16x16x32_bf16 v[44:47], v[68:71], a[164:167], v[44:47]
    v_mfma_f32_16x16x32_bf16 v[48:51], v[68:71], a[132:135], v[48:51]
    ds_write_b128 v11, v[128:131] offset:6208
    v_mfma_f32_16x16x32_bf16 v[52:55], v[68:71], a[100:103], v[52:55]
    v_mfma_f32_16x16x32_bf16 v[56:59], v[68:71], a[68:71], v[56:59]
    ds_write_b128 v11, v[130:133] offset:22848
    v_mfma_f32_16x16x32_bf16 v[60:63], v[68:71], a[36:39], v[60:63]
    v_mfma_f32_16x16x32_bf16 v[36:39], v[72:75], a[232:235], v[36:39]
    v_alignbit_b32 v136, v114, v113, 16
    v_mfma_f32_16x16x32_bf16 v[40:43], v[72:75], a[200:203], v[40:43]
    v_mfma_f32_16x16x32_bf16 v[44:47], v[72:75], a[168:171], v[44:47]
    v_alignbit_b32 v137, v115, v114, 16
    v_mfma_f32_16x16x32_bf16 v[48:51], v[72:75], a[136:139], v[48:51]
    v_mfma_f32_16x16x32_bf16 v[52:55], v[72:75], a[104:107], v[52:55]
    v_alignbit_b32 v138, v116, v115, 16
    v_mfma_f32_16x16x32_bf16 v[56:59], v[72:75], a[72:75], v[56:59]
    v_mfma_f32_16x16x32_bf16 v[60:63], v[72:75], a[40:43], v[60:63]
    v_alignbit_b32 v139, v117, v116, 16
    v_mfma_f32_16x16x32_bf16 v[36:39], v[76:79], a[236:239], v[36:39]
    v_mfma_f32_16x16x32_bf16 v[40:43], v[76:79], a[204:207], v[40:43]
    v_alignbit_b32 v140, v118, v117, 16
    v_mfma_f32_16x16x32_bf16 v[44:47], v[76:79], a[172:175], v[44:47]
    v_mfma_f32_16x16x32_bf16 v[48:51], v[76:79], a[140:143], v[48:51]
    v_alignbit_b32 v141, v119, v118, 16
    v_mfma_f32_16x16x32_bf16 v[52:55], v[76:79], a[108:111], v[52:55]
    v_mfma_f32_16x16x32_bf16 v[56:59], v[76:79], a[76:79], v[56:59]
    ds_write_b128 v11, v[136:139] offset:14528
    v_mfma_f32_16x16x32_bf16 v[60:63], v[76:79], a[44:47], v[60:63]
    v_mfma_f32_16x16x32_bf16 v[36:39], v[80:83], a[240:243], v[36:39]
    ds_write_b128 v11, v[138:141] offset:31168
    v_mfma_f32_16x16x32_bf16 v[40:43], v[80:83], a[208:211], v[40:43]
    v_mfma_f32_16x16x32_bf16 v[44:47], v[80:83], a[176:179], v[44:47]
    v_mfma_f32_16x16x32_bf16 v[48:51], v[80:83], a[144:147], v[48:51]
    v_mfma_f32_16x16x32_bf16 v[52:55], v[80:83], a[112:115], v[52:55]
    v_mfma_f32_16x16x32_bf16 v[56:59], v[80:83], a[80:83], v[56:59]
    v_mfma_f32_16x16x32_bf16 v[60:63], v[80:83], a[48:51], v[60:63]
    s_waitcnt lgkmcnt(7)
    v_mfma_f32_16x16x32_bf16 v[36:39], v[84:87], a[244:247], v[36:39]
    v_mfma_f32_16x16x32_bf16 v[40:43], v[84:87], a[212:215], v[40:43]
    v_mfma_f32_16x16x32_bf16 v[44:47], v[84:87], a[180:183], v[44:47]
    v_mfma_f32_16x16x32_bf16 v[48:51], v[84:87], a[148:151], v[48:51]
    v_mfma_f32_16x16x32_bf16 v[52:55], v[84:87], a[116:119], v[52:55]
    v_mfma_f32_16x16x32_bf16 v[56:59], v[84:87], a[84:87], v[56:59]
    s_waitcnt vmcnt(0)
    v_mfma_f32_16x16x32_bf16 v[60:63], v[84:87], a[52:55], v[60:63]
    ds_read_b128 v[64:67], v5 offset:3008
    ds_read_b128 v[68:71], v5 offset:2944
    s_waitcnt lgkmcnt(8)
    v_mfma_f32_16x16x32_bf16 v[36:39], v[88:91], a[248:251], v[36:39]
    ds_read_b128 v[72:75], v5 offset:2880
    ds_read_b128 v[76:79], v5 offset:2816
    ds_read_b128 v[80:83], v5 offset:2752
    v_mfma_f32_16x16x32_bf16 v[40:43], v[88:91], a[216:219], v[40:43]
    ds_read_b128 v[84:87], v5 offset:2688
    v_mfma_f32_16x16x32_bf16 v[44:47], v[88:91], a[184:187], v[44:47]
    ds_read_b64 v[20:21], v13 offset:2560
    v_mfma_f32_16x16x32_bf16 v[48:51], v[88:91], a[152:155], v[48:51]
    v_mfma_f32_16x16x32_bf16 v[52:55], v[88:91], a[120:123], v[52:55]
    v_mfma_f32_16x16x32_bf16 v[56:59], v[88:91], a[88:91], v[56:59]
    v_mfma_f32_16x16x32_bf16 v[60:63], v[88:91], a[56:59], v[60:63]
    ds_read_b128 v[88:91], v5 offset:2624
    s_waitcnt lgkmcnt(13)
    v_mfma_f32_16x16x32_bf16 v[36:39], v[92:95], a[252:255], v[36:39]
    v_mfma_f32_16x16x32_bf16 v[40:43], v[92:95], a[220:223], v[40:43]
    v_mfma_f32_16x16x32_bf16 v[44:47], v[92:95], a[188:191], v[44:47]
    v_mfma_f32_16x16x32_bf16 v[48:51], v[92:95], a[156:159], v[48:51]
    v_mfma_f32_16x16x32_bf16 v[52:55], v[92:95], a[124:127], v[52:55]
    s_nop 3
    v_cvt_pk_bf16_f32 v36, 0, v36
    v_cvt_pk_bf16_f32 v37, 0, v37
    v_cvt_pk_bf16_f32 v38, 0, v38
    v_mfma_f32_16x16x32_bf16 v[56:59], v[92:95], a[92:95], v[56:59]
    s_waitcnt lgkmcnt(1)
    v_and_b32 v216, 0xffff0000, v21
    v_cvt_pk_bf16_f32 v39, 0, v39
    v_mfma_f32_16x16x32_bf16 v[60:63], v[92:95], a[60:63], v[60:63]
    ds_read_b128 v[92:95], v5 offset:2560
    v_add_f32 v212, v212, v36
    v_mfma_f32_16x16x32_bf16 v[40:43], v[64:67], a[224:227], v[40:43]
    v_lshlrev_b32 v217, 16, v21
    v_and_b32 v218, 0xffff0000, v20
    v_add_f32 v213, v213, v37
    v_mfma_f32_16x16x32_bf16 v[44:47], v[64:67], a[192:195], v[44:47]
    v_lshlrev_b32 v219, 16, v20
    v_mul_f32 v216, v216, v15
    v_add_f32 v214, v214, v38
    v_mfma_f32_16x16x32_bf16 v[48:51], v[64:67], a[160:163], v[48:51]
    v_mul_f32 v217, v217, v15
    v_mul_f32 v218, v218, v15
    v_add_f32 v215, v215, v39
    v_mfma_f32_16x16x32_bf16 v[52:55], v[64:67], a[128:131], v[52:55]
    v_mul_f32 v219, v219, v15
    v_cvt_pk_bf16_f32 v216, 0, v216
    v_cvt_pk_bf16_f32 v212, v212, v213
    v_mfma_f32_16x16x32_bf16 v[56:59], v[64:67], a[96:99], v[56:59]
    v_cvt_pk_bf16_f32 v217, 0, v217
    v_cvt_pk_bf16_f32 v218, 0, v218
    v_cvt_pk_bf16_f32 v213, v214, v215
    v_mfma_f32_16x16x32_bf16 v[60:63], v[64:67], a[64:67], v[60:63]
    ds_read_b128 v[64:67], v5 offset:2496
    ds_write_b64 v9, v[212:213] offset:2304
    v_mfma_f32_16x16x32_bf16 v[40:43], v[68:71], a[228:231], v[40:43]
    buffer_load_dwordx4 a[0:3], v244, s[96:99], 0 offen nt
    v_mfma_f32_16x16x32_bf16 v[44:47], v[68:71], a[196:199], v[44:47]
    v_cvt_pk_bf16_f32 v219, 0, v219
    v_mfma_f32_16x16x32_bf16 v[48:51], v[68:71], a[164:167], v[48:51]
    ds_read_b64 v[22:23], v13 offset:2048
    v_mfma_f32_16x16x32_bf16 v[52:55], v[68:71], a[132:135], v[52:55]
    v_mfma_f32_16x16x32_bf16 v[56:59], v[68:71], a[100:103], v[56:59]
    s_waitcnt lgkmcnt(1)
    s_barrier
    ds_read_b128 v[192:195], v10 offset:0
    v_mfma_f32_16x16x32_bf16 v[60:63], v[68:71], a[68:71], v[60:63]
    ds_read_b128 v[68:71], v5 offset:2432
    v_mfma_f32_16x16x32_bf16 v[40:43], v[72:75], a[232:235], v[40:43]
    v_alignbit_b32 v128, v105, v104, 16
    s_mov_b64 exec, 1
    buffer_store_dword v249, off, s[56:59], s49 sc1
    s_mov_b64 exec, -1
    v_mfma_f32_16x16x32_bf16 v[44:47], v[72:75], a[200:203], v[44:47]
    buffer_load_dwordx4 a[4:7], v244, s[96:99], 0 offen offset:128 nt
    v_mfma_f32_16x16x32_bf16 v[48:51], v[72:75], a[168:171], v[48:51]
    v_alignbit_b32 v129, v106, v105, 16
    v_mfma_f32_16x16x32_bf16 v[52:55], v[72:75], a[136:139], v[52:55]
    v_mfma_f32_16x16x32_bf16 v[56:59], v[72:75], a[104:107], v[56:59]
    v_alignbit_b32 v130, v107, v106, 16
    v_mfma_f32_16x16x32_bf16 v[60:63], v[72:75], a[72:75], v[60:63]
    ds_read_b128 v[72:75], v5 offset:2368
    v_mfma_f32_16x16x32_bf16 v[40:43], v[76:79], a[236:239], v[40:43]
    v_alignbit_b32 v131, v108, v107, 16
    s_waitcnt lgkmcnt(3)
    s_waitcnt lgkmcnt(2)
    s_add_u32 s31, s30, 0
    buffer_store_dwordx4 v[192:195], v1, s[32:35], s31 offen sc1
    v_mfma_f32_16x16x32_bf16 v[44:47], v[76:79], a[204:207], v[44:47]
    buffer_load_dwordx4 a[8:11], v248, s[96:99], 0 offen nt
    v_mfma_f32_16x16x32_bf16 v[48:51], v[76:79], a[172:175], v[48:51]
    v_alignbit_b32 v132, v109, v108, 16
    v_and_b32 v220, 0xffff0000, v23
    v_mfma_f32_16x16x32_bf16 v[52:55], v[76:79], a[140:143], v[52:55]
    v_lshlrev_b32 v221, 16, v23
    v_and_b32 v222, 0xffff0000, v22
    v_mfma_f32_16x16x32_bf16 v[56:59], v[76:79], a[108:111], v[56:59]
    v_alignbit_b32 v133, v110, v109, 16
    v_lshlrev_b32 v223, 16, v22
    v_mfma_f32_16x16x32_bf16 v[60:63], v[76:79], a[76:79], v[60:63]
    ds_read_b128 v[76:79], v5 offset:2304
    v_mfma_f32_16x16x32_bf16 v[40:43], v[80:83], a[240:243], v[40:43]
    ds_write_b128 v11, v[128:131] offset:5184
    v_mul_f32 v220, v220, v15
    v_mfma_f32_16x16x32_bf16 v[44:47], v[80:83], a[208:211], v[44:47]
    buffer_load_ushort a12, v241, s[96:99], 0 offen
    v_mfma_f32_16x16x32_bf16 v[48:51], v[80:83], a[176:179], v[48:51]
    ds_write_b128 v11, v[130:133] offset:21824
    v_mul_f32 v221, v221, v15
    v_mfma_f32_16x16x32_bf16 v[52:55], v[80:83], a[144:147], v[52:55]
    v_mul_f32 v222, v222, v15
    v_mul_f32 v223, v223, v15
    v_mfma_f32_16x16x32_bf16 v[56:59], v[80:83], a[112:115], v[56:59]
    v_alignbit_b32 v136, v106, v105, 16
    v_cvt_pk_bf16_f32 v220, 0, v220
    v_mfma_f32_16x16x32_bf16 v[60:63], v[80:83], a[80:83], v[60:63]
    ds_read_b128 v[80:83], v5 offset:2240
    v_mfma_f32_16x16x32_bf16 v[40:43], v[84:87], a[244:247], v[40:43]
    v_alignbit_b32 v137, v107, v106, 16
    v_cvt_pk_bf16_f32 v221, 0, v221
    v_mfma_f32_16x16x32_bf16 v[44:47], v[84:87], a[212:215], v[44:47]
    v_cvt_pk_bf16_f32 v222, 0, v222
    v_cvt_pk_bf16_f32 v223, 0, v223
    v_mfma_f32_16x16x32_bf16 v[48:51], v[84:87], a[180:183], v[48:51]
    v_alignbit_b32 v138, v108, v107, 16
    v_mfma_f32_16x16x32_bf16 v[52:55], v[84:87], a[148:151], v[52:55]
    v_mfma_f32_16x16x32_bf16 v[56:59], v[84:87], a[116:119], v[56:59]
    v_alignbit_b32 v139, v109, v108, 16
    v_mfma_f32_16x16x32_bf16 v[60:63], v[84:87], a[84:87], v[60:63]
    ds_read_b128 v[84:87], v5 offset:2176
    v_mfma_f32_16x16x32_bf16 v[40:43], v[88:91], a[248:251], v[40:43]
    v_alignbit_b32 v140, v110, v109, 16
    v_mfma_f32_16x16x32_bf16 v[44:47], v[88:91], a[216:219], v[44:47]
    ds_read_b64 v[24:25], v13 offset:1536
    v_mfma_f32_16x16x32_bf16 v[48:51], v[88:91], a[184:187], v[48:51]
    v_alignbit_b32 v141, v111, v110, 16
    v_mfma_f32_16x16x32_bf16 v[52:55], v[88:91], a[152:155], v[52:55]
    v_mfma_f32_16x16x32_bf16 v[56:59], v[88:91], a[120:123], v[56:59]
    ds_write_b128 v11, v[136:139] offset:13504
    v_mfma_f32_16x16x32_bf16 v[60:63], v[88:91], a[88:91], v[60:63]
    ds_read_b128 v[88:91], v5 offset:2112
    v_mfma_f32_16x16x32_bf16 v[40:43], v[92:95], a[252:255], v[40:43]
    ds_write_b128 v11, v[138:141] offset:30144
    v_mfma_f32_16x16x32_bf16 v[44:47], v[92:95], a[220:223], v[44:47]
    v_mfma_f32_16x16x32_bf16 v[48:51], v[92:95], a[188:191], v[48:51]
    v_mfma_f32_16x16x32_bf16 v[52:55], v[92:95], a[156:159], v[52:55]
    v_mfma_f32_16x16x32_bf16 v[56:59], v[92:95], a[124:127], v[56:59]
    s_nop 2
    v_cvt_pk_bf16_f32 v40, 0, v40
    v_cvt_pk_bf16_f32 v41, 0, v41
    v_cvt_pk_bf16_f32 v42, 0, v42
    v_mfma_f32_16x16x32_bf16 v[60:63], v[92:95], a[92:95], v[60:63]
    ds_read_b128 v[92:95], v5 offset:2048
    v_cvt_pk_bf16_f32 v43, 0, v43
    v_mfma_f32_16x16x32_bf16 v[44:47], v[64:67], a[224:227], v[44:47]
    s_waitcnt lgkmcnt(4)
    v_and_b32 v224, 0xffff0000, v25
    v_add_f32 v216, v216, v40
    v_mfma_f32_16x16x32_bf16 v[48:51], v[64:67], a[192:195], v[48:51]
    v_lshlrev_b32 v225, 16, v25
    v_and_b32 v226, 0xffff0000, v24
    v_add_f32 v217, v217, v41
    v_mfma_f32_16x16x32_bf16 v[52:55], v[64:67], a[160:163], v[52:55]
    v_lshlrev_b32 v227, 16, v24
    v_mul_f32 v224, v224, v15
    v_add_f32 v218, v218, v42
    v_mfma_f32_16x16x32_bf16 v[56:59], v[64:67], a[128:131], v[56:59]
    v_mul_f32 v225, v225, v15
    v_mul_f32 v226, v226, v15
    v_add_f32 v219, v219, v43
    v_mfma_f32_16x16x32_bf16 v[60:63], v[64:67], a[96:99], v[60:63]
    ds_read_b128 v[64:67], v5 offset:1984
    v_cvt_pk_bf16_f32 v216, v216, v217
    v_mfma_f32_16x16x32_bf16 v[44:47], v[68:71], a[228:231], v[44:47]
    v_mul_f32 v227, v227, v15
    v_cvt_pk_bf16_f32 v224, 0, v224
    v_cvt_pk_bf16_f32 v217, v218, v219
    v_mfma_f32_16x16x32_bf16 v[48:51], v[68:71], a[196:199], v[48:51]
    v_cvt_pk_bf16_f32 v225, 0, v225
    v_cvt_pk_bf16_f32 v226, 0, v226
    ds_write_b64 v9, v[216:217] offset:4608
    v_mfma_f32_16x16x32_bf16 v[52:55], v[68:71], a[164:167], v[52:55]
    v_cvt_pk_bf16_f32 v227, 0, v227
    v_mfma_f32_16x16x32_bf16 v[56:59], v[68:71], a[132:135], v[56:59]
    ds_read_b64 v[26:27], v13 offset:1024
    v_mfma_f32_16x16x32_bf16 v[60:63], v[68:71], a[100:103], v[60:63]
    ds_read_b128 v[68:71], v5 offset:1920
    v_mfma_f32_16x16x32_bf16 v[44:47], v[72:75], a[232:235], v[44:47]
    v_mfma_f32_16x16x32_bf16 v[48:51], v[72:75], a[200:203], v[48:51]
    v_mfma_f32_16x16x32_bf16 v[52:55], v[72:75], a[168:171], v[52:55]
    v_mfma_f32_16x16x32_bf16 v[56:59], v[72:75], a[136:139], v[56:59]
    v_mfma_f32_16x16x32_bf16 v[60:63], v[72:75], a[104:107], v[60:63]
    v_alignbit_b32 v128, v97, v96, 16
    ds_read_b128 v[72:75], v5 offset:1856
    v_mfma_f32_16x16x32_bf16 v[44:47], v[76:79], a[236:239], v[44:47]
    v_mfma_f32_16x16x32_bf16 v[48:51], v[76:79], a[204:207], v[48:51]
    v_alignbit_b32 v129, v98, v97, 16
    v_mfma_f32_16x16x32_bf16 v[52:55], v[76:79], a[172:175], v[52:55]
    v_mfma_f32_16x16x32_bf16 v[56:59], v[76:79], a[140:143], v[56:59]
    v_alignbit_b32 v130, v99, v98, 16
    s_waitcnt lgkmcnt(2)
    v_mfma_f32_16x16x32_bf16 v[60:63], v[76:79], a[108:111], v[60:63]
    ds_read_b128 v[76:79], v5 offset:1792
    v_mfma_f32_16x16x32_bf16 v[44:47], v[80:83], a[240:243], v[44:47]
    v_alignbit_b32 v131, v100, v99, 16
    v_and_b32 v228, 0xffff0000, v27
    v_mfma_f32_16x16x32_bf16 v[48:51], v[80:83], a[208:211], v[48:51]
    v_lshlrev_b32 v229, 16, v27
    v_and_b32 v230, 0xffff0000, v26
    v_mfma_f32_16x16x32_bf16 v[52:55], v[80:83], a[176:179], v[52:55]
    v_alignbit_b32 v132, v101, v100, 16
    v_lshlrev_b32 v231, 16, v26
    v_mfma_f32_16x16x32_bf16 v[56:59], v[80:83], a[144:147], v[56:59]
    v_mul_f32 v228, v228, v15
    v_mul_f32 v229, v229, v15
    v_mfma_f32_16x16x32_bf16 v[60:63], v[80:83], a[112:115], v[60:63]
    v_alignbit_b32 v133, v102, v101, 16
    ds_read_b128 v[80:83], v5 offset:1728
    v_mfma_f32_16x16x32_bf16 v[44:47], v[84:87], a[244:247], v[44:47]
    v_mul_f32 v230, v230, v15
    v_mul_f32 v231, v231, v15
    v_mfma_f32_16x16x32_bf16 v[48:51], v[84:87], a[212:215], v[48:51]
    ds_write_b128 v11, v[128:131] offset:4160
    v_cvt_pk_bf16_f32 v228, 0, v228
    v_mfma_f32_16x16x32_bf16 v[52:55], v[84:87], a[180:183], v[52:55]
    v_cvt_pk_bf16_f32 v229, 0, v229
    v_cvt_pk_bf16_f32 v230, 0, v230
    v_mfma_f32_16x16x32_bf16 v[56:59], v[84:87], a[148:151], v[56:59]
    ds_write_b128 v11, v[130:133] offset:20800
    v_cvt_pk_bf16_f32 v231, 0, v231
    v_mfma_f32_16x16x32_bf16 v[60:63], v[84:87], a[116:119], v[60:63]
    ds_read_b128 v[84:87], v5 offset:1664
    v_mfma_f32_16x16x32_bf16 v[44:47], v[88:91], a[248:251], v[44:47]
    v_alignbit_b32 v136, v98, v97, 16
    v_mfma_f32_16x16x32_bf16 v[48:51], v[88:91], a[216:219], v[48:51]
    v_mfma_f32_16x16x32_bf16 v[52:55], v[88:91], a[184:187], v[52:55]
    v_alignbit_b32 v137, v99, v98, 16
    v_mfma_f32_16x16x32_bf16 v[56:59], v[88:91], a[152:155], v[56:59]
    v_mfma_f32_16x16x32_bf16 v[60:63], v[88:91], a[120:123], v[60:63]
    v_alignbit_b32 v138, v100, v99, 16
    ds_read_b128 v[88:91], v5 offset:1600
    v_mfma_f32_16x16x32_bf16 v[44:47], v[92:95], a[252:255], v[44:47]
    v_mfma_f32_16x16x32_bf16 v[48:51], v[92:95], a[220:223], v[48:51]
    v_alignbit_b32 v139, v101, v100, 16
    v_mfma_f32_16x16x32_bf16 v[52:55], v[92:95], a[188:191], v[52:55]
    ds_read_b64 v[28:29], v13 offset:512
    v_mfma_f32_16x16x32_bf16 v[56:59], v[92:95], a[156:159], v[56:59]
    v_alignbit_b32 v140, v102, v101, 16
    v_mfma_f32_16x16x32_bf16 v[60:63], v[92:95], a[124:127], v[60:63]
    ds_read_b128 v[92:95], v5 offset:1536
    v_cvt_pk_bf16_f32 v44, 0, v44
    v_mfma_f32_16x16x32_bf16 v[48:51], v[64:67], a[224:227], v[48:51]
    v_alignbit_b32 v141, v103, v102, 16
    v_cvt_pk_bf16_f32 v45, 0, v45
    v_cvt_pk_bf16_f32 v46, 0, v46
    v_mfma_f32_16x16x32_bf16 v[52:55], v[64:67], a[192:195], v[52:55]
    v_cvt_pk_bf16_f32 v47, 0, v47
    v_add_f32 v220, v220, v44
    v_add_f32 v221, v221, v45
    v_mfma_f32_16x16x32_bf16 v[56:59], v[64:67], a[160:163], v[56:59]
    ds_write_b128 v11, v[136:139] offset:12480
    v_add_f32 v222, v222, v46
    v_add_f32 v223, v223, v47
    v_mfma_f32_16x16x32_bf16 v[60:63], v[64:67], a[128:131], v[60:63]
    ds_read_b128 v[64:67], v5 offset:1472
    v_cvt_pk_bf16_f32 v220, v220, v221
    s_waitcnt lgkmcnt(11)
    v_mfma_f32_16x16x32_bf16 v[48:51], v[68:71], a[228:231], v[48:51]
    ds_write_b128 v11, v[138:141] offset:29120
    v_cvt_pk_bf16_f32 v221, v222, v223
    ds_write_b64 v9, v[220:221] offset:6912
    v_mfma_f32_16x16x32_bf16 v[52:55], v[68:71], a[196:199], v[52:55]
    v_mfma_f32_16x16x32_bf16 v[56:59], v[68:71], a[164:167], v[56:59]
    v_mfma_f32_16x16x32_bf16 v[60:63], v[68:71], a[132:135], v[60:63]
    ds_read_b128 v[68:71], v5 offset:1408
    s_waitcnt lgkmcnt(13)
    v_mfma_f32_16x16x32_bf16 v[48:51], v[72:75], a[232:235], v[48:51]
    s_waitcnt lgkmcnt(6)
    v_and_b32 v232, 0xffff0000, v29
    v_mfma_f32_16x16x32_bf16 v[52:55], v[72:75], a[200:203], v[52:55]
    v_lshlrev_b32 v233, 16, v29
    v_and_b32 v234, 0xffff0000, v28
    s_waitcnt lgkmcnt(1)
    s_barrier
    ds_read_b128 v[196:199], v10 offset:4608
    v_mfma_f32_16x16x32_bf16 v[56:59], v[72:75], a[168:171], v[56:59]
    v_lshlrev_b32 v235, 16, v28
    v_mul_f32 v232, v232, v15
    v_mfma_f32_16x16x32_bf16 v[60:63], v[72:75], a[136:139], v[60:63]
    ds_read_b128 v[72:75], v5 offset:1344
    v_mfma_f32_16x16x32_bf16 v[48:51], v[76:79], a[236:239], v[48:51]
    v_mul_f32 v233, v233, v15
    v_mul_f32 v234, v234, v15
    v_mfma_f32_16x16x32_bf16 v[52:55], v[76:79], a[204:207], v[52:55]
    v_mul_f32 v235, v235, v15
    v_cvt_pk_bf16_f32 v232, 0, v232
    v_mfma_f32_16x16x32_bf16 v[56:59], v[76:79], a[172:175], v[56:59]
    v_cvt_pk_bf16_f32 v233, 0, v233
    v_cvt_pk_bf16_f32 v234, 0, v234
    v_mfma_f32_16x16x32_bf16 v[60:63], v[76:79], a[140:143], v[60:63]
    ds_read_b128 v[76:79], v5 offset:1280
    v_mfma_f32_16x16x32_bf16 v[48:51], v[80:83], a[240:243], v[48:51]
    v_cvt_pk_bf16_f32 v235, 0, v235
    v_mfma_f32_16x16x32_bf16 v[52:55], v[80:83], a[208:211], v[52:55]
    ds_read_b64 v[30:31], v13 offset:0
    s_waitcnt lgkmcnt(3)
    s_add_u32 s31, s30, 589824
    buffer_store_dwordx4 v[196:199], v1, s[32:35], s31 offen sc1
    v_mfma_f32_16x16x32_bf16 v[56:59], v[80:83], a[176:179], v[56:59]
    v_mfma_f32_16x16x32_bf16 v[60:63], v[80:83], a[144:147], v[60:63]
    ds_read_b128 v[80:83], v5 offset:1216
    v_mfma_f32_16x16x32_bf16 v[48:51], v[84:87], a[244:247], v[48:51]
    v_mfma_f32_16x16x32_bf16 v[52:55], v[84:87], a[212:215], v[52:55]
    v_mfma_f32_16x16x32_bf16 v[56:59], v[84:87], a[180:183], v[56:59]
    v_mfma_f32_16x16x32_bf16 v[60:63], v[84:87], a[148:151], v[60:63]
    ds_read_b128 v[84:87], v5 offset:1152
    v_mfma_f32_16x16x32_bf16 v[48:51], v[88:91], a[248:251], v[48:51]
    v_mfma_f32_16x16x32_bf16 v[52:55], v[88:91], a[216:219], v[52:55]
    v_mfma_f32_16x16x32_bf16 v[56:59], v[88:91], a[184:187], v[56:59]
    v_mfma_f32_16x16x32_bf16 v[60:63], v[88:91], a[152:155], v[60:63]
    ds_read_b128 v[88:91], v5 offset:1088
    v_mfma_f32_16x16x32_bf16 v[48:51], v[92:95], a[252:255], v[48:51]
    s_waitcnt lgkmcnt(3)
    v_and_b32 v236, 0xffff0000, v31
    v_mfma_f32_16x16x32_bf16 v[52:55], v[92:95], a[220:223], v[52:55]
    v_lshlrev_b32 v237, 16, v31
    v_and_b32 v238, 0xffff0000, v30
    v_mfma_f32_16x16x32_bf16 v[56:59], v[92:95], a[188:191], v[56:59]
    v_lshlrev_b32 v239, 16, v30
    v_mul_f32 v236, v236, v15
    v_mfma_f32_16x16x32_bf16 v[60:63], v[92:95], a[156:159], v[60:63]
    ds_read_b128 v[92:95], v5 offset:1024
    v_mfma_f32_16x16x32_bf16 v[52:55], v[64:67], a[224:227], v[52:55]
    v_mul_f32 v237, v237, v15
    v_mul_f32 v238, v238, v15
    v_cvt_pk_bf16_f32 v48, 0, v48
    v_mfma_f32_16x16x32_bf16 v[56:59], v[64:67], a[192:195], v[56:59]
    v_mul_f32 v239, v239, v15
    v_cvt_pk_bf16_f32 v236, 0, v236
    v_cvt_pk_bf16_f32 v49, 0, v49
    v_mfma_f32_16x16x32_bf16 v[60:63], v[64:67], a[160:163], v[60:63]
    ds_read_b128 v[64:67], v5 offset:960
    v_cvt_pk_bf16_f32 v50, 0, v50
    v_mfma_f32_16x16x32_bf16 v[52:55], v[68:71], a[228:231], v[52:55]
    v_cvt_pk_bf16_f32 v237, 0, v237
    v_cvt_pk_bf16_f32 v238, 0, v238
    v_cvt_pk_bf16_f32 v51, 0, v51
    v_mfma_f32_16x16x32_bf16 v[56:59], v[68:71], a[196:199], v[56:59]
    v_cvt_pk_bf16_f32 v239, 0, v239
    v_add_f32 v224, v224, v48
    v_add_f32 v225, v225, v49
    v_mfma_f32_16x16x32_bf16 v[60:63], v[68:71], a[164:167], v[60:63]
    ds_read_b128 v[68:71], v5 offset:896
    v_add_f32 v226, v226, v50
    v_mfma_f32_16x16x32_bf16 v[52:55], v[72:75], a[232:235], v[52:55]
    v_add_f32 v227, v227, v51
    v_cvt_pk_bf16_f32 v224, v224, v225
    v_cvt_pk_bf16_f32 v225, v226, v227
    v_mfma_f32_16x16x32_bf16 v[56:59], v[72:75], a[200:203], v[56:59]
    ds_write_b64 v9, v[224:225] offset:9216
    v_mfma_f32_16x16x32_bf16 v[60:63], v[72:75], a[168:171], v[60:63]
    ds_read_b128 v[72:75], v5 offset:832
    v_mfma_f32_16x16x32_bf16 v[52:55], v[76:79], a[236:239], v[52:55]
    v_mfma_f32_16x16x32_bf16 v[56:59], v[76:79], a[204:207], v[56:59]
    v_mfma_f32_16x16x32_bf16 v[60:63], v[76:79], a[172:175], v[60:63]
    ds_read_b128 v[76:79], v5 offset:768
    s_waitcnt lgkmcnt(8)
    v_mfma_f32_16x16x32_bf16 v[52:55], v[80:83], a[240:243], v[52:55]
    v_mfma_f32_16x16x32_bf16 v[56:59], v[80:83], a[208:211], v[56:59]
    v_mfma_f32_16x16x32_bf16 v[60:63], v[80:83], a[176:179], v[60:63]
    ds_read_b128 v[80:83], v5 offset:704
    s_waitcnt lgkmcnt(8)
    v_mfma_f32_16x16x32_bf16 v[52:55], v[84:87], a[244:247], v[52:55]
    v_mfma_f32_16x16x32_bf16 v[56:59], v[84:87], a[212:215], v[56:59]
    v_mfma_f32_16x16x32_bf16 v[60:63], v[84:87], a[180:183], v[60:63]
    ds_read_b128 v[84:87], v5 offset:640
    s_waitcnt lgkmcnt(8)
    v_mfma_f32_16x16x32_bf16 v[52:55], v[88:91], a[248:251], v[52:55]
    v_mfma_f32_16x16x32_bf16 v[56:59], v[88:91], a[216:219], v[56:59]
    v_mfma_f32_16x16x32_bf16 v[60:63], v[88:91], a[184:187], v[60:63]
    ds_read_b128 v[88:91], v5 offset:576
    s_waitcnt lgkmcnt(8)
    v_mfma_f32_16x16x32_bf16 v[52:55], v[92:95], a[252:255], v[52:55]
    v_mfma_f32_16x16x32_bf16 v[56:59], v[92:95], a[220:223], v[56:59]
    v_mfma_f32_16x16x32_bf16 v[60:63], v[92:95], a[188:191], v[60:63]
    ds_read_b128 v[92:95], v5 offset:512
    s_waitcnt lgkmcnt(8)
    v_mfma_f32_16x16x32_bf16 v[56:59], v[64:67], a[224:227], v[56:59]
    v_mfma_f32_16x16x32_bf16 v[60:63], v[64:67], a[192:195], v[60:63]
    ds_read_b128 v[64:67], v5 offset:448
    s_nop 0
    v_cvt_pk_bf16_f32 v52, 0, v52
    s_waitcnt lgkmcnt(8)
    v_mfma_f32_16x16x32_bf16 v[56:59], v[68:71], a[228:231], v[56:59]
    v_cvt_pk_bf16_f32 v53, 0, v53
    v_cvt_pk_bf16_f32 v54, 0, v54
    v_cvt_pk_bf16_f32 v55, 0, v55
    v_mfma_f32_16x16x32_bf16 v[60:63], v[68:71], a[196:199], v[60:63]
    ds_read_b128 v[68:71], v5 offset:384
    v_add_f32 v228, v228, v52
    s_waitcnt lgkmcnt(7)
    v_mfma_f32_16x16x32_bf16 v[56:59], v[72:75], a[232:235], v[56:59]
    v_add_f32 v229, v229, v53
    v_add_f32 v230, v230, v54
    v_add_f32 v231, v231, v55
    v_mfma_f32_16x16x32_bf16 v[60:63], v[72:75], a[200:203], v[60:63]
    ds_read_b128 v[72:75], v5 offset:320
    v_cvt_pk_bf16_f32 v228, v228, v229
    s_waitcnt lgkmcnt(7)
    v_mfma_f32_16x16x32_bf16 v[56:59], v[76:79], a[236:239], v[56:59]
    v_cvt_pk_bf16_f32 v229, v230, v231
    ds_write_b64 v9, v[228:229] offset:11520
    v_mfma_f32_16x16x32_bf16 v[60:63], v[76:79], a[204:207], v[60:63]
    ds_read_b128 v[76:79], v5 offset:256
    s_waitcnt lgkmcnt(8)
    v_mfma_f32_16x16x32_bf16 v[56:59], v[80:83], a[240:243], v[56:59]
    v_mfma_f32_16x16x32_bf16 v[60:63], v[80:83], a[208:211], v[60:63]
    ds_read_b128 v[80:83], v5 offset:192
    s_waitcnt lgkmcnt(8)
    v_mfma_f32_16x16x32_bf16 v[56:59], v[84:87], a[244:247], v[56:59]
    v_mfma_f32_16x16x32_bf16 v[60:63], v[84:87], a[212:215], v[60:63]
    ds_read_b128 v[84:87], v5 offset:128
    s_waitcnt lgkmcnt(3)
    s_barrier
    ds_read_b128 v[200:203], v10 offset:9216
    v_mfma_f32_16x16x32_bf16 v[56:59], v[88:91], a[248:251], v[56:59]
    v_mfma_f32_16x16x32_bf16 v[60:63], v[88:91], a[216:219], v[60:63]
    ds_read_b128 v[88:91], v5 offset:64
    v_mfma_f32_16x16x32_bf16 v[56:59], v[92:95], a[252:255], v[56:59]
    v_mfma_f32_16x16x32_bf16 v[60:63], v[92:95], a[220:223], v[60:63]
    ds_read_b128 v[92:95], v5 offset:0
    v_mfma_f32_16x16x32_bf16 v[60:63], v[64:67], a[224:227], v[60:63]
    v_mfma_f32_16x16x32_bf16 v[60:63], v[68:71], a[228:231], v[60:63]
    v_mfma_f32_16x16x32_bf16 v[60:63], v[72:75], a[232:235], v[60:63]
    s_nop 2
    v_cvt_pk_bf16_f32 v56, 0, v56
    v_cvt_pk_bf16_f32 v57, 0, v57
    v_cvt_pk_bf16_f32 v58, 0, v58
    s_waitcnt lgkmcnt(5)
    v_mfma_f32_16x16x32_bf16 v[60:63], v[76:79], a[236:239], v[60:63]
    s_waitcnt lgkmcnt(2)
    s_add_u32 s31, s30, 1179648
    buffer_store_dwordx4 v[200:203], v1, s[32:35], s31 offen sc1
    v_cvt_pk_bf16_f32 v59, 0, v59
    v_mfma_f32_16x16x32_bf16 v[60:63], v[80:83], a[240:243], v[60:63]
    v_add_f32 v232, v232, v56
    v_add_f32 v233, v233, v57
    v_add_f32 v234, v234, v58
    v_mfma_f32_16x16x32_bf16 v[60:63], v[84:87], a[244:247], v[60:63]
    v_add_f32 v235, v235, v59
    v_cvt_pk_bf16_f32 v232, v232, v233
    v_cvt_pk_bf16_f32 v233, v234, v235
    s_waitcnt lgkmcnt(1)
    v_mfma_f32_16x16x32_bf16 v[60:63], v[88:91], a[248:251], v[60:63]
    ds_write_b64 v9, v[232:233] offset:13824
    s_waitcnt lgkmcnt(1)
    v_mfma_f32_16x16x32_bf16 v[60:63], v[92:95], a[252:255], v[60:63]
    s_nop 7
    v_cvt_pk_bf16_f32 v60, 0, v60
    v_cvt_pk_bf16_f32 v61, 0, v61
    v_cvt_pk_bf16_f32 v62, 0, v62
    v_cvt_pk_bf16_f32 v63, 0, v63
    v_add_f32 v236, v236, v60
    v_add_f32 v237, v237, v61
    v_add_f32 v238, v238, v62
    v_add_f32 v239, v239, v63
    v_cvt_pk_bf16_f32 v236, v236, v237
    v_cvt_pk_bf16_f32 v237, v238, v239
    ds_write_b64 v9, v[236:237] offset:16128
    s_waitcnt lgkmcnt(0)
    s_barrier
    ds_read_b128 v[204:207], v10 offset:13824
    s_waitcnt lgkmcnt(0)
    s_add_u32 s31, s30, 1769472
    buffer_store_dwordx4 v[204:207], v1, s[32:35], s31 offen sc1
    s_branch m_setup
m_pp0:
    s_cmp_lt_u32 s2, 252
    s_cbranch_scc1 cpf_code_starta
    s_getpc_b64 s[52:53]
cpf_code_starta_pc:
    s_sub_u32 s52, s52, cpf_code_starta_pc-code_start
    s_subb_u32 s53, s53, 0
    v_lshlrev_b32 v245, 7, v0
    v_min_u32 v246, code_end-code_start-4, v245
    global_load_dword v247, v246, s[52:53]
    v_add_u32 v245, 32768, v245
    v_min_u32 v246, code_end-code_start-4, v245
    global_load_dword v247, v246, s[52:53]
cpf_code_starta:
    s_waitcnt lgkmcnt(0)
    s_add_u32 s56, s22, 0x1a60000
    s_addc_u32 s57, s23, 0
    s_mov_b32 s58, 0x10000
    s_mov_b32 s59, 0x20000
    s_load_dword s54, s[56:57], 0
    s_mov_b32 s98, 0x240000
    s_mov_b32 s99, 0x20000
    s_and_b32 s3, s2, 4
    s_lshr_b32 s100, s2, 6
    s_add_u32 s3, s3, s100
    s_lshl_b32 s3, s3, 2
    s_and_b32 s100, s2, 3
    s_add_u32 s3, s3, s100
    s_lshl_b32 s3, s3, 3
    s_bfe_u32 s100, s2, 0x30003
    s_add_u32 s3, s3, s100
    s_mul_i32 s3, s3, 9216
    v_and_b32 v241, 7, v0
    v_mul_u32_u24 v241, 1152, v241
    v_add_u32 v241, s3, v241
    s_mul_i32 s100, s24, 384
    v_bfe_u32 v244, v0, 3, 3
    v_lshl_add_u32 v244, v244, 4, v241
    s_cmp_ge_u32 s24, 2
    s_cselect_b32 s3, 128, 0
    s_cselect_b32 s101, 0, 0x100
    s_add_u32 s3, s3, s100
    s_add_u32 s101, s101, s100
    v_add_u32 v248, s101, v244
    v_add_u32 v244, s3, v244
    buffer_load_dwordx4 a[0:3], v244, s[96:99], 0 offen nt
    buffer_load_dwordx4 a[4:7], v244, s[96:99], 0 offen offset:128 nt
    buffer_load_dwordx4 a[8:11], v248, s[96:99], 0 offen nt
    buffer_load_ushort a12, v241, s[96:99], 0 offen
    s_sub_u32 s3, s2, 144
    s_cmp_ge_u32 s3, 108
    s_cbranch_scc1 m_idle
    s_load_dwordx4 s[16:19], s[0:1], 56
    s_load_dwordx2 s[20:21], s[0:1], 72
    v_and_b32 v2, 63, v0
    s_lshl_b32 s25, s3, 2
    s_add_u32 s25, s25, s24
    s_mov_b32 s10, 0x510000
    s_mov_b32 s11, 0x20000
    s_cmp_ge_u32 s25, 432
    s_cbranch_scc1 pp_pp_wd
    s_cmp_ge_u32 s25, 216
    s_cselect_b32 s26, 1, 0
    s_cselect_b32 s27, 216, 0
    s_sub_u32 s25, s25, s27
    s_mul_hi_u32 s27, s25, 0x38e38e4
    s_mul_i32 s28, s27, 72
    s_sub_u32 s28, s25, s28
    s_mov_b32 s29, 9216
    s_mul_i32 s30, s27, 1769472
    s_waitcnt lgkmcnt(0)
    s_cmp_eq_u32 s26, 1
    s_cselect_b32 s8, s18, s16
    s_cselect_b32 s9, s19, s17
    s_branch pp_pp_go
pp_pp_wd:
    s_sub_u32 s25, s25, 432
    s_mul_hi_u32 s27, s25, 0x1c71c71d
    s_mul_i32 s28, s27, 9
    s_sub_u32 s28, s25, s28
    s_mov_b32 s26, 2
    s_mov_b32 s29, 1152
    s_mul_i32 s30, s27, 221184
    s_waitcnt lgkmcnt(0)
    s_mov_b32 s8, s20
    s_mov_b32 s9, s21
pp_pp_go:
    s_lshl_b32 s31, s28, 7
    s_add_u32 s30, s30, s31
    v_lshrrev_b32 v3, 3, v2
    v_mul_lo_u32 v3, v3, s29
    v_and_b32 v4, 7, v2
    v_lshl_add_u32 v3, v4, 4, v3
    s_mul_i32 s45, s24, 24576
    s_lshl_b32 s46, s29, 3
    s_sub_u32 s30, s30, s46
    s_add_u32 m0, s45, 0
    s_add_u32 s30, s30, s46
    buffer_load_dwordx4 v3, s[8:11], s30 offen nt lds
    s_add_u32 m0, s45, 1024
    s_add_u32 s30, s30, s46
    buffer_load_dwordx4 v3, s[8:11], s30 offen nt lds
    s_add_u32 m0, s45, 2048
    s_add_u32 s30, s30, s46
    buffer_load_dwordx4 v3, s[8:11], s30 offen nt lds
    s_add_u32 m0, s45, 3072
    s_add_u32 s30, s30, s46
    buffer_load_dwordx4 v3, s[8:11], s30 offen nt lds
    s_add_u32 m0, s45, 4096
    s_add_u32 s30, s30, s46
    buffer_load_dwordx4 v3, s[8:11], s30 offen nt lds
    s_add_u32 m0, s45, 5120
    s_add_u32 s30, s30, s46
    buffer_load_dwordx4 v3, s[8:11], s30 offen nt lds
    s_add_u32 m0, s45, 6144
    s_add_u32 s30, s30, s46
    buffer_load_dwordx4 v3, s[8:11], s30 offen nt lds
    s_add_u32 m0, s45, 7168
    s_add_u32 s30, s30, s46
    buffer_load_dwordx4 v3, s[8:11], s30 offen nt lds
    s_add_u32 m0, s45, 8192
    s_add_u32 s30, s30, s46
    buffer_load_dwordx4 v3, s[8:11], s30 offen nt lds
    s_add_u32 m0, s45, 9216
    s_add_u32 s30, s30, s46
    buffer_load_dwordx4 v3, s[8:11], s30 offen nt lds
    s_add_u32 m0, s45, 10240
    s_add_u32 s30, s30, s46
    buffer_load_dwordx4 v3, s[8:11], s30 offen nt lds
    s_add_u32 m0, s45, 11264
    s_add_u32 s30, s30, s46
    buffer_load_dwordx4 v3, s[8:11], s30 offen nt lds
    s_add_u32 m0, s45, 12288
    s_add_u32 s30, s30, s46
    buffer_load_dwordx4 v3, s[8:11], s30 offen nt lds
    s_add_u32 m0, s45, 13312
    s_add_u32 s30, s30, s46
    buffer_load_dwordx4 v3, s[8:11], s30 offen nt lds
    s_add_u32 m0, s45, 14336
    s_add_u32 s30, s30, s46
    buffer_load_dwordx4 v3, s[8:11], s30 offen nt lds
    s_add_u32 m0, s45, 15360
    s_add_u32 s30, s30, s46
    buffer_load_dwordx4 v3, s[8:11], s30 offen nt lds
    s_mov_b32 s12, s22
    s_mov_b32 s13, s23
    s_mov_b32 s14, 0xf30000
    s_mov_b32 s15, 0x20000
    s_lshl_b32 s32, s28, 1
    s_add_u32 s32, s32, 0
    s_mul_hi_u32 s33, s32, 0x1c71c71d
    s_mul_i32 s34, s33, 9
    s_sub_u32 s34, s32, s34
    s_lshl_b32 s33, s33, 1
    s_cmp_gt_u32 s34, 4
    s_addc_u32 s33, s33, 0
    s_cmp_gt_u32 s34, 4
    s_cselect_b32 s35, 5, 0
    s_sub_u32 s35, s34, s35
    s_lshl_b32 s35, s35, 1
    s_min_u32 s34, s35, 8
    s_mul_i32 s33, s33, 324
    s_cmp_lt_u32 s34, 3
    s_cselect_b32 s35, 2, 36
    s_cselect_b32 s40, 6, 2
    s_mul_i32 s35, s35, s34
    s_cmp_eq_u32 s34, 8
    s_cselect_b32 s35, 254, s35
    s_cmp_ge_u32 s34, 7
    s_cselect_b32 s40, 4, s40
    s_add_u32 s35, s35, s26
    s_cmp_eq_u32 s26, 2
    s_cselect_b32 s35, s34, s35
    s_cselect_b32 s40, 1, s40
    s_add_u32 s36, s33, s35
    s_lshl_b32 s32, s28, 1
    s_add_u32 s32, s32, 0
    s_mul_hi_u32 s33, s32, 0x1c71c71d
    s_mul_i32 s34, s33, 9
    s_sub_u32 s34, s32, s34
    s_lshl_b32 s33, s33, 1
    s_cmp_gt_u32 s34, 3
    s_addc_u32 s33, s33, 0
    s_cmp_gt_u32 s34, 4
    s_cselect_b32 s35, 5, 0
    s_sub_u32 s35, s34, s35
    s_lshl_b32 s35, s35, 1
    s_add_u32 s35, s35, 1
    s_min_u32 s34, s35, 8
    s_mul_i32 s33, s33, 324
    s_cmp_lt_u32 s34, 3
    s_cselect_b32 s35, 2, 36
    s_cselect_b32 s41, 6, 2
    s_mul_i32 s35, s35, s34
    s_cmp_eq_u32 s34, 8
    s_cselect_b32 s35, 254, s35
    s_cmp_ge_u32 s34, 7
    s_cselect_b32 s41, 4, s41
    s_add_u32 s35, s35, s26
    s_cmp_eq_u32 s26, 2
    s_cselect_b32 s35, s34, s35
    s_cselect_b32 s41, 1, s41
    s_add_u32 s37, s33, s35
    s_lshl_b32 s32, s28, 1
    s_add_u32 s32, s32, 1
    s_mul_hi_u32 s33, s32, 0x1c71c71d
    s_mul_i32 s34, s33, 9
    s_sub_u32 s34, s32, s34
    s_lshl_b32 s33, s33, 1
    s_cmp_gt_u32 s34, 4
    s_addc_u32 s33, s33, 0
    s_cmp_gt_u32 s34, 4
    s_cselect_b32 s35, 5, 0
    s_sub_u32 s35, s34, s35
    s_lshl_b32 s35, s35, 1
    s_min_u32 s34, s35, 8
    s_mul_i32 s33, s33, 324
    s_cmp_lt_u32 s34, 3
    s_cselect_b32 s35, 2, 36
    s_cselect_b32 s42, 6, 2
    s_mul_i32 s35, s35, s34
    s_cmp_eq_u32 s34, 8
    s_cselect_b32 s35, 254, s35
    s_cmp_ge_u32 s34, 7
    s_cselect_b32 s42, 4, s42
    s_add_u32 s35, s35, s26
    s_cmp_eq_u32 s26, 2
    s_cselect_b32 s35, s34, s35
    s_cselect_b32 s42, 1, s42
    s_add_u32 s38, s33, s35
    s_lshl_b32 s32, s28, 1
    s_add_u32 s32, s32, 1
    s_mul_hi_u32 s33, s32, 0x1c71c71d
    s_mul_i32 s34, s33, 9
    s_sub_u32 s34, s32, s34
    s_lshl_b32 s33, s33, 1
    s_cmp_gt_u32 s34, 3
    s_addc_u32 s33, s33, 0
    s_cmp_gt_u32 s34, 4
    s_cselect_b32 s35, 5, 0
    s_sub_u32 s35, s34, s35
    s_lshl_b32 s35, s35, 1
    s_add_u32 s35, s35, 1
    s_min_u32 s34, s35, 8
    s_mul_i32 s33, s33, 324
    s_cmp_lt_u32 s34, 3
    s_cselect_b32 s35, 2, 36
    s_cselect_b32 s43, 6, 2
    s_mul_i32 s35, s35, s34
    s_cmp_eq_u32 s34, 8
    s_cselect_b32 s35, 254, s35
    s_cmp_ge_u32 s34, 7
    s_cselect_b32 s43, 4, s43
    s_add_u32 s35, s35, s26
    s_cmp_eq_u32 s26, 2
    s_cselect_b32 s35, s34, s35
    s_cselect_b32 s43, 1, s43
    s_add_u32 s39, s33, s35
    s_sub_u32 s3, s2, 144
    s_lshl_b32 s3, s3, 2
    s_add_u32 s100, s3, s24
    s_mul_hi_u32 s60, s100, 0x55555556
    s_mul_i32 s61, s60, 3
    s_sub_u32 s61, s100, s61
    v_bfe_u32 v240, v0, 4, 2
    v_mul_u32_u24 v240, 1024, v240
    v_bfe_u32 v241, v0, 2, 2
    v_lshl_add_u32 v240, v241, 7, v240
    v_and_b32 v241, 3, v0
    v_lshl_add_u32 v240, v241, 4, v240
    s_mul_i32 s3, s24, 12288
    s_add_u32 s3, s3, 98304
    v_add_u32 v240, s3, v240
    s_mul_hi_u32 s100, s60, 0x1c71c71d
    s_mul_i32 s101, s100, 9
    s_sub_u32 s101, s60, s101
    s_lshl_b32 s100, s100, 1
    s_cmp_gt_u32 s101, 4
    s_addc_u32 s100, s100, 0
    s_cmp_gt_u32 s101, 4
    s_cselect_b32 s3, 5, 0
    s_sub_u32 s3, s101, s3
    s_lshl_b32 s3, s3, 1
    s_min_u32 s101, s3, 8
    s_and_b32 s3, s100, 7
    s_lshr_b32 s31, s3, 1
    s_cmp_eq_u32 s101, 8
    s_cselect_b32 s3, s31, s3
    s_lshl_b32 s101, s101, 2
    s_add_u32 s3, s3, s101
    s_mul_i32 s3, s3, 9
    s_lshr_b32 s100, s100, 3
    s_mul_i32 s100, s100, 1296
    s_add_u32 s48, s3, s100
    s_add_u32 s48, s48, 10368
    s_mul_i32 s49, s61, 6
    s_add_u32 s31, s49, 0
    s_mul_hi_u32 s100, s31, 0x1c71c71d
    s_mul_i32 s101, s100, 9
    s_sub_u32 s101, s31, s101
    s_lshl_b32 s100, s100, 1
    s_cmp_gt_u32 s101, 4
    s_addc_u32 s100, s100, 0
    s_cmp_gt_u32 s101, 4
    s_cselect_b32 s3, 5, 0
    s_sub_u32 s3, s101, s3
    s_lshl_b32 s3, s3, 1
    s_min_u32 s101, s3, 8
    s_mul_i32 s100, s100, 324
    s_add_u32 s100, s100, s101
    s_add_u32 s100, s100, s48
    s_lshl_b32 s84, s100, 10
    s_add_u32 s31, s49, 0
    s_mul_hi_u32 s100, s31, 0x1c71c71d
    s_mul_i32 s101, s100, 9
    s_sub_u32 s101, s31, s101
    s_lshl_b32 s100, s100, 1
    s_cmp_gt_u32 s101, 3
    s_addc_u32 s100, s100, 0
    s_cmp_gt_u32 s101, 4
    s_cselect_b32 s3, 5, 0
    s_sub_u32 s3, s101, s3
    s_lshl_b32 s3, s3, 1
    s_add_u32 s3, s3, 1
    s_min_u32 s101, s3, 8
    s_mul_i32 s100, s100, 324
    s_add_u32 s100, s100, s101
    s_add_u32 s100, s100, s48
    s_lshl_b32 s85, s100, 10
    s_add_u32 s31, s49, 1
    s_mul_hi_u32 s100, s31, 0x1c71c71d
    s_mul_i32 s101, s100, 9
    s_sub_u32 s101, s31, s101
    s_lshl_b32 s100, s100, 1
    s_cmp_gt_u32 s101, 4
    s_addc_u32 s100, s100, 0
    s_cmp_gt_u32 s101, 4
    s_cselect_b32 s3, 5, 0
    s_sub_u32 s3, s101, s3
    s_lshl_b32 s3, s3, 1
    s_min_u32 s101, s3, 8
    s_mul_i32 s100, s100, 324
    s_add_u32 s100, s100, s101
    s_add_u32 s100, s100, s48
    s_lshl_b32 s86, s100, 10
    s_add_u32 s31, s49, 1
    s_mul_hi_u32 s100, s31, 0x1c71c71d
    s_mul_i32 s101, s100, 9
    s_sub_u32 s101, s31, s101
    s_lshl_b32 s100, s100, 1
    s_cmp_gt_u32 s101, 3
    s_addc_u32 s100, s100, 0
    s_cmp_gt_u32 s101, 4
    s_cselect_b32 s3, 5, 0
    s_sub_u32 s3, s101, s3
    s_lshl_b32 s3, s3, 1
    s_add_u32 s3, s3, 1
    s_min_u32 s101, s3, 8
    s_mul_i32 s100, s100, 324
    s_add_u32 s100, s100, s101
    s_add_u32 s100, s100, s48
    s_lshl_b32 s87, s100, 10
    s_add_u32 s31, s49, 2
    s_mul_hi_u32 s100, s31, 0x1c71c71d
    s_mul_i32 s101, s100, 9
    s_sub_u32 s101, s31, s101
    s_lshl_b32 s100, s100, 1
    s_cmp_gt_u32 s101, 4
    s_addc_u32 s100, s100, 0
    s_cmp_gt_u32 s101, 4
    s_cselect_b32 s3, 5, 0
    s_sub_u32 s3, s101, s3
    s_lshl_b32 s3, s3, 1
    s_min_u32 s101, s3, 8
    s_mul_i32 s100, s100, 324
    s_add_u32 s100, s100, s101
    s_add_u32 s100, s100, s48
    s_lshl_b32 s88, s100, 10
    s_add_u32 s31, s49, 2
    s_mul_hi_u32 s100, s31, 0x1c71c71d
    s_mul_i32 s101, s100, 9
    s_sub_u32 s101, s31, s101
    s_lshl_b32 s100, s100, 1
    s_cmp_gt_u32 s101, 3
    s_addc_u32 s100, s100, 0
    s_cmp_gt_u32 s101, 4
    s_cselect_b32 s3, 5, 0
    s_sub_u32 s3, s101, s3
    s_lshl_b32 s3, s3, 1
    s_add_u32 s3, s3, 1
    s_min_u32 s101, s3, 8
    s_mul_i32 s100, s100, 324
    s_add_u32 s100, s100, s101
    s_add_u32 s100, s100, s48
    s_lshl_b32 s89, s100, 10
    s_add_u32 s31, s49, 3
    s_mul_hi_u32 s100, s31, 0x1c71c71d
    s_mul_i32 s101, s100, 9
    s_sub_u32 s101, s31, s101
    s_lshl_b32 s100, s100, 1
    s_cmp_gt_u32 s101, 4
    s_addc_u32 s100, s100, 0
    s_cmp_gt_u32 s101, 4
    s_cselect_b32 s3, 5, 0
    s_sub_u32 s3, s101, s3
    s_lshl_b32 s3, s3, 1
    s_min_u32 s101, s3, 8
    s_mul_i32 s100, s100, 324
    s_add_u32 s100, s100, s101
    s_add_u32 s100, s100, s48
    s_lshl_b32 s90, s100, 10
    s_add_u32 s31, s49, 3
    s_mul_hi_u32 s100, s31, 0x1c71c71d
    s_mul_i32 s101, s100, 9
    s_sub_u32 s101, s31, s101
    s_lshl_b32 s100, s100, 1
    s_cmp_gt_u32 s101, 3
    s_addc_u32 s100, s100, 0
    s_cmp_gt_u32 s101, 4
    s_cselect_b32 s3, 5, 0
    s_sub_u32 s3, s101, s3
    s_lshl_b32 s3, s3, 1
    s_add_u32 s3, s3, 1
    s_min_u32 s101, s3, 8
    s_mul_i32 s100, s100, 324
    s_add_u32 s100, s100, s101
    s_add_u32 s100, s100, s48
    s_lshl_b32 s91, s100, 10
    s_add_u32 s31, s49, 4
    s_mul_hi_u32 s100, s31, 0x1c71c71d
    s_mul_i32 s101, s100, 9
    s_sub_u32 s101, s31, s101
    s_lshl_b32 s100, s100, 1
    s_cmp_gt_u32 s101, 4
    s_addc_u32 s100, s100, 0
    s_cmp_gt_u32 s101, 4
    s_cselect_b32 s3, 5, 0
    s_sub_u32 s3, s101, s3
    s_lshl_b32 s3, s3, 1
    s_min_u32 s101, s3, 8
    s_mul_i32 s100, s100, 324
    s_add_u32 s100, s100, s101
    s_add_u32 s100, s100, s48
    s_lshl_b32 s92, s100, 10
    s_add_u32 s31, s49, 4
    s_mul_hi_u32 s100, s31, 0x1c71c71d
    s_mul_i32 s101, s100, 9
    s_sub_u32 s101, s31, s101
    s_lshl_b32 s100, s100, 1
    s_cmp_gt_u32 s101, 3
    s_addc_u32 s100, s100, 0
    s_cmp_gt_u32 s101, 4
    s_cselect_b32 s3, 5, 0
    s_sub_u32 s3, s101, s3
    s_lshl_b32 s3, s3, 1
    s_add_u32 s3, s3, 1
    s_min_u32 s101, s3, 8
    s_mul_i32 s100, s100, 324
    s_add_u32 s100, s100, s101
    s_add_u32 s100, s100, s48
    s_lshl_b32 s93, s100, 10
    s_add_u32 s31, s49, 5
    s_mul_hi_u32 s100, s31, 0x1c71c71d
    s_mul_i32 s101, s100, 9
    s_sub_u32 s101, s31, s101
    s_lshl_b32 s100, s100, 1
    s_cmp_gt_u32 s101, 4
    s_addc_u32 s100, s100, 0
    s_cmp_gt_u32 s101, 4
    s_cselect_b32 s3, 5, 0
    s_sub_u32 s3, s101, s3
    s_lshl_b32 s3, s3, 1
    s_min_u32 s101, s3, 8
    s_mul_i32 s100, s100, 324
    s_add_u32 s100, s100, s101
    s_add_u32 s100, s100, s48
    s_lshl_b32 s94, s100, 10
    s_add_u32 s31, s49, 5
    s_mul_hi_u32 s100, s31, 0x1c71c71d
    s_mul_i32 s101, s100, 9
    s_sub_u32 s101, s31, s101
    s_lshl_b32 s100, s100, 1
    s_cmp_gt_u32 s101, 3
    s_addc_u32 s100, s100, 0
    s_cmp_gt_u32 s101, 4
    s_cselect_b32 s3, 5, 0
    s_sub_u32 s3, s101, s3
    s_lshl_b32 s3, s3, 1
    s_add_u32 s3, s3, 1
    s_min_u32 s101, s3, 8
    s_mul_i32 s100, s100, 324
    s_add_u32 s100, s100, s101
    s_add_u32 s100, s100, s48
    s_lshl_b32 s95, s100, 10
    s_mov_b32 s4, s50
    s_mov_b32 s5, s51
    s_mov_b32 s6, 0x510000
    s_mov_b32 s7, 0x20000
    v_bfe_u32 v242, v0, 3, 3
    v_mul_u32_u24 v242, 1152, v242
    v_and_b32 v243, 7, v0
    v_lshl_add_u32 v242, v243, 4, v242
    s_mul_i32 s3, s61, 384
    s_mul_i32 s52, s60, 36864
    s_add_u32 s3, s3, s52
    v_add_u32 v242, s3, v242
    s_mul_i32 s52, s24, 12288
    s_add_u32 s52, s52, 98304
    v_lshrrev_b32 v4, 4, v2
    v_lshlrev_b32 v4, 10, v4
    v_bfe_u32 v5, v2, 2, 2
    v_lshl_add_u32 v4, v5, 7, v4
    v_and_b32 v5, 3, v2
    v_lshl_add_u32 v4, v5, 4, v4
    v_add_u32 v4, s45, v4
    v_lshlrev_b32 v6, 4, v2
    s_mul_i32 s32, s27, 6
    s_add_u32 s32, s32, 0
    s_mul_hi_u32 s33, s32, 0x1c71c71d
    s_mul_i32 s34, s33, 9
    s_sub_u32 s34, s32, s34
    s_lshl_b32 s33, s33, 1
    s_cmp_gt_u32 s34, 4
    s_addc_u32 s33, s33, 0
    s_cmp_gt_u32 s34, 4
    s_cselect_b32 s35, 5, 0
    s_sub_u32 s35, s34, s35
    s_lshl_b32 s35, s35, 1
    s_min_u32 s34, s35, 8
    s_and_b32 s35, s33, 7
    s_lshr_b32 s44, s35, 1
    s_cmp_eq_u32 s34, 8
    s_cselect_b32 s35, s44, s35
    s_lshl_b32 s34, s34, 2
    s_add_u32 s35, s35, s34
    s_mul_i32 s35, s35, 9
    s_lshr_b32 s33, s33, 3
    s_mul_i32 s33, s33, 1296
    s_add_u32 s35, s35, s33
    s_add_u32 s35, s35, 10368
    s_cmp_eq_u32 s26, 2
    s_cselect_b32 s48, s35, s32
    s_waitcnt vmcnt(12)
    ds_read_b64_tr_b16 v[8:9], v4 offset:0
    ds_read_b64_tr_b16 v[10:11], v4 offset:512
    ds_read_b64_tr_b16 v[12:13], v4 offset:8
    ds_read_b64_tr_b16 v[14:15], v4 offset:520
    ds_read_b64_tr_b16 v[16:17], v4 offset:64
    ds_read_b64_tr_b16 v[18:19], v4 offset:576
    ds_read_b64_tr_b16 v[20:21], v4 offset:72
    ds_read_b64_tr_b16 v[22:23], v4 offset:584
    s_mul_i32 s32, s48, s40
    s_add_u32 s32, s32, s36
    s_lshl_b32 s32, s32, 10
    s_waitcnt lgkmcnt(6)
    buffer_store_dwordx4 v[8:11], v6, s[12:15], s32 offen sc1
    s_mul_i32 s32, s48, s41
    s_add_u32 s32, s32, s37
    s_lshl_b32 s32, s32, 10
    s_waitcnt lgkmcnt(4)
    buffer_store_dwordx4 v[12:15], v6, s[12:15], s32 offen sc1
    s_mul_i32 s32, s48, s42
    s_add_u32 s32, s32, s38
    s_lshl_b32 s32, s32, 10
    s_waitcnt lgkmcnt(2)
    buffer_store_dwordx4 v[16:19], v6, s[12:15], s32 offen sc1
    s_mul_i32 s32, s48, s43
    s_add_u32 s32, s32, s39
    s_lshl_b32 s32, s32, 10
    s_waitcnt lgkmcnt(0)
    buffer_store_dwordx4 v[20:23], v6, s[12:15], s32 offen sc1
    s_add_u32 m0, s45, 16384
    s_add_u32 s30, s30, s46
    buffer_load_dwordx4 v3, s[8:11], s30 offen nt lds
    s_add_u32 m0, s45, 17408
    s_add_u32 s30, s30, s46
    buffer_load_dwordx4 v3, s[8:11], s30 offen nt lds
    s_add_u32 m0, s45, 18432
    s_add_u32 s30, s30, s46
    buffer_load_dwordx4 v3, s[8:11], s30 offen nt lds
    s_add_u32 m0, s45, 19456
    s_add_u32 s30, s30, s46
    buffer_load_dwordx4 v3, s[8:11], s30 offen nt lds
    s_mul_i32 s32, s27, 6
    s_add_u32 s32, s32, 1
    s_mul_hi_u32 s33, s32, 0x1c71c71d
    s_mul_i32 s34, s33, 9
    s_sub_u32 s34, s32, s34
    s_lshl_b32 s33, s33, 1
    s_cmp_gt_u32 s34, 4
    s_addc_u32 s33, s33, 0
    s_cmp_gt_u32 s34, 4
    s_cselect_b32 s35, 5, 0
    s_sub_u32 s35, s34, s35
    s_lshl_b32 s35, s35, 1
    s_min_u32 s34, s35, 8
    s_and_b32 s35, s33, 7
    s_lshr_b32 s44, s35, 1
    s_cmp_eq_u32 s34, 8
    s_cselect_b32 s35, s44, s35
    s_lshl_b32 s34, s34, 2
    s_add_u32 s35, s35, s34
    s_mul_i32 s35, s35, 9
    s_lshr_b32 s33, s33, 3
    s_mul_i32 s33, s33, 1296
    s_add_u32 s35, s35, s33
    s_add_u32 s35, s35, 10368
    s_cmp_eq_u32 s26, 2
    s_cselect_b32 s48, s35, s32
    s_waitcnt vmcnt(16)
    ds_read_b64_tr_b16 v[24:25], v4 offset:4096
    ds_read_b64_tr_b16 v[26:27], v4 offset:4608
    ds_read_b64_tr_b16 v[28:29], v4 offset:4104
    ds_read_b64_tr_b16 v[30:31], v4 offset:4616
    ds_read_b64_tr_b16 v[32:33], v4 offset:4160
    ds_read_b64_tr_b16 v[34:35], v4 offset:4672
    ds_read_b64_tr_b16 v[36:37], v4 offset:4168
    ds_read_b64_tr_b16 v[38:39], v4 offset:4680
    s_mul_i32 s32, s48, s40
    s_add_u32 s32, s32, s36
    s_lshl_b32 s32, s32, 10
    s_waitcnt lgkmcnt(6)
    buffer_store_dwordx4 v[24:27], v6, s[12:15], s32 offen sc1
    s_mul_i32 s32, s48, s41
    s_add_u32 s32, s32, s37
    s_lshl_b32 s32, s32, 10
    s_waitcnt lgkmcnt(4)
    buffer_store_dwordx4 v[28:31], v6, s[12:15], s32 offen sc1
    s_mul_i32 s32, s48, s42
    s_add_u32 s32, s32, s38
    s_lshl_b32 s32, s32, 10
    s_waitcnt lgkmcnt(2)
    buffer_store_dwordx4 v[32:35], v6, s[12:15], s32 offen sc1
    s_mul_i32 s32, s48, s43
    s_add_u32 s32, s32, s39
    s_lshl_b32 s32, s32, 10
    s_waitcnt lgkmcnt(0)
    buffer_store_dwordx4 v[36:39], v6, s[12:15], s32 offen sc1
    s_add_u32 m0, s45, 20480
    s_add_u32 s30, s30, s46
    buffer_load_dwordx4 v3, s[8:11], s30 offen nt lds
    s_add_u32 m0, s45, 21504
    s_add_u32 s30, s30, s46
    buffer_load_dwordx4 v3, s[8:11], s30 offen nt lds
    s_add_u32 m0, s45, 22528
    s_add_u32 s30, s30, s46
    buffer_load_dwordx4 v3, s[8:11], s30 offen nt lds
    s_add_u32 m0, s45, 23552
    s_add_u32 s30, s30, s46
    buffer_load_dwordx4 v3, s[8:11], s30 offen nt lds
    s_mul_i32 s32, s27, 6
    s_add_u32 s32, s32, 2
    s_mul_hi_u32 s33, s32, 0x1c71c71d
    s_mul_i32 s34, s33, 9
    s_sub_u32 s34, s32, s34
    s_lshl_b32 s33, s33, 1
    s_cmp_gt_u32 s34, 4
    s_addc_u32 s33, s33, 0
    s_cmp_gt_u32 s34, 4
    s_cselect_b32 s35, 5, 0
    s_sub_u32 s35, s34, s35
    s_lshl_b32 s35, s35, 1
    s_min_u32 s34, s35, 8
    s_and_b32 s35, s33, 7
    s_lshr_b32 s44, s35, 1
    s_cmp_eq_u32 s34, 8
    s_cselect_b32 s35, s44, s35
    s_lshl_b32 s34, s34, 2
    s_add_u32 s35, s35, s34
    s_mul_i32 s35, s35, 9
    s_lshr_b32 s33, s33, 3
    s_mul_i32 s33, s33, 1296
    s_add_u32 s35, s35, s33
    s_add_u32 s35, s35, 10368
    s_cmp_eq_u32 s26, 2
    s_cselect_b32 s48, s35, s32
    s_waitcnt vmcnt(20)
    ds_read_b64_tr_b16 v[40:41], v4 offset:8192
    ds_read_b64_tr_b16 v[42:43], v4 offset:8704
    ds_read_b64_tr_b16 v[44:45], v4 offset:8200
    ds_read_b64_tr_b16 v[46:47], v4 offset:8712
    ds_read_b64_tr_b16 v[48:49], v4 offset:8256
    ds_read_b64_tr_b16 v[50:51], v4 offset:8768
    ds_read_b64_tr_b16 v[52:53], v4 offset:8264
    ds_read_b64_tr_b16 v[54:55], v4 offset:8776
    s_mul_i32 s32, s48, s40
    s_add_u32 s32, s32, s36
    s_lshl_b32 s32, s32, 10
    s_waitcnt lgkmcnt(6)
    buffer_store_dwordx4 v[40:43], v6, s[12:15], s32 offen sc1
    s_mul_i32 s32, s48, s41
    s_add_u32 s32, s32, s37
    s_lshl_b32 s32, s32, 10
    s_waitcnt lgkmcnt(4)
    buffer_store_dwordx4 v[44:47], v6, s[12:15], s32 offen sc1
    s_mul_i32 s32, s48, s42
    s_add_u32 s32, s32, s38
    s_lshl_b32 s32, s32, 10
    s_waitcnt lgkmcnt(2)
    buffer_store_dwordx4 v[48:51], v6, s[12:15], s32 offen sc1
    s_mul_i32 s32, s48, s43
    s_add_u32 s32, s32, s39
    s_lshl_b32 s32, s32, 10
    s_waitcnt lgkmcnt(0)
    buffer_store_dwordx4 v[52:55], v6, s[12:15], s32 offen sc1
    s_mul_i32 s32, s27, 6
    s_add_u32 s32, s32, 3
    s_mul_hi_u32 s33, s32, 0x1c71c71d
    s_mul_i32 s34, s33, 9
    s_sub_u32 s34, s32, s34
    s_lshl_b32 s33, s33, 1
    s_cmp_gt_u32 s34, 4
    s_addc_u32 s33, s33, 0
    s_cmp_gt_u32 s34, 4
    s_cselect_b32 s35, 5, 0
    s_sub_u32 s35, s34, s35
    s_lshl_b32 s35, s35, 1
    s_min_u32 s34, s35, 8
    s_and_b32 s35, s33, 7
    s_lshr_b32 s44, s35, 1
    s_cmp_eq_u32 s34, 8
    s_cselect_b32 s35, s44, s35
    s_lshl_b32 s34, s34, 2
    s_add_u32 s35, s35, s34
    s_mul_i32 s35, s35, 9
    s_lshr_b32 s33, s33, 3
    s_mul_i32 s33, s33, 1296
    s_add_u32 s35, s35, s33
    s_add_u32 s35, s35, 10368
    s_cmp_eq_u32 s26, 2
    s_cselect_b32 s48, s35, s32
    s_waitcnt vmcnt(20)
    ds_read_b64_tr_b16 v[56:57], v4 offset:12288
    ds_read_b64_tr_b16 v[58:59], v4 offset:12800
    ds_read_b64_tr_b16 v[60:61], v4 offset:12296
    ds_read_b64_tr_b16 v[62:63], v4 offset:12808
    ds_read_b64_tr_b16 v[64:65], v4 offset:12352
    ds_read_b64_tr_b16 v[66:67], v4 offset:12864
    ds_read_b64_tr_b16 v[68:69], v4 offset:12360
    ds_read_b64_tr_b16 v[70:71], v4 offset:12872
    s_mul_i32 s32, s48, s40
    s_add_u32 s32, s32, s36
    s_lshl_b32 s32, s32, 10
    s_waitcnt lgkmcnt(6)
    buffer_store_dwordx4 v[56:59], v6, s[12:15], s32 offen sc1
    s_mul_i32 s32, s48, s41
    s_add_u32 s32, s32, s37
    s_lshl_b32 s32, s32, 10
    s_waitcnt lgkmcnt(4)
    buffer_store_dwordx4 v[60:63], v6, s[12:15], s32 offen sc1
    s_mul_i32 s32, s48, s42
    s_add_u32 s32, s32, s38
    s_lshl_b32 s32, s32, 10
    s_waitcnt lgkmcnt(2)
    buffer_store_dwordx4 v[64:67], v6, s[12:15], s32 offen sc1
    s_mul_i32 s32, s48, s43
    s_add_u32 s32, s32, s39
    s_lshl_b32 s32, s32, 10
    s_waitcnt lgkmcnt(0)
    buffer_store_dwordx4 v[68:71], v6, s[12:15], s32 offen sc1
    s_mul_i32 s32, s27, 6
    s_add_u32 s32, s32, 4
    s_mul_hi_u32 s33, s32, 0x1c71c71d
    s_mul_i32 s34, s33, 9
    s_sub_u32 s34, s32, s34
    s_lshl_b32 s33, s33, 1
    s_cmp_gt_u32 s34, 4
    s_addc_u32 s33, s33, 0
    s_cmp_gt_u32 s34, 4
    s_cselect_b32 s35, 5, 0
    s_sub_u32 s35, s34, s35
    s_lshl_b32 s35, s35, 1
    s_min_u32 s34, s35, 8
    s_and_b32 s35, s33, 7
    s_lshr_b32 s44, s35, 1
    s_cmp_eq_u32 s34, 8
    s_cselect_b32 s35, s44, s35
    s_lshl_b32 s34, s34, 2
    s_add_u32 s35, s35, s34
    s_mul_i32 s35, s35, 9
    s_lshr_b32 s33, s33, 3
    s_mul_i32 s33, s33, 1296
    s_add_u32 s35, s35, s33
    s_add_u32 s35, s35, 10368
    s_cmp_eq_u32 s26, 2
    s_cselect_b32 s48, s35, s32
    s_waitcnt vmcnt(16)
    ds_read_b64_tr_b16 v[72:73], v4 offset:16384
    ds_read_b64_tr_b16 v[74:75], v4 offset:16896
    ds_read_b64_tr_b16 v[76:77], v4 offset:16392
    ds_read_b64_tr_b16 v[78:79], v4 offset:16904
    ds_read_b64_tr_b16 v[80:81], v4 offset:16448
    ds_read_b64_tr_b16 v[82:83], v4 offset:16960
    ds_read_b64_tr_b16 v[84:85], v4 offset:16456
    ds_read_b64_tr_b16 v[86:87], v4 offset:16968
    s_mul_i32 s32, s48, s40
    s_add_u32 s32, s32, s36
    s_lshl_b32 s32, s32, 10
    s_waitcnt lgkmcnt(6)
    buffer_store_dwordx4 v[72:75], v6, s[12:15], s32 offen sc1
    s_mul_i32 s32, s48, s41
    s_add_u32 s32, s32, s37
    s_lshl_b32 s32, s32, 10
    s_waitcnt lgkmcnt(4)
    buffer_store_dwordx4 v[76:79], v6, s[12:15], s32 offen sc1
    s_mul_i32 s32, s48, s42
    s_add_u32 s32, s32, s38
    s_lshl_b32 s32, s32, 10
    s_waitcnt lgkmcnt(2)
    buffer_store_dwordx4 v[80:83], v6, s[12:15], s32 offen sc1
    s_mul_i32 s32, s48, s43
    s_add_u32 s32, s32, s39
    s_lshl_b32 s32, s32, 10
    s_waitcnt lgkmcnt(0)
    buffer_store_dwordx4 v[84:87], v6, s[12:15], s32 offen sc1
    s_mul_i32 s32, s27, 6
    s_add_u32 s32, s32, 5
    s_mul_hi_u32 s33, s32, 0x1c71c71d
    s_mul_i32 s34, s33, 9
    s_sub_u32 s34, s32, s34
    s_lshl_b32 s33, s33, 1
    s_cmp_gt_u32 s34, 4
    s_addc_u32 s33, s33, 0
    s_cmp_gt_u32 s34, 4
    s_cselect_b32 s35, 5, 0
    s_sub_u32 s35, s34, s35
    s_lshl_b32 s35, s35, 1
    s_min_u32 s34, s35, 8
    s_and_b32 s35, s33, 7
    s_lshr_b32 s44, s35, 1
    s_cmp_eq_u32 s34, 8
    s_cselect_b32 s35, s44, s35
    s_lshl_b32 s34, s34, 2
    s_add_u32 s35, s35, s34
    s_mul_i32 s35, s35, 9
    s_lshr_b32 s33, s33, 3
    s_mul_i32 s33, s33, 1296
    s_add_u32 s35, s35, s33
    s_add_u32 s35, s35, 10368
    s_cmp_eq_u32 s26, 2
    s_cselect_b32 s48, s35, s32
    s_waitcnt vmcnt(12)
    ds_read_b64_tr_b16 v[88:89], v4 offset:20480
    ds_read_b64_tr_b16 v[90:91], v4 offset:20992
    ds_read_b64_tr_b16 v[92:93], v4 offset:20488
    ds_read_b64_tr_b16 v[94:95], v4 offset:21000
    ds_read_b64_tr_b16 v[96:97], v4 offset:20544
    ds_read_b64_tr_b16 v[98:99], v4 offset:21056
    ds_read_b64_tr_b16 v[100:101], v4 offset:20552
    ds_read_b64_tr_b16 v[102:103], v4 offset:21064
    s_mul_i32 s32, s48, s40
    s_add_u32 s32, s32, s36
    s_lshl_b32 s32, s32, 10
    s_waitcnt lgkmcnt(6)
    buffer_store_dwordx4 v[88:91], v6, s[12:15], s32 offen sc1
    s_mul_i32 s32, s48, s41
    s_add_u32 s32, s32, s37
    s_lshl_b32 s32, s32, 10
    s_waitcnt lgkmcnt(4)
    buffer_store_dwordx4 v[92:95], v6, s[12:15], s32 offen sc1
    s_mul_i32 s32, s48, s42
    s_add_u32 s32, s32, s38
    s_lshl_b32 s32, s32, 10
    s_waitcnt lgkmcnt(2)
    buffer_store_dwordx4 v[96:99], v6, s[12:15], s32 offen sc1
    s_mul_i32 s32, s48, s43
    s_add_u32 s32, s32, s39
    s_lshl_b32 s32, s32, 10
    s_waitcnt lgkmcnt(0)
    buffer_store_dwordx4 v[100:103], v6, s[12:15], s32 offen sc1
    s_branch m_ppdone
m_idle:
    s_add_u32 s4, s22, 0x1a60000
    s_addc_u32 s5, s23, 0
    s_mov_b32 s6, 0x60000
    s_mov_b32 s7, 0x20000
    v_lshlrev_b32 v242, 7, v0
    s_and_b32 s3, s2, 3
    s_mul_i32 s3, s3, 0x18000
    buffer_load_dword v243, v242, s[4:7], s3 offen sc1
    s_add_u32 s3, s3, 0x8000
    buffer_load_dword v243, v242, s[4:7], s3 offen sc1
    s_add_u32 s3, s3, 0x8000
    buffer_load_dword v243, v242, s[4:7], s3 offen sc1
    s_add_u32 s3, s3, 0x8000
m_ppdone:
    s_waitcnt lgkmcnt(0)
    s_add_u32 s54, s54, 1
    v_mov_b32 v249, s54
    s_waitcnt vmcnt(0)
m_setup:
    v_lshlrev_b32 v250, 2, v0
    v_add_u32 v250, 160768, v250
    v_mov_b32 v251, -1
    ds_write_b32 v250, v251
    ds_write_b32 v250, v251 offset:1024
    s_waitcnt lgkmcnt(0)
    s_lshr_b32 s3, s2, 2
    s_lshl_b32 s3, s3, 7
    s_and_b32 s100, s2, 3
    s_lshl_b32 s100, s100, 2
    s_add_u32 s3, s3, s100
    s_add_u32 s3, s3, 40960
    s_cmp_lt_u32 s2, 144
    s_cselect_b32 s3, 0x100000, s3
    s_barrier
    s_cmp_lg_u32 s24, 0
    s_cbranch_scc1 sig_p2
    v_mov_b32 v250, 0
    s_mov_b64 exec, 1
    buffer_store_dword v249, v250, s[56:59], s3 offen sc1
    s_mov_b64 exec, -1
sig_p2:
    s_sub_u32 s3, s2, 144
    s_cmp_ge_u32 s3, 108
    s_cbranch_scc1 m_nowdl
    s_mov_b32 s4, s50
    s_mov_b32 s5, s51
    s_mov_b32 s6, 0x510000
    s_mov_b32 s7, 0x20000
    s_add_u32 m0, s52, 0
    s_mov_b32 s53, 0
    buffer_load_dwordx4 v242, s[4:7], s53 offen nt lds
    s_add_u32 m0, s52, 1024
    s_mov_b32 s53, 9216
    buffer_load_dwordx4 v242, s[4:7], s53 offen nt lds
    s_add_u32 m0, s52, 2048
    s_mov_b32 s53, 18432
    buffer_load_dwordx4 v242, s[4:7], s53 offen nt lds
    s_add_u32 m0, s52, 3072
    s_mov_b32 s53, 27648
    buffer_load_dwordx4 v242, s[4:7], s53 offen nt lds
    s_add_u32 m0, s52, 4096
    s_mov_b32 s53, 128
    buffer_load_dwordx4 v242, s[4:7], s53 offen nt lds
    s_add_u32 m0, s52, 5120
    s_mov_b32 s53, 9344
    buffer_load_dwordx4 v242, s[4:7], s53 offen nt lds
    s_add_u32 m0, s52, 6144
    s_mov_b32 s53, 18560
    buffer_load_dwordx4 v242, s[4:7], s53 offen nt lds
    s_add_u32 m0, s52, 7168
    s_mov_b32 s53, 27776
    buffer_load_dwordx4 v242, s[4:7], s53 offen nt lds
    s_add_u32 m0, s52, 8192
    s_mov_b32 s53, 256
    buffer_load_dwordx4 v242, s[4:7], s53 offen nt lds
    s_add_u32 m0, s52, 9216
    s_mov_b32 s53, 9472
    buffer_load_dwordx4 v242, s[4:7], s53 offen nt lds
    s_add_u32 m0, s52, 10240
    s_mov_b32 s53, 18688
    buffer_load_dwordx4 v242, s[4:7], s53 offen nt lds
    s_add_u32 m0, s52, 11264
    s_mov_b32 s53, 27904
    buffer_load_dwordx4 v242, s[4:7], s53 offen nt lds
m_nowdl:
m_setup2:
    s_load_dwordx2 s[20:21], s[0:1], 80
    v_and_b32 v2, 63, v0
    v_lshlrev_b32 v3, 4, v2
    s_and_b32 s25, s2, 3
    s_bfe_u32 s26, s2, 0x30003
    s_and_b32 s27, s2, 4
    s_lshr_b32 s28, s2, 6
    s_add_u32 s27, s27, s28
    s_lshl_b32 s31, s25, 3
    s_add_u32 s31, s31, s26
    s_lshl_b32 s100, s27, 5
    s_add_u32 s100, s100, s31
    v_and_b32 v41, 7, v2
    v_lshrrev_b32 v42, 3, v2
    s_mul_i32 s30, s24, 3
    s_cmp_ge_u32 s24, 2
    s_addc_u32 s30, s30, 0
    s_cmp_ge_u32 s24, 2
    s_cselect_b32 s32, -1, 2
    s_lshl_b32 s3, s30, 3
    v_add_u32 v42, s3, v42
    v_mul_u32_u24 v37, 1152, v41
    v_lshl_add_u32 v37, v42, 4, v37
    s_mul_i32 s99, s100, 9216
    s_lshl_b32 s3, s30, 6
    v_add_u32 v252, s3, v2
    v_lshlrev_b32 v252, 5, v252
    s_lshr_b32 s101, s100, 1
    s_mul_i32 s101, s101, 18432
    s_and_b32 s3, s100, 1
    s_lshl_b32 s3, s3, 4
    s_add_u32 s101, s101, s3
    v_add_u32 v252, s101, v252
    v_add_u32 v253, 2048, v252
    s_lshl_b32 s3, s32, 11
    v_add_u32 v254, s3, v252
    v_lshrrev_b32 v255, 0, v2
    v_lshlrev_b32 v255, 7, v255
    v_and_b32 v251, 0, v2
    v_lshl_add_u32 v255, v251, 4, v255
    v_add_u32 v255, 40960, v255
    buffer_load_dwordx4 v[88:91], v255, s[56:59], 0 offen sc1
    s_mul_i32 s29, s24, 3072
    s_mov_b32 s12, s22
    s_mov_b32 s13, s23
    s_mov_b32 s14, 0xf30000
    s_mov_b32 s15, 0x20000
    s_add_u32 s8, s22, 0x1b00000
    s_addc_u32 s9, s23, 0
    s_mov_b32 s10, 0x240000
    s_mov_b32 s11, 0x20000
    s_add_u32 s40, s22, 0x1a80000
    s_addc_u32 s41, s23, 0
    s_mov_b32 s42, 0x20000
    s_mov_b32 s43, 0x20000
    s_add_u32 s16, s22, 0x2000000
    s_addc_u32 s17, s23, 0
    s_mov_b32 s18, 0x900000
    s_mov_b32 s19, 0x20000
    s_add_u32 s36, s22, 0x3200000
    s_addc_u32 s37, s23, 0
    s_mov_b32 s38, 0x1200000
    s_mov_b32 s39, 0x20000
    v_lshlrev_b32 v36, 8, v42
    v_lshl_add_u32 v36, v41, 4, v36
    s_lshr_b32 s49, s100, 1
    s_mul_i32 s49, s49, 18432
    s_and_b32 s3, s100, 1
    s_lshl_b32 s3, s3, 7
    s_add_u32 s49, s49, s3
    v_bfe_u32 v38, v2, 4, 2
    v_lshlrev_b32 v38, 8, v38
    v_bfe_u32 v43, v2, 1, 1
    v_lshl_add_u32 v38, v43, 7, v38
    v_bfe_u32 v43, v2, 2, 2
    v_lshl_add_u32 v38, v43, 4, v38
    v_and_b32 v43, 1, v2
    v_lshl_add_u32 v38, v43, 3, v38
    s_add_u32 s3, s29, 147456
    v_add_u32 v38, s3, v38
    v_lshlrev_b32 v39, 5, v41
    v_add_u32 v39, 160768, v39
    s_lshl_b32 s97, s27, 12
    s_add_u32 s97, s97, 65536
    s_lshl_b32 s3, s24, 10
    s_add_u32 s98, s97, s3
    s_lshr_b32 s3, s31, 3
    s_lshl_b32 s3, s3, 10
    s_add_u32 s97, s97, s3
    s_and_b32 s3, s31, 7
    s_lshl_b32 s3, s3, 5
    s_add_u32 s97, s97, s3
    s_lshr_b32 s96, s100, 2
    s_lshl_b32 s96, s96, 9
    s_add_u32 s96, s96, 32768
    s_mul_i32 s31, s31, 331776
    v_and_b32 v19, 7, v2
    v_lshlrev_b32 v19, 2, v19
    v_bfe_u32 v23, v0, 2, 2
    v_lshlrev_b32 v23, 7, v23
    v_and_b32 v41, 3, v0
    v_lshl_add_u32 v23, v41, 2, v23
    s_lshl_b32 s3, s24, 3
    v_bfe_u32 v40, v0, 4, 1
    v_lshl_add_u32 v40, v40, 2, v39
    v_add_u32 v40, s3, v40
    v_lshlrev_b32 v41, 3, v19
    v_and_b32 v42, 63, v0
    v_min_u32 v42, 26, v42
    s_and_b32 s3, s2, 3
    s_mul_i32 s3, s3, 27
    s_add_u32 s3, s3, 144
    v_add_u32 v42, s3, v42
    v_lshlrev_b32 v42, 5, v42
    v_add_u32 v42, 24576, v42
    s_cmp_ge_u32 s24, 2
    s_cselect_b32 s100, -1, 2
    s_lshl_b32 s3, s100, 7
    v_add_u32 v44, s3, v37
    s_lshl_b32 s3, s100, 11
    v_add_u32 v45, s3, v36
    s_and_b32 s3, s49, 128
    v_and_b32 v46, 1023, v45
    v_add_u32 v46, s3, v46
    v_lshrrev_b32 v46, 1, v46
    v_subrev_u32 v46, s3, v46
    v_and_b32 v47, 0xfffffc00, v45
    v_add_u32 v46, v46, v47
    v_cmp_eq_u32 vcc, 4096, v47
    s_mov_b32 s3, 13312
    v_cmp_eq_u32 s[100:101], s3, v47
    s_nop 0
    s_or_b64 vcc, vcc, s[100:101]
    v_add_u32 v47, 512, v46
    v_add_u32 v43, 8, v45
    v_cndmask_b32 v46, v45, v46, vcc
    v_cndmask_b32 v47, v43, v47, vcc
    v_mov_b32 v21, v249
    v_mov_b32 v64, 160256
    v_mov_b32 v66, -1
    v_mov_b32 v67, -1
    ds_write_b64 v64, v[66:67]
    s_mov_b32 s61, 20000
    s_mov_b32 s28, 0
    s_waitcnt lgkmcnt(0)
    s_cmp_eq_u32 s24, 3
    s_cbranch_scc1 m_loop
    s_cmp_ge_u32 s2, 144
    s_cbranch_scc1 m_qok
    s_add_u32 s4, s22, 0x1800000
    s_addc_u32 s5, s23, 0
    s_mov_b32 s6, 0x240000
    s_mov_b32 s7, 0x20000
    s_mul_i32 s3, s24, 12
    s_mov_b64 s[100:101], 0xfff
    s_lshl_b64 exec, s[100:101], s3
m_pge:
    buffer_load_dwordx4 v[88:91], v255, s[56:59], 0 offen sc1
    s_waitcnt vmcnt(0)
    v_xor_b32 v88, v21, v88
    v_xor_b32 v89, v21, v89
    v_xor_b32 v90, v21, v90
    v_xor_b32 v91, v21, v91
    v_or3_b32 v88, v88, v89, v90
    v_or_b32 v88, v88, v91
    v_cmp_ne_u32 vcc, 0, v88
    s_cbranch_vccz m_pge_ok
    s_sub_i32 s55, s55, 1
    s_cmp_lt_i32 s55, 0
    s_cbranch_scc1 m_pge_ok
    s_sleep 2
    s_branch m_pge
m_pge_ok:
    s_mov_b64 exec, -1
    s_add_u32 m0, s29, 147456
    s_nop 0
    buffer_load_dwordx4 v252, s[4:7], 0 offen sc1 lds
    s_add_u32 m0, s29, 148480
    s_nop 0
    buffer_load_dwordx4 v253, s[4:7], 0 offen sc1 lds
    s_add_u32 m0, s29, 149504
    s_nop 0
    buffer_load_dwordx4 v254, s[4:7], 0 offen sc1 lds
m_qok:
    v_accvgpr_read_b32 v24, a0
    v_accvgpr_read_b32 v25, a1
    v_accvgpr_read_b32 v26, a2
    v_accvgpr_read_b32 v27, a3
    v_accvgpr_read_b32 v28, a4
    v_accvgpr_read_b32 v29, a5
    v_accvgpr_read_b32 v30, a6
    v_accvgpr_read_b32 v31, a7
    v_accvgpr_read_b32 v32, a8
    v_accvgpr_read_b32 v33, a9
    v_accvgpr_read_b32 v34, a10
    v_accvgpr_read_b32 v35, a11
    v_accvgpr_read_b32 v2, a12
    v_lshlrev_b32 v2, 16, v2
    v_lshlrev_b32 v96, 16, v24
    v_and_b32 v97, 0xffff0000, v24
    v_lshlrev_b32 v98, 16, v25
    v_and_b32 v99, 0xffff0000, v25
    v_lshlrev_b32 v100, 16, v26
    v_and_b32 v101, 0xffff0000, v26
    v_lshlrev_b32 v102, 16, v27
    v_and_b32 v103, 0xffff0000, v27
    v_lshlrev_b32 v104, 16, v28
    v_and_b32 v105, 0xffff0000, v28
    v_lshlrev_b32 v106, 16, v29
    v_and_b32 v107, 0xffff0000, v29
    v_lshlrev_b32 v108, 16, v30
    v_and_b32 v109, 0xffff0000, v30
    v_lshlrev_b32 v110, 16, v31
    v_and_b32 v111, 0xffff0000, v31
    v_lshlrev_b32 v112, 16, v32
    v_and_b32 v113, 0xffff0000, v32
    v_lshlrev_b32 v114, 16, v33
    v_and_b32 v115, 0xffff0000, v33
    v_lshlrev_b32 v116, 16, v34
    v_and_b32 v117, 0xffff0000, v34
    v_lshlrev_b32 v118, 16, v35
    v_and_b32 v119, 0xffff0000, v35
m_loop:
    s_lshl_b32 s3, s28, 2
    s_add_u32 s3, s3, 161792
    v_mov_b32 v92, s3
    v_mov_b32 v93, 1
    s_cmp_eq_u32 s24, 3
    s_cbranch_scc1 m_w3
    v_pk_add_f32 v[120:121], v[96:97], v[2:3] op_sel_hi:[1,0] neg_lo:[0,1] neg_hi:[0,1]
    v_pk_add_f32 v[122:123], v[98:99], v[2:3] op_sel_hi:[1,0] neg_lo:[0,1] neg_hi:[0,1]
    v_pk_add_f32 v[124:125], v[100:101], v[2:3] op_sel_hi:[1,0] neg_lo:[0,1] neg_hi:[0,1]
    v_pk_add_f32 v[126:127], v[102:103], v[2:3] op_sel_hi:[1,0] neg_lo:[0,1] neg_hi:[0,1]
    v_pk_add_f32 v[128:129], v[104:105], v[2:3] op_sel_hi:[1,0] neg_lo:[0,1] neg_hi:[0,1]
    v_pk_add_f32 v[130:131], v[106:107], v[2:3] op_sel_hi:[1,0] neg_lo:[0,1] neg_hi:[0,1]
    v_pk_add_f32 v[132:133], v[108:109], v[2:3] op_sel_hi:[1,0] neg_lo:[0,1] neg_hi:[0,1]
    v_pk_add_f32 v[134:135], v[110:111], v[2:3] op_sel_hi:[1,0] neg_lo:[0,1] neg_hi:[0,1]
    v_pk_add_f32 v[136:137], v[112:113], v[2:3] op_sel_hi:[1,0] neg_lo:[0,1] neg_hi:[0,1]
    v_pk_add_f32 v[138:139], v[114:115], v[2:3] op_sel_hi:[1,0] neg_lo:[0,1] neg_hi:[0,1]
    v_pk_add_f32 v[140:141], v[116:117], v[2:3] op_sel_hi:[1,0] neg_lo:[0,1] neg_hi:[0,1]
    v_pk_add_f32 v[142:143], v[118:119], v[2:3] op_sel_hi:[1,0] neg_lo:[0,1] neg_hi:[0,1]
    v_pk_add_f32 v[146:147], v[120:121], v[122:123]
    v_pk_add_f32 v[148:149], v[124:125], v[126:127]
    v_pk_mul_f32 v[150:151], v[120:121], v[120:121]
    v_pk_mul_f32 v[152:153], v[122:123], v[122:123]
    v_pk_fma_f32 v[150:151], v[124:125], v[124:125], v[150:151]
    v_pk_fma_f32 v[152:153], v[126:127], v[126:127], v[152:153]
    v_pk_add_f32 v[146:147], v[146:147], v[128:129]
    v_pk_fma_f32 v[150:151], v[128:129], v[128:129], v[150:151]
    v_pk_add_f32 v[148:149], v[148:149], v[130:131]
    v_pk_fma_f32 v[152:153], v[130:131], v[130:131], v[152:153]
    v_pk_add_f32 v[146:147], v[146:147], v[132:133]
    v_pk_fma_f32 v[150:151], v[132:133], v[132:133], v[150:151]
    v_pk_add_f32 v[148:149], v[148:149], v[134:135]
    v_pk_fma_f32 v[152:153], v[134:135], v[134:135], v[152:153]
    v_pk_add_f32 v[146:147], v[146:147], v[136:137]
    v_pk_fma_f32 v[150:151], v[136:137], v[136:137], v[150:151]
    v_pk_add_f32 v[148:149], v[148:149], v[138:139]
    v_pk_fma_f32 v[152:153], v[138:139], v[138:139], v[152:153]
    v_pk_add_f32 v[146:147], v[146:147], v[140:141]
    v_pk_fma_f32 v[150:151], v[140:141], v[140:141], v[150:151]
    v_pk_add_f32 v[148:149], v[148:149], v[142:143]
    v_pk_fma_f32 v[152:153], v[142:143], v[142:143], v[152:153]
    v_pk_add_f32 v[146:147], v[146:147], v[148:149]
    v_pk_add_f32 v[150:151], v[150:151], v[152:153]
    v_add_f32 v146, v146, v147
    v_add_f32 v150, v150, v151
    s_nop 1
    v_permlane16_swap_b32 v146, v150
    v_add_f32 v146, v146, v150
    s_nop 1
    v_add_f32_dpp v146, v146, v146 row_ror:8 row_mask:0xf bank_mask:0xf
    v_mov_b32 v150, v146
    s_nop 1
    v_permlane32_swap_b32 v146, v150
    v_add_f32 v146, v146, v150
    v_min_u32 v146, -2, v146
    s_mov_b64 exec, 0x00ff00ff
    ds_write_b32 v40, v146 offset:0
    s_mov_b64 exec, -1
m_st1:
    ds_read_b128 v[152:155], v39 offset:0
    ds_read_b64 v[156:157], v39 offset:16
    s_waitcnt lgkmcnt(0)
    v_max3_u32 v148, v152, v153, v154
    v_max3_u32 v149, v155, v156, v157
    v_pk_add_f32 v[146:147], v[152:153], v[154:155]
    v_max_u32 v148, v148, v149
    v_pk_add_f32 v[146:147], v[146:147], v[156:157]
    v_cmp_eq_u32 vcc, -1, v148
    s_cbranch_vccnz m_st1
    v_mul_f32 v146, 0x3ae38e39, v146
    v_mul_f32 v145, 0x3ae38e39, v147
    v_add_f32 v148, v146, v2
    v_fma_f32 v145, -v146, v146, v145
    v_cvt_pk_bf16_f32 v148, 0, v148
    v_max_f32 v145, 0, v145
    v_sub_f32 v144, v148, v2
    v_cvt_pk_bf16_f32 v145, 0, v145
    v_mov_b32 v2, v148
    v_add_f32 v145, 0x3727c5ac, v145
    v_cvt_pk_bf16_f32 v145, 0, v145
    v_sqrt_f32 v145, v145
    s_nop 0
    v_cvt_pk_bf16_f32 v145, 0, v145
    v_rcp_f32 v145, v145
    s_nop 0
    v_mul_f32 v144, v144, v145
    v_pk_fma_f32 v[120:121], v[120:121], v[144:145], v[144:145] op_sel:[0,1,0] op_sel_hi:[1,1,0] neg_lo:[0,0,1] neg_hi:[0,0,1]
    v_pk_fma_f32 v[122:123], v[122:123], v[144:145], v[144:145] op_sel:[0,1,0] op_sel_hi:[1,1,0] neg_lo:[0,0,1] neg_hi:[0,0,1]
    v_pk_fma_f32 v[124:125], v[124:125], v[144:145], v[144:145] op_sel:[0,1,0] op_sel_hi:[1,1,0] neg_lo:[0,0,1] neg_hi:[0,0,1]
    v_pk_fma_f32 v[126:127], v[126:127], v[144:145], v[144:145] op_sel:[0,1,0] op_sel_hi:[1,1,0] neg_lo:[0,0,1] neg_hi:[0,0,1]
    v_pk_fma_f32 v[128:129], v[128:129], v[144:145], v[144:145] op_sel:[0,1,0] op_sel_hi:[1,1,0] neg_lo:[0,0,1] neg_hi:[0,0,1]
    v_pk_fma_f32 v[130:131], v[130:131], v[144:145], v[144:145] op_sel:[0,1,0] op_sel_hi:[1,1,0] neg_lo:[0,0,1] neg_hi:[0,0,1]
    v_pk_fma_f32 v[132:133], v[132:133], v[144:145], v[144:145] op_sel:[0,1,0] op_sel_hi:[1,1,0] neg_lo:[0,0,1] neg_hi:[0,0,1]
    v_pk_fma_f32 v[134:135], v[134:135], v[144:145], v[144:145] op_sel:[0,1,0] op_sel_hi:[1,1,0] neg_lo:[0,0,1] neg_hi:[0,0,1]
    v_pk_fma_f32 v[136:137], v[136:137], v[144:145], v[144:145] op_sel:[0,1,0] op_sel_hi:[1,1,0] neg_lo:[0,0,1] neg_hi:[0,0,1]
    v_pk_fma_f32 v[138:139], v[138:139], v[144:145], v[144:145] op_sel:[0,1,0] op_sel_hi:[1,1,0] neg_lo:[0,0,1] neg_hi:[0,0,1]
    v_pk_fma_f32 v[140:141], v[140:141], v[144:145], v[144:145] op_sel:[0,1,0] op_sel_hi:[1,1,0] neg_lo:[0,0,1] neg_hi:[0,0,1]
    v_pk_fma_f32 v[142:143], v[142:143], v[144:145], v[144:145] op_sel:[0,1,0] op_sel_hi:[1,1,0] neg_lo:[0,0,1] neg_hi:[0,0,1]
    s_cmp_lg_u32 s28, 0
    s_cbranch_scc1 m_havey
m_l1done:
    s_add_u32 s4, s22, 0x1800000
    s_addc_u32 s5, s23, 0
    s_mov_b32 s6, 0x240000
    s_mov_b32 s7, 0x20000
    s_cmp_lt_u32 s2, 144
    s_cbranch_scc1 m_ywait
    s_mul_i32 s3, s24, 12
    s_mov_b64 s[100:101], 0xfff
    s_lshl_b64 exec, s[100:101], s3
m_pg:
    buffer_load_dwordx4 v[88:91], v255, s[56:59], 0 offen sc1
    s_waitcnt vmcnt(0)
    v_xor_b32 v88, v21, v88
    v_xor_b32 v89, v21, v89
    v_xor_b32 v90, v21, v90
    v_xor_b32 v91, v21, v91
    v_or3_b32 v88, v88, v89, v90
    v_or_b32 v88, v88, v91
    v_cmp_ne_u32 vcc, 0, v88
    s_cbranch_vccz m_pg_ok
    s_sub_i32 s55, s55, 1
    s_cmp_lt_i32 s55, 0
    s_cbranch_scc1 m_pg_ok
    s_sleep 2
    s_branch m_pg
m_pg_ok:
    s_mov_b64 exec, -1
    s_branch m_yfirst
m_yre:
    s_sleep 2
m_yfirst:
    s_add_u32 m0, s29, 147456
    s_nop 0
    buffer_load_dwordx4 v252, s[4:7], 0 offen sc1 lds
    s_add_u32 m0, s29, 148480
    s_nop 0
    buffer_load_dwordx4 v253, s[4:7], 0 offen sc1 lds
    s_add_u32 m0, s29, 149504
    s_nop 0
    buffer_load_dwordx4 v254, s[4:7], 0 offen sc1 lds
m_ywait:
    s_waitcnt vmcnt(0)
    ds_read_b64_tr_b16 v[160:161], v38 offset:0
    ds_read_b64_tr_b16 v[162:163], v38 offset:64
    ds_read_b64_tr_b16 v[164:165], v38 offset:1024
    ds_read_b64_tr_b16 v[166:167], v38 offset:1088
    ds_read_b64_tr_b16 v[168:169], v38 offset:2048
    ds_read_b64_tr_b16 v[170:171], v38 offset:2112
    s_waitcnt lgkmcnt(0)
    v_lshlrev_b32 v64, 16, v160
    v_and_b32 v65, 0xffff0000, v160
    v_lshlrev_b32 v66, 16, v161
    v_and_b32 v67, 0xffff0000, v161
    v_lshlrev_b32 v68, 16, v162
    v_and_b32 v69, 0xffff0000, v162
    v_lshlrev_b32 v70, 16, v163
    v_and_b32 v71, 0xffff0000, v163
    v_lshlrev_b32 v72, 16, v164
    v_and_b32 v73, 0xffff0000, v164
    v_lshlrev_b32 v74, 16, v165
    v_and_b32 v75, 0xffff0000, v165
    v_lshlrev_b32 v76, 16, v166
    v_and_b32 v77, 0xffff0000, v166
    v_lshlrev_b32 v78, 16, v167
    v_and_b32 v79, 0xffff0000, v167
    v_lshlrev_b32 v80, 16, v168
    v_and_b32 v81, 0xffff0000, v168
    v_lshlrev_b32 v82, 16, v169
    v_and_b32 v83, 0xffff0000, v169
    v_lshlrev_b32 v84, 16, v170
    v_and_b32 v85, 0xffff0000, v170
    v_lshlrev_b32 v86, 16, v171
    v_and_b32 v87, 0xffff0000, v171
    v_pk_add_f32 v[160:161], v[64:65], v[66:67]
    v_pk_add_f32 v[162:163], v[68:69], v[70:71]
    v_pk_add_f32 v[164:165], v[72:73], v[74:75]
    v_pk_add_f32 v[166:167], v[76:77], v[78:79]
    v_pk_add_f32 v[168:169], v[80:81], v[82:83]
    v_pk_add_f32 v[170:171], v[84:85], v[86:87]
    v_pk_add_f32 v[160:161], v[160:161], v[166:167]
    v_pk_add_f32 v[162:163], v[162:163], v[168:169]
    v_pk_add_f32 v[164:165], v[164:165], v[170:171]
    v_pk_add_f32 v[160:161], v[160:161], v[162:163]
    v_pk_add_f32 v[160:161], v[160:161], v[164:165]
    v_cmp_u_f32 vcc, v160, v161
    s_cbranch_vccz m_yre_ok
    s_sub_i32 s61, s61, 1
    s_cmp_gt_i32 s61, 0
    s_cbranch_scc1 m_yre
m_yre_ok:
m_havey:
    v_pk_fma_f32 v[96:97], v[120:121], v[64:65], v[96:97]
    v_pk_fma_f32 v[98:99], v[122:123], v[66:67], v[98:99]
    v_pk_fma_f32 v[100:101], v[124:125], v[68:69], v[100:101]
    v_pk_fma_f32 v[102:103], v[126:127], v[70:71], v[102:103]
    v_pk_fma_f32 v[104:105], v[128:129], v[72:73], v[104:105]
    v_pk_fma_f32 v[106:107], v[130:131], v[74:75], v[106:107]
    v_pk_fma_f32 v[108:109], v[132:133], v[76:77], v[108:109]
    v_pk_fma_f32 v[110:111], v[134:135], v[78:79], v[110:111]
    v_pk_fma_f32 v[112:113], v[136:137], v[80:81], v[112:113]
    v_pk_fma_f32 v[114:115], v[138:139], v[82:83], v[114:115]
    v_pk_fma_f32 v[116:117], v[140:141], v[84:85], v[116:117]
    v_pk_fma_f32 v[118:119], v[142:143], v[86:87], v[118:119]
    v_cvt_pk_bf16_f32 v96, 0, v96
    v_cvt_pk_bf16_f32 v97, 0, v97
    v_cvt_pk_bf16_f32 v98, 0, v98
    v_cvt_pk_bf16_f32 v99, 0, v99
    v_cvt_pk_bf16_f32 v100, 0, v100
    v_cvt_pk_bf16_f32 v101, 0, v101
    v_cvt_pk_bf16_f32 v102, 0, v102
    v_cvt_pk_bf16_f32 v103, 0, v103
    v_cvt_pk_bf16_f32 v104, 0, v104
    v_cvt_pk_bf16_f32 v105, 0, v105
    v_cvt_pk_bf16_f32 v106, 0, v106
    v_cvt_pk_bf16_f32 v107, 0, v107
    v_cvt_pk_bf16_f32 v108, 0, v108
    v_cvt_pk_bf16_f32 v109, 0, v109
    v_cvt_pk_bf16_f32 v110, 0, v110
    v_cvt_pk_bf16_f32 v111, 0, v111
    v_cvt_pk_bf16_f32 v112, 0, v112
    v_cvt_pk_bf16_f32 v113, 0, v113
    v_cvt_pk_bf16_f32 v114, 0, v114
    v_cvt_pk_bf16_f32 v115, 0, v115
    v_cvt_pk_bf16_f32 v116, 0, v116
    v_cvt_pk_bf16_f32 v117, 0, v117
    v_cvt_pk_bf16_f32 v118, 0, v118
    v_cvt_pk_bf16_f32 v119, 0, v119
    v_pk_add_f32 v[120:121], v[96:97], v[2:3] op_sel_hi:[1,0] neg_lo:[0,1] neg_hi:[0,1]
    v_pk_add_f32 v[122:123], v[98:99], v[2:3] op_sel_hi:[1,0] neg_lo:[0,1] neg_hi:[0,1]
    v_pk_add_f32 v[124:125], v[100:101], v[2:3] op_sel_hi:[1,0] neg_lo:[0,1] neg_hi:[0,1]
    v_pk_add_f32 v[126:127], v[102:103], v[2:3] op_sel_hi:[1,0] neg_lo:[0,1] neg_hi:[0,1]
    v_pk_add_f32 v[128:129], v[104:105], v[2:3] op_sel_hi:[1,0] neg_lo:[0,1] neg_hi:[0,1]
    v_pk_add_f32 v[130:131], v[106:107], v[2:3] op_sel_hi:[1,0] neg_lo:[0,1] neg_hi:[0,1]
    v_pk_add_f32 v[132:133], v[108:109], v[2:3] op_sel_hi:[1,0] neg_lo:[0,1] neg_hi:[0,1]
    v_pk_add_f32 v[134:135], v[110:111], v[2:3] op_sel_hi:[1,0] neg_lo:[0,1] neg_hi:[0,1]
    v_pk_add_f32 v[136:137], v[112:113], v[2:3] op_sel_hi:[1,0] neg_lo:[0,1] neg_hi:[0,1]
    v_pk_add_f32 v[138:139], v[114:115], v[2:3] op_sel_hi:[1,0] neg_lo:[0,1] neg_hi:[0,1]
    v_pk_add_f32 v[140:141], v[116:117], v[2:3] op_sel_hi:[1,0] neg_lo:[0,1] neg_hi:[0,1]
    v_pk_add_f32 v[142:143], v[118:119], v[2:3] op_sel_hi:[1,0] neg_lo:[0,1] neg_hi:[0,1]
    v_pk_add_f32 v[146:147], v[120:121], v[122:123]
    v_pk_add_f32 v[148:149], v[124:125], v[126:127]
    v_pk_mul_f32 v[150:151], v[120:121], v[120:121]
    v_pk_mul_f32 v[152:153], v[122:123], v[122:123]
    v_pk_fma_f32 v[150:151], v[124:125], v[124:125], v[150:151]
    v_pk_fma_f32 v[152:153], v[126:127], v[126:127], v[152:153]
    v_pk_add_f32 v[146:147], v[146:147], v[128:129]
    v_pk_fma_f32 v[150:151], v[128:129], v[128:129], v[150:151]
    v_pk_add_f32 v[148:149], v[148:149], v[130:131]
    v_pk_fma_f32 v[152:153], v[130:131], v[130:131], v[152:153]
    v_pk_add_f32 v[146:147], v[146:147], v[132:133]
    v_pk_fma_f32 v[150:151], v[132:133], v[132:133], v[150:151]
    v_pk_add_f32 v[148:149], v[148:149], v[134:135]
    v_pk_fma_f32 v[152:153], v[134:135], v[134:135], v[152:153]
    v_pk_add_f32 v[146:147], v[146:147], v[136:137]
    v_pk_fma_f32 v[150:151], v[136:137], v[136:137], v[150:151]
    v_pk_add_f32 v[148:149], v[148:149], v[138:139]
    v_pk_fma_f32 v[152:153], v[138:139], v[138:139], v[152:153]
    v_pk_add_f32 v[146:147], v[146:147], v[140:141]
    v_pk_fma_f32 v[150:151], v[140:141], v[140:141], v[150:151]
    v_pk_add_f32 v[148:149], v[148:149], v[142:143]
    v_pk_fma_f32 v[152:153], v[142:143], v[142:143], v[152:153]
    v_pk_add_f32 v[146:147], v[146:147], v[148:149]
    v_pk_add_f32 v[150:151], v[150:151], v[152:153]
    v_add_f32 v146, v146, v147
    v_add_f32 v150, v150, v151
    s_nop 1
    v_permlane16_swap_b32 v146, v150
    v_add_f32 v146, v146, v150
    s_nop 1
    v_add_f32_dpp v146, v146, v146 row_ror:8 row_mask:0xf bank_mask:0xf
    v_mov_b32 v150, v146
    s_nop 1
    v_permlane32_swap_b32 v146, v150
    v_add_f32 v146, v146, v150
    v_min_u32 v146, -2, v146
    s_mov_b64 exec, 0x00ff00ff
    ds_write_b32 v40, v146 offset:256
    s_mov_b64 exec, -1
m_st2:
    ds_read_b128 v[152:155], v39 offset:256
    ds_read_b64 v[156:157], v39 offset:272
    s_waitcnt lgkmcnt(0)
    v_max3_u32 v148, v152, v153, v154
    v_max3_u32 v149, v155, v156, v157
    v_pk_add_f32 v[146:147], v[152:153], v[154:155]
    v_max_u32 v148, v148, v149
    v_pk_add_f32 v[146:147], v[146:147], v[156:157]
    v_cmp_eq_u32 vcc, -1, v148
    s_cbranch_vccnz m_st2
    v_mul_f32 v146, 0x3ae38e39, v146
    v_mul_f32 v145, 0x3ae38e39, v147
    v_add_f32 v148, v146, v2
    v_fma_f32 v145, -v146, v146, v145
    v_cvt_pk_bf16_f32 v148, 0, v148
    v_max_f32 v145, 0, v145
    v_sub_f32 v144, v148, v2
    v_cvt_pk_bf16_f32 v145, 0, v145
    v_mov_b32 v2, v148
    v_add_f32 v145, 0x3727c5ac, v145
    v_cvt_pk_bf16_f32 v145, 0, v145
    v_sqrt_f32 v145, v145
    s_nop 0
    v_cvt_pk_bf16_f32 v145, 0, v145
    v_rcp_f32 v145, v145
    s_nop 0
    v_mul_f32 v144, v144, v145
    v_pk_fma_f32 v[120:121], v[120:121], v[144:145], v[144:145] op_sel:[0,1,0] op_sel_hi:[1,1,0] neg_lo:[0,0,1] neg_hi:[0,0,1]
    v_pk_fma_f32 v[122:123], v[122:123], v[144:145], v[144:145] op_sel:[0,1,0] op_sel_hi:[1,1,0] neg_lo:[0,0,1] neg_hi:[0,0,1]
    v_pk_fma_f32 v[124:125], v[124:125], v[144:145], v[144:145] op_sel:[0,1,0] op_sel_hi:[1,1,0] neg_lo:[0,0,1] neg_hi:[0,0,1]
    v_pk_fma_f32 v[126:127], v[126:127], v[144:145], v[144:145] op_sel:[0,1,0] op_sel_hi:[1,1,0] neg_lo:[0,0,1] neg_hi:[0,0,1]
    v_cvt_pk_bf16_f32 v176, v120, v121
    v_cvt_pk_bf16_f32 v177, v122, v123
    v_cvt_pk_bf16_f32 v178, v124, v125
    v_cvt_pk_bf16_f32 v179, v126, v127
    buffer_store_dwordx4 v[176:179], v36, s[8:11], s49 offen offset:0 sc1
    v_pk_fma_f32 v[128:129], v[128:129], v[144:145], v[144:145] op_sel:[0,1,0] op_sel_hi:[1,1,0] neg_lo:[0,0,1] neg_hi:[0,0,1]
    v_pk_fma_f32 v[130:131], v[130:131], v[144:145], v[144:145] op_sel:[0,1,0] op_sel_hi:[1,1,0] neg_lo:[0,0,1] neg_hi:[0,0,1]
    v_pk_fma_f32 v[132:133], v[132:133], v[144:145], v[144:145] op_sel:[0,1,0] op_sel_hi:[1,1,0] neg_lo:[0,0,1] neg_hi:[0,0,1]
    v_pk_fma_f32 v[134:135], v[134:135], v[144:145], v[144:145] op_sel:[0,1,0] op_sel_hi:[1,1,0] neg_lo:[0,0,1] neg_hi:[0,0,1]
    v_cvt_pk_bf16_f32 v180, v128, v129
    v_cvt_pk_bf16_f32 v181, v130, v131
    v_cvt_pk_bf16_f32 v182, v132, v133
    v_cvt_pk_bf16_f32 v183, v134, v135
    buffer_store_dwordx4 v[180:183], v36, s[8:11], s49 offen offset:2048 sc1
    v_pk_fma_f32 v[136:137], v[136:137], v[144:145], v[144:145] op_sel:[0,1,0] op_sel_hi:[1,1,0] neg_lo:[0,0,1] neg_hi:[0,0,1]
    v_pk_fma_f32 v[138:139], v[138:139], v[144:145], v[144:145] op_sel:[0,1,0] op_sel_hi:[1,1,0] neg_lo:[0,0,1] neg_hi:[0,0,1]
    v_pk_fma_f32 v[140:141], v[140:141], v[144:145], v[144:145] op_sel:[0,1,0] op_sel_hi:[1,1,0] neg_lo:[0,0,1] neg_hi:[0,0,1]
    v_pk_fma_f32 v[142:143], v[142:143], v[144:145], v[144:145] op_sel:[0,1,0] op_sel_hi:[1,1,0] neg_lo:[0,0,1] neg_hi:[0,0,1]
    v_cvt_pk_bf16_f32 v184, v136, v137
    v_cvt_pk_bf16_f32 v185, v138, v139
    v_cvt_pk_bf16_f32 v186, v140, v141
    v_cvt_pk_bf16_f32 v187, v142, v143
    buffer_store_dwordx4 v[184:187], v45, s[8:11], s49 offen offset:0 sc1
    v_cvt_pk_bf16_f32 v24, v96, v97
    v_cvt_pk_bf16_f32 v25, v98, v99
    v_cvt_pk_bf16_f32 v26, v100, v101
    v_cvt_pk_bf16_f32 v27, v102, v103
    v_cvt_pk_bf16_f32 v28, v104, v105
    v_cvt_pk_bf16_f32 v29, v106, v107
    v_cvt_pk_bf16_f32 v30, v108, v109
    v_cvt_pk_bf16_f32 v31, v110, v111
    v_cvt_pk_bf16_f32 v32, v112, v113
    v_cvt_pk_bf16_f32 v33, v114, v115
    v_cvt_pk_bf16_f32 v34, v116, v117
    v_cvt_pk_bf16_f32 v35, v118, v119
    s_waitcnt vmcnt(0)
    s_mov_b64 exec, 1
    ds_add_rtn_u32 v22, v92, v93
    s_waitcnt lgkmcnt(0)
    v_cmp_eq_u32 vcc, 1, v22
    s_cbranch_vccz m_nosig
    buffer_store_dword v21, off, s[40:43], s97 sc1
m_nosig:
    s_mov_b64 exec, -1
    s_branch m_join
m_w3:
    s_cmp_eq_u32 s28, 0
    s_cbranch_scc1 m_w3first
m_w3wait:
    s_sleep 1
    ds_read_b32 v22, v92
    s_waitcnt lgkmcnt(0)
    v_cmp_ne_u32 vcc, 2, v22
    s_cbranch_vccnz m_w3wait
    s_branch m_join
m_w3first:
m_w3after:
    s_mov_b64 exec, 0
    s_mov_b32 exec_hi, 0xfffffff0
m_pg3:
    buffer_load_dwordx4 v[64:67], v255, s[56:59], 0 offen sc1
    s_waitcnt vmcnt(0)
    v_xor_b32 v64, v21, v64
    v_xor_b32 v65, v21, v65
    v_xor_b32 v66, v21, v66
    v_xor_b32 v67, v21, v67
    v_or3_b32 v64, v64, v65, v66
    v_or_b32 v64, v64, v67
    v_cmp_ne_u32 vcc, 0, v64
    s_cbranch_vccz m_pg3_ok
    s_sub_i32 s55, s55, 1
    s_cmp_lt_i32 s55, 0
    s_cbranch_scc1 m_pg3_ok
    s_sleep 2
    s_branch m_pg3
m_pg3_ok:
    s_mov_b64 exec, -1
    s_mov_b32 s3, s31
    s_mov_b32 m0, 0
    s_nop 0
    buffer_load_dwordx4 v3, s[12:15], s3 offen offset:0 sc1 lds
    buffer_load_dwordx4 v3, s[12:15], s3 offen offset:1024 sc1 lds
    buffer_load_dwordx4 v3, s[12:15], s3 offen offset:2048 sc1 lds
    buffer_load_dwordx4 v3, s[12:15], s3 offen offset:3072 sc1 lds
    s_mov_b32 m0, 4096
    s_add_u32 s3, s3, 4096
    buffer_load_dwordx4 v3, s[12:15], s3 offen offset:0 sc1 lds
    buffer_load_dwordx4 v3, s[12:15], s3 offen offset:1024 sc1 lds
    buffer_load_dwordx4 v3, s[12:15], s3 offen offset:2048 sc1 lds
    buffer_load_dwordx4 v3, s[12:15], s3 offen offset:3072 sc1 lds
    s_mov_b32 m0, 8192
    s_add_u32 s3, s3, 4096
    buffer_load_dwordx4 v3, s[12:15], s3 offen offset:0 sc1 lds
    buffer_load_dwordx4 v3, s[12:15], s3 offen offset:1024 sc1 lds
    buffer_load_dwordx4 v3, s[12:15], s3 offen offset:2048 sc1 lds
    buffer_load_dwordx4 v3, s[12:15], s3 offen offset:3072 sc1 lds
    s_mov_b32 m0, 12288
    s_add_u32 s3, s3, 4096
    buffer_load_dwordx4 v3, s[12:15], s3 offen offset:0 sc1 lds
    buffer_load_dwordx4 v3, s[12:15], s3 offen offset:1024 sc1 lds
    buffer_load_dwordx4 v3, s[12:15], s3 offen offset:2048 sc1 lds
    buffer_load_dwordx4 v3, s[12:15], s3 offen offset:3072 sc1 lds
    s_mov_b32 m0, 16384
    s_add_u32 s3, s3, 4096
    buffer_load_dwordx4 v3, s[12:15], s3 offen offset:0 sc1 lds
    buffer_load_dwordx4 v3, s[12:15], s3 offen offset:1024 sc1 lds
    buffer_load_dwordx4 v3, s[12:15], s3 offen offset:2048 sc1 lds
    buffer_load_dwordx4 v3, s[12:15], s3 offen offset:3072 sc1 lds
    s_mov_b32 m0, 20480
    s_add_u32 s3, s3, 4096
    buffer_load_dwordx4 v3, s[12:15], s3 offen offset:0 sc1 lds
    buffer_load_dwordx4 v3, s[12:15], s3 offen offset:1024 sc1 lds
    buffer_load_dwordx4 v3, s[12:15], s3 offen offset:2048 sc1 lds
    buffer_load_dwordx4 v3, s[12:15], s3 offen offset:3072 sc1 lds
    s_mov_b32 m0, 24576
    s_add_u32 s3, s3, 4096
    buffer_load_dwordx4 v3, s[12:15], s3 offen offset:0 sc1 lds
    buffer_load_dwordx4 v3, s[12:15], s3 offen offset:1024 sc1 lds
    buffer_load_dwordx4 v3, s[12:15], s3 offen offset:2048 sc1 lds
    buffer_load_dwordx4 v3, s[12:15], s3 offen offset:3072 sc1 lds
    s_mov_b32 m0, 28672
    s_add_u32 s3, s3, 4096
    buffer_load_dwordx4 v3, s[12:15], s3 offen offset:0 sc1 lds
    buffer_load_dwordx4 v3, s[12:15], s3 offen offset:1024 sc1 lds
    buffer_load_dwordx4 v3, s[12:15], s3 offen offset:2048 sc1 lds
    buffer_load_dwordx4 v3, s[12:15], s3 offen offset:3072 sc1 lds
    s_mov_b32 m0, 32768
    s_add_u32 s3, s3, 4096
    buffer_load_dwordx4 v3, s[12:15], s3 offen offset:0 sc1 lds
    buffer_load_dwordx4 v3, s[12:15], s3 offen offset:1024 sc1 lds
    buffer_load_dwordx4 v3, s[12:15], s3 offen offset:2048 sc1 lds
    buffer_load_dwordx4 v3, s[12:15], s3 offen offset:3072 sc1 lds
    s_mov_b32 m0, 36864
    s_add_u32 s3, s3, 4096
    buffer_load_dwordx4 v3, s[12:15], s3 offen offset:0 sc1 lds
    buffer_load_dwordx4 v3, s[12:15], s3 offen offset:1024 sc1 lds
    buffer_load_dwordx4 v3, s[12:15], s3 offen offset:2048 sc1 lds
    buffer_load_dwordx4 v3, s[12:15], s3 offen offset:3072 sc1 lds
    s_mov_b32 m0, 40960
    s_add_u32 s3, s3, 4096
    buffer_load_dwordx4 v3, s[12:15], s3 offen offset:0 sc1 lds
    buffer_load_dwordx4 v3, s[12:15], s3 offen offset:1024 sc1 lds
    buffer_load_dwordx4 v3, s[12:15], s3 offen offset:2048 sc1 lds
    buffer_load_dwordx4 v3, s[12:15], s3 offen offset:3072 sc1 lds
    s_mov_b32 m0, 45056
    s_add_u32 s3, s3, 4096
    buffer_load_dwordx4 v3, s[12:15], s3 offen offset:0 sc1 lds
    buffer_load_dwordx4 v3, s[12:15], s3 offen offset:1024 sc1 lds
    buffer_load_dwordx4 v3, s[12:15], s3 offen offset:2048 sc1 lds
    buffer_load_dwordx4 v3, s[12:15], s3 offen offset:3072 sc1 lds
    s_mov_b32 m0, 49152
    s_add_u32 s3, s3, 4096
    buffer_load_dwordx4 v3, s[12:15], s3 offen offset:0 sc1 lds
    buffer_load_dwordx4 v3, s[12:15], s3 offen offset:1024 sc1 lds
    buffer_load_dwordx4 v3, s[12:15], s3 offen offset:2048 sc1 lds
    buffer_load_dwordx4 v3, s[12:15], s3 offen offset:3072 sc1 lds
    s_mov_b32 m0, 53248
    s_add_u32 s3, s3, 4096
    buffer_load_dwordx4 v3, s[12:15], s3 offen offset:0 sc1 lds
    buffer_load_dwordx4 v3, s[12:15], s3 offen offset:1024 sc1 lds
    buffer_load_dwordx4 v3, s[12:15], s3 offen offset:2048 sc1 lds
    buffer_load_dwordx4 v3, s[12:15], s3 offen offset:3072 sc1 lds
    s_mov_b32 m0, 57344
    s_add_u32 s3, s3, 4096
    buffer_load_dwordx4 v3, s[12:15], s3 offen offset:0 sc1 lds
    buffer_load_dwordx4 v3, s[12:15], s3 offen offset:1024 sc1 lds
    buffer_load_dwordx4 v3, s[12:15], s3 offen offset:2048 sc1 lds
    buffer_load_dwordx4 v3, s[12:15], s3 offen offset:3072 sc1 lds
    s_mov_b32 m0, 61440
    s_add_u32 s3, s3, 4096
    buffer_load_dwordx4 v3, s[12:15], s3 offen offset:0 sc1 lds
    buffer_load_dwordx4 v3, s[12:15], s3 offen offset:1024 sc1 lds
    buffer_load_dwordx4 v3, s[12:15], s3 offen offset:2048 sc1 lds
    buffer_load_dwordx4 v3, s[12:15], s3 offen offset:3072 sc1 lds
    s_mov_b32 m0, 65536
    s_add_u32 s3, s3, 4096
    buffer_load_dwordx4 v3, s[12:15], s3 offen offset:0 sc1 lds
    buffer_load_dwordx4 v3, s[12:15], s3 offen offset:1024 sc1 lds
    buffer_load_dwordx4 v3, s[12:15], s3 offen offset:2048 sc1 lds
    buffer_load_dwordx4 v3, s[12:15], s3 offen offset:3072 sc1 lds
    s_mov_b32 m0, 69632
    s_add_u32 s3, s3, 4096
    buffer_load_dwordx4 v3, s[12:15], s3 offen offset:0 sc1 lds
    buffer_load_dwordx4 v3, s[12:15], s3 offen offset:1024 sc1 lds
    buffer_load_dwordx4 v3, s[12:15], s3 offen offset:2048 sc1 lds
    buffer_load_dwordx4 v3, s[12:15], s3 offen offset:3072 sc1 lds
    s_branch m_w3wait
m_join:
    v_lshrrev_b32 v14, 1, v3
    v_add_u32 v1, 18432, v14
    v_add_u32 v5, 18432, v3
    v_add_u32 v11, 147456, v3
    v_add_u32 v15, 147456, v14
    v_add_u32 v6, 36864, v3
    v_add_u32 v12, 294912, v3
    v_add_u32 v16, 294912, v14
    v_add_u32 v7, 55296, v3
    v_add_u32 v13, 442368, v3
    v_add_u32 v17, 442368, v14
    s_cmp_lg_u32 s28, 0
    s_cbranch_scc1 m_nowdL
    s_cmp_ge_u32 s2, 8
    s_cbranch_scc1 cpf_m_joinb
    s_getpc_b64 s[100:101]
cpf_m_joinb_pc:
    s_sub_u32 s100, s100, cpf_m_joinb_pc-m_join
    s_subb_u32 s101, s101, 0
    v_lshlrev_b32 v245, 7, v0
    v_min_u32 v246, code_end-m_join-4, v245
    global_load_dword v247, v246, s[100:101]
cpf_m_joinb:
    s_lshl_b32 s100, s27, 2
    s_add_u32 s100, s100, s24
    s_mul_i32 s34, s100, 73728
    s_and_b32 s101, s26, 3
    s_lshl_b32 s33, s25, 2
    s_add_u32 s33, s33, s101
    s_lshl_b32 s54, s25, 7
    s_lshl_b32 s3, s101, 2
    s_add_u32 s54, s54, s3
    s_mul_i32 s33, s33, 331776
    s_add_u32 s33, s33, 10616832
    s_add_u32 s33, s33, s29
    v_add_u32 v4, 0, v3
    v_add_u32 v8, 36864, v3
    v_add_u32 v9, 73728, v3
    v_add_u32 v10, 110592, v3
    s_lshl_b32 s45, s100, 4
    s_add_u32 s45, s45, s25
    s_mul_i32 s45, s45, 36864
    s_lshl_b32 s44, s26, 9
    s_add_u32 s44, s44, s45
    s_add_u32 s44, s44, 32768
    s_lshl_b32 s3, s26, 10
    s_add_u32 s45, s45, s3
    s_lshl_b32 s100, s27, 3
    s_and_b32 s3, s26, 4
    s_add_u32 s100, s100, s3
    s_add_u32 s100, s100, s24
    s_lshl_b32 s3, s100, 9
    s_add_u32 s54, s54, s3
    s_add_u32 s54, s54, 32768
    s_lshl_b32 s46, s100, 3
    s_add_u32 s46, s46, s25
    s_mul_i32 s46, s46, 36864
    s_mul_i32 s48, s100, 36864
    s_mul_i32 s3, s25, 2359296
    s_add_u32 s48, s48, s3
    s_lshr_b32 s3, s101, 1
    s_mul_i32 s3, s3, 9216
    s_add_u32 s48, s48, s3
    s_and_b32 s3, s101, 1
    s_lshl_b32 s50, s3, 9
    s_add_u32 s50, s50, 4096
    s_add_u32 s50, s50, s48
    s_mul_i32 s3, s3, 5120
    s_add_u32 s48, s48, s3
    s_lshl_b32 s100, s27, 2
    s_add_u32 s100, s100, s25
    s_lshl_b32 s100, s100, 10
    s_lshl_b32 s52, s24, 8
    s_add_u32 s52, s52, s100
    s_lshl_b32 s3, s26, 2
    s_add_u32 s52, s52, s3
    s_lshr_b32 s53, s26, 2
    s_lshl_b32 s53, s53, 1
    s_lshr_b32 s3, s24, 1
    s_add_u32 s53, s53, s3
    s_lshl_b32 s53, s53, 8
    s_add_u32 s53, s53, s100
    s_mov_b32 s25, s29
    s_add_u32 s26, s29, 73728
    s_sub_u32 s3, s2, 144
    s_cmp_ge_u32 s3, 108
    s_cbranch_scc1 m_nowdL
    s_waitcnt vmcnt(0)
    ds_read_b64_tr_b16 a[16:17], v240 offset:0
    ds_read_b64_tr_b16 a[18:19], v240 offset:512
    ds_read_b64_tr_b16 a[20:21], v240 offset:8
    ds_read_b64_tr_b16 a[22:23], v240 offset:520
    ds_read_b64_tr_b16 a[24:25], v240 offset:64
    ds_read_b64_tr_b16 a[26:27], v240 offset:576
    ds_read_b64_tr_b16 a[28:29], v240 offset:72
    ds_read_b64_tr_b16 a[30:31], v240 offset:584
    ds_read_b64_tr_b16 a[32:33], v240 offset:4096
    ds_read_b64_tr_b16 a[34:35], v240 offset:4608
    ds_read_b64_tr_b16 a[36:37], v240 offset:4104
    ds_read_b64_tr_b16 a[38:39], v240 offset:4616
    ds_read_b64_tr_b16 a[40:41], v240 offset:4160
    ds_read_b64_tr_b16 a[42:43], v240 offset:4672
    ds_read_b64_tr_b16 a[44:45], v240 offset:4168
    ds_read_b64_tr_b16 a[46:47], v240 offset:4680
    ds_read_b64_tr_b16 a[48:49], v240 offset:8192
    ds_read_b64_tr_b16 a[50:51], v240 offset:8704
    ds_read_b64_tr_b16 a[52:53], v240 offset:8200
    ds_read_b64_tr_b16 a[54:55], v240 offset:8712
    ds_read_b64_tr_b16 a[56:57], v240 offset:8256
    ds_read_b64_tr_b16 a[58:59], v240 offset:8768
    ds_read_b64_tr_b16 a[60:61], v240 offset:8264
    ds_read_b64_tr_b16 a[62:63], v240 offset:8776
    s_waitcnt lgkmcnt(14)
    buffer_store_dwordx4 a[16:19], v3, s[12:15], s84 offen sc1
    buffer_store_dwordx4 a[20:23], v3, s[12:15], s85 offen sc1
    buffer_store_dwordx4 a[24:27], v3, s[12:15], s86 offen sc1
    buffer_store_dwordx4 a[28:31], v3, s[12:15], s87 offen sc1
    buffer_store_dwordx4 a[32:35], v3, s[12:15], s88 offen sc1
    s_waitcnt lgkmcnt(12)
    buffer_store_dwordx4 a[36:39], v3, s[12:15], s89 offen sc1
    s_waitcnt lgkmcnt(10)
    buffer_store_dwordx4 a[40:43], v3, s[12:15], s90 offen sc1
    s_waitcnt lgkmcnt(8)
    buffer_store_dwordx4 a[44:47], v3, s[12:15], s91 offen sc1
    s_waitcnt lgkmcnt(6)
    buffer_store_dwordx4 a[48:51], v3, s[12:15], s92 offen sc1
    s_waitcnt lgkmcnt(4)
    buffer_store_dwordx4 a[52:55], v3, s[12:15], s93 offen sc1
    s_waitcnt lgkmcnt(2)
    buffer_store_dwordx4 a[56:59], v3, s[12:15], s94 offen sc1
    s_waitcnt lgkmcnt(0)
    buffer_store_dwordx4 a[60:63], v3, s[12:15], s95 offen sc1
m_nowdL:
    s_add_u32 s30, s31, s29
    s_add_u32 s30, s30, 61440
    s_mov_b32 s32, s34
    s_mov_b32 s35, s45
    s_mov_b32 s47, s46
m_px:
    buffer_load_dword v22, v41, s[40:43], s98 offen sc1
    s_waitcnt vmcnt(0)
    v_cmp_ne_u32 vcc, v21, v22
    s_cbranch_vccz m_px_ok
    s_sub_i32 s55, s55, 1
    s_cmp_lt_i32 s55, 0
    s_cbranch_scc1 m_px_ok
    s_sleep 1
    s_branch m_px
m_px_ok:
    buffer_load_dwordx4 a[0:3], v3, s[8:11], s32 offen offset:0 sc1
    buffer_load_dwordx4 a[4:7], v5, s[8:11], s32 offen offset:0 sc1
    buffer_load_dwordx4 a[8:11], v6, s[8:11], s32 offen offset:0 sc1
    buffer_load_dwordx4 a[12:15], v7, s[8:11], s32 offen offset:0 sc1
    buffer_load_dwordx4 a[16:19], v3, s[8:11], s32 offen offset:1024 sc1
    buffer_load_dwordx4 a[20:23], v5, s[8:11], s32 offen offset:1024 sc1
    buffer_load_dwordx4 a[24:27], v6, s[8:11], s32 offen offset:1024 sc1
    buffer_load_dwordx4 a[28:31], v7, s[8:11], s32 offen offset:1024 sc1
    buffer_load_dwordx4 a[32:35], v3, s[8:11], s32 offen offset:2048 sc1
    buffer_load_dwordx4 a[36:39], v5, s[8:11], s32 offen offset:2048 sc1
    buffer_load_dwordx4 a[40:43], v6, s[8:11], s32 offen offset:2048 sc1
    buffer_load_dwordx4 a[44:47], v7, s[8:11], s32 offen offset:2048 sc1
    buffer_load_dwordx4 a[48:51], v3, s[8:11], s32 offen offset:3072 sc1
    buffer_load_dwordx4 a[52:55], v5, s[8:11], s32 offen offset:3072 sc1
    buffer_load_dwordx4 a[56:59], v6, s[8:11], s32 offen offset:3072 sc1
    buffer_load_dwordx4 a[60:63], v7, s[8:11], s32 offen offset:3072 sc1
    s_barrier
    s_lshl_b32 s100, s2, 5
    s_add_u32 s100, s100, 24576
    s_lshl_b32 s3, s24, 20
    s_add_u32 s100, s100, s3
    s_mov_b64 exec, 1
    buffer_store_dword v21, off, s[56:59], s100 sc1
    s_lshl_b32 s100, s2, 22
    s_add_u32 s100, s100, s3
    buffer_store_dword v21, off, s[56:59], s100 sc1
    s_mov_b64 exec, -1
    ds_read_b128 v[64:67], v4 offset:0
    ds_read_b128 v[68:71], v4 offset:1024
    ds_read_b128 v[72:75], v4 offset:2048
    ds_read_b128 v[76:79], v4 offset:3072
    ds_read_b128 v[80:83], v4 offset:4096
    ds_read_b128 v[84:87], v4 offset:5120
    ds_read_b128 v[88:91], v4 offset:6144
    ds_read_b128 v[92:95], v4 offset:7168
    s_waitcnt vmcnt(14) lgkmcnt(7)
    v_mfma_f32_16x16x32_bf16 v[96:99], v[64:67], a[0:3], 0
    s_add_u32 s32, s32, 4096
    v_mfma_f32_16x16x32_bf16 v[100:103], v[64:67], a[4:7], 0
    v_mfma_f32_16x16x32_bf16 v[104:107], v[64:67], a[8:11], 0
    v_mfma_f32_16x16x32_bf16 v[108:111], v[64:67], a[12:15], 0
    ds_read_b128 v[64:67], v4 offset:8192
    s_waitcnt lgkmcnt(7)
    v_mfma_f32_16x16x32_bf16 v[112:115], v[68:71], a[0:3], 0
    buffer_load_dwordx4 a[64:67], v3, s[8:11], s32 offen offset:0 sc1
    v_mfma_f32_16x16x32_bf16 v[116:119], v[68:71], a[4:7], 0
    v_mfma_f32_16x16x32_bf16 v[120:123], v[68:71], a[8:11], 0
    v_mfma_f32_16x16x32_bf16 v[124:127], v[68:71], a[12:15], 0
    ds_read_b128 v[68:71], v4 offset:9216
    s_waitcnt lgkmcnt(7)
    v_mfma_f32_16x16x32_bf16 v[128:131], v[72:75], a[0:3], 0
    buffer_load_dwordx4 a[68:71], v5, s[8:11], s32 offen offset:0 sc1
    v_mfma_f32_16x16x32_bf16 v[132:135], v[72:75], a[4:7], 0
    v_mfma_f32_16x16x32_bf16 v[136:139], v[72:75], a[8:11], 0
    v_mfma_f32_16x16x32_bf16 v[140:143], v[72:75], a[12:15], 0
    ds_read_b128 v[72:75], v4 offset:10240
    s_waitcnt lgkmcnt(7)
    v_mfma_f32_16x16x32_bf16 v[144:147], v[76:79], a[0:3], 0
    buffer_load_dwordx4 a[72:75], v6, s[8:11], s32 offen offset:0 sc1
    v_mfma_f32_16x16x32_bf16 v[148:151], v[76:79], a[4:7], 0
    v_mfma_f32_16x16x32_bf16 v[152:155], v[76:79], a[8:11], 0
    v_mfma_f32_16x16x32_bf16 v[156:159], v[76:79], a[12:15], 0
    ds_read_b128 v[76:79], v4 offset:11264
    s_waitcnt lgkmcnt(7)
    v_mfma_f32_16x16x32_bf16 v[160:163], v[80:83], a[0:3], 0
    buffer_load_dwordx4 a[76:79], v7, s[8:11], s32 offen offset:0 sc1
    v_mfma_f32_16x16x32_bf16 v[164:167], v[80:83], a[4:7], 0
    v_mfma_f32_16x16x32_bf16 v[168:171], v[80:83], a[8:11], 0
    v_mfma_f32_16x16x32_bf16 v[172:175], v[80:83], a[12:15], 0
    ds_read_b128 v[80:83], v4 offset:12288
    s_waitcnt lgkmcnt(7)
    v_mfma_f32_16x16x32_bf16 v[176:179], v[84:87], a[0:3], 0
    v_mfma_f32_16x16x32_bf16 v[180:183], v[84:87], a[4:7], 0
    v_mfma_f32_16x16x32_bf16 v[184:187], v[84:87], a[8:11], 0
    v_mfma_f32_16x16x32_bf16 v[188:191], v[84:87], a[12:15], 0
    ds_read_b128 v[84:87], v4 offset:13312
    s_waitcnt vmcnt(14) lgkmcnt(7)
    v_mfma_f32_16x16x32_bf16 v[96:99], v[88:91], a[16:19], v[96:99]
    buffer_load_dwordx4 a[80:83], v3, s[8:11], s32 offen offset:1024 sc1
    v_mfma_f32_16x16x32_bf16 v[100:103], v[88:91], a[20:23], v[100:103]
    v_mfma_f32_16x16x32_bf16 v[104:107], v[88:91], a[24:27], v[104:107]
    v_mfma_f32_16x16x32_bf16 v[108:111], v[88:91], a[28:31], v[108:111]
    ds_read_b128 v[88:91], v4 offset:14336
    s_waitcnt lgkmcnt(7)
    v_mfma_f32_16x16x32_bf16 v[112:115], v[92:95], a[16:19], v[112:115]
    buffer_load_dwordx4 a[84:87], v5, s[8:11], s32 offen offset:1024 sc1
    v_mfma_f32_16x16x32_bf16 v[116:119], v[92:95], a[20:23], v[116:119]
    v_mfma_f32_16x16x32_bf16 v[120:123], v[92:95], a[24:27], v[120:123]
    v_mfma_f32_16x16x32_bf16 v[124:127], v[92:95], a[28:31], v[124:127]
    ds_read_b128 v[92:95], v4 offset:15360
    s_waitcnt lgkmcnt(7)
    v_mfma_f32_16x16x32_bf16 v[128:131], v[64:67], a[16:19], v[128:131]
    buffer_load_dwordx4 a[88:91], v6, s[8:11], s32 offen offset:1024 sc1
    v_mfma_f32_16x16x32_bf16 v[132:135], v[64:67], a[20:23], v[132:135]
    v_mfma_f32_16x16x32_bf16 v[136:139], v[64:67], a[24:27], v[136:139]
    v_mfma_f32_16x16x32_bf16 v[140:143], v[64:67], a[28:31], v[140:143]
    ds_read_b128 v[64:67], v4 offset:16384
    s_waitcnt lgkmcnt(7)
    v_mfma_f32_16x16x32_bf16 v[144:147], v[68:71], a[16:19], v[144:147]
    buffer_load_dwordx4 a[92:95], v7, s[8:11], s32 offen offset:1024 sc1
    v_mfma_f32_16x16x32_bf16 v[148:151], v[68:71], a[20:23], v[148:151]
    v_mfma_f32_16x16x32_bf16 v[152:155], v[68:71], a[24:27], v[152:155]
    v_mfma_f32_16x16x32_bf16 v[156:159], v[68:71], a[28:31], v[156:159]
    ds_read_b128 v[68:71], v4 offset:17408
    s_waitcnt lgkmcnt(7)
    v_mfma_f32_16x16x32_bf16 v[160:163], v[72:75], a[16:19], v[160:163]
    v_mfma_f32_16x16x32_bf16 v[164:167], v[72:75], a[20:23], v[164:167]
    v_mfma_f32_16x16x32_bf16 v[168:171], v[72:75], a[24:27], v[168:171]
    v_mfma_f32_16x16x32_bf16 v[172:175], v[72:75], a[28:31], v[172:175]
    ds_read_b128 v[72:75], v4 offset:18432
    s_waitcnt lgkmcnt(7)
    v_mfma_f32_16x16x32_bf16 v[176:179], v[76:79], a[16:19], v[176:179]
    v_mfma_f32_16x16x32_bf16 v[180:183], v[76:79], a[20:23], v[180:183]
    v_mfma_f32_16x16x32_bf16 v[184:187], v[76:79], a[24:27], v[184:187]
    v_mfma_f32_16x16x32_bf16 v[188:191], v[76:79], a[28:31], v[188:191]
    ds_read_b128 v[76:79], v4 offset:19456
    s_waitcnt vmcnt(14) lgkmcnt(7)
    v_mfma_f32_16x16x32_bf16 v[96:99], v[80:83], a[32:35], v[96:99]
    buffer_load_dwordx4 a[96:99], v3, s[8:11], s32 offen offset:2048 sc1
    v_mfma_f32_16x16x32_bf16 v[100:103], v[80:83], a[36:39], v[100:103]
    v_mfma_f32_16x16x32_bf16 v[104:107], v[80:83], a[40:43], v[104:107]
    v_mfma_f32_16x16x32_bf16 v[108:111], v[80:83], a[44:47], v[108:111]
    ds_read_b128 v[80:83], v4 offset:20480
    s_waitcnt lgkmcnt(7)
    v_mfma_f32_16x16x32_bf16 v[112:115], v[84:87], a[32:35], v[112:115]
    buffer_load_dwordx4 a[100:103], v5, s[8:11], s32 offen offset:2048 sc1
    v_mfma_f32_16x16x32_bf16 v[116:119], v[84:87], a[36:39], v[116:119]
    v_mfma_f32_16x16x32_bf16 v[120:123], v[84:87], a[40:43], v[120:123]
    v_mfma_f32_16x16x32_bf16 v[124:127], v[84:87], a[44:47], v[124:127]
    ds_read_b128 v[84:87], v4 offset:21504
    s_waitcnt lgkmcnt(7)
    v_mfma_f32_16x16x32_bf16 v[128:131], v[88:91], a[32:35], v[128:131]
    buffer_load_dwordx4 a[104:107], v6, s[8:11], s32 offen offset:2048 sc1
    v_mfma_f32_16x16x32_bf16 v[132:135], v[88:91], a[36:39], v[132:135]
    v_mfma_f32_16x16x32_bf16 v[136:139], v[88:91], a[40:43], v[136:139]
    v_mfma_f32_16x16x32_bf16 v[140:143], v[88:91], a[44:47], v[140:143]
    ds_read_b128 v[88:91], v4 offset:22528
    s_waitcnt lgkmcnt(7)
    v_mfma_f32_16x16x32_bf16 v[144:147], v[92:95], a[32:35], v[144:147]
    buffer_load_dwordx4 a[108:111], v7, s[8:11], s32 offen offset:2048 sc1
    v_mfma_f32_16x16x32_bf16 v[148:151], v[92:95], a[36:39], v[148:151]
    v_mfma_f32_16x16x32_bf16 v[152:155], v[92:95], a[40:43], v[152:155]
    v_mfma_f32_16x16x32_bf16 v[156:159], v[92:95], a[44:47], v[156:159]
    ds_read_b128 v[92:95], v4 offset:23552
    s_waitcnt lgkmcnt(7)
    v_mfma_f32_16x16x32_bf16 v[160:163], v[64:67], a[32:35], v[160:163]
    v_mfma_f32_16x16x32_bf16 v[164:167], v[64:67], a[36:39], v[164:167]
    v_mfma_f32_16x16x32_bf16 v[168:171], v[64:67], a[40:43], v[168:171]
    v_mfma_f32_16x16x32_bf16 v[172:175], v[64:67], a[44:47], v[172:175]
    ds_read_b128 v[64:67], v4 offset:24576
    s_waitcnt lgkmcnt(7)
    v_mfma_f32_16x16x32_bf16 v[176:179], v[68:71], a[32:35], v[176:179]
    v_mfma_f32_16x16x32_bf16 v[180:183], v[68:71], a[36:39], v[180:183]
    v_mfma_f32_16x16x32_bf16 v[184:187], v[68:71], a[40:43], v[184:187]
    v_mfma_f32_16x16x32_bf16 v[188:191], v[68:71], a[44:47], v[188:191]
    ds_read_b128 v[68:71], v4 offset:25600
    s_waitcnt vmcnt(14) lgkmcnt(7)
    v_mfma_f32_16x16x32_bf16 v[96:99], v[72:75], a[48:51], v[96:99]
    buffer_load_dwordx4 a[112:115], v3, s[8:11], s32 offen offset:3072 sc1
    v_mfma_f32_16x16x32_bf16 v[100:103], v[72:75], a[52:55], v[100:103]
    v_mfma_f32_16x16x32_bf16 v[104:107], v[72:75], a[56:59], v[104:107]
    v_mfma_f32_16x16x32_bf16 v[108:111], v[72:75], a[60:63], v[108:111]
    ds_read_b128 v[72:75], v4 offset:26624
    s_waitcnt lgkmcnt(7)
    v_mfma_f32_16x16x32_bf16 v[112:115], v[76:79], a[48:51], v[112:115]
    buffer_load_dwordx4 a[116:119], v5, s[8:11], s32 offen offset:3072 sc1
    v_mfma_f32_16x16x32_bf16 v[116:119], v[76:79], a[52:55], v[116:119]
    v_mfma_f32_16x16x32_bf16 v[120:123], v[76:79], a[56:59], v[120:123]
    v_mfma_f32_16x16x32_bf16 v[124:127], v[76:79], a[60:63], v[124:127]
    ds_read_b128 v[76:79], v4 offset:27648
    s_waitcnt lgkmcnt(7)
    v_mfma_f32_16x16x32_bf16 v[128:131], v[80:83], a[48:51], v[128:131]
    buffer_load_dwordx4 a[120:123], v6, s[8:11], s32 offen offset:3072 sc1
    v_mfma_f32_16x16x32_bf16 v[132:135], v[80:83], a[52:55], v[132:135]
    v_mfma_f32_16x16x32_bf16 v[136:139], v[80:83], a[56:59], v[136:139]
    v_mfma_f32_16x16x32_bf16 v[140:143], v[80:83], a[60:63], v[140:143]
    ds_read_b128 v[80:83], v4 offset:28672
    s_waitcnt lgkmcnt(7)
    v_mfma_f32_16x16x32_bf16 v[144:147], v[84:87], a[48:51], v[144:147]
    buffer_load_dwordx4 a[124:127], v7, s[8:11], s32 offen offset:3072 sc1
    v_mfma_f32_16x16x32_bf16 v[148:151], v[84:87], a[52:55], v[148:151]
    v_mfma_f32_16x16x32_bf16 v[152:155], v[84:87], a[56:59], v[152:155]
    v_mfma_f32_16x16x32_bf16 v[156:159], v[84:87], a[60:63], v[156:159]
    ds_read_b128 v[84:87], v4 offset:29696
    s_waitcnt lgkmcnt(7)
    v_mfma_f32_16x16x32_bf16 v[160:163], v[88:91], a[48:51], v[160:163]
    v_mfma_f32_16x16x32_bf16 v[164:167], v[88:91], a[52:55], v[164:167]
    v_mfma_f32_16x16x32_bf16 v[168:171], v[88:91], a[56:59], v[168:171]
    v_mfma_f32_16x16x32_bf16 v[172:175], v[88:91], a[60:63], v[172:175]
    ds_read_b128 v[88:91], v4 offset:30720
    s_waitcnt lgkmcnt(7)
    v_mfma_f32_16x16x32_bf16 v[176:179], v[92:95], a[48:51], v[176:179]
    v_mfma_f32_16x16x32_bf16 v[180:183], v[92:95], a[52:55], v[180:183]
    v_mfma_f32_16x16x32_bf16 v[184:187], v[92:95], a[56:59], v[184:187]
    v_mfma_f32_16x16x32_bf16 v[188:191], v[92:95], a[60:63], v[188:191]
    ds_read_b128 v[92:95], v4 offset:31744
    s_waitcnt vmcnt(12) lgkmcnt(7)
    v_mfma_f32_16x16x32_bf16 v[96:99], v[64:67], a[64:67], v[96:99]
    s_add_u32 s32, s32, 4096
    v_mfma_f32_16x16x32_bf16 v[100:103], v[64:67], a[68:71], v[100:103]
    v_mfma_f32_16x16x32_bf16 v[104:107], v[64:67], a[72:75], v[104:107]
    v_mfma_f32_16x16x32_bf16 v[108:111], v[64:67], a[76:79], v[108:111]
    ds_read_b128 v[64:67], v4 offset:32768
    s_waitcnt lgkmcnt(7)
    v_mfma_f32_16x16x32_bf16 v[112:115], v[68:71], a[64:67], v[112:115]
    buffer_load_dwordx4 a[128:131], v3, s[8:11], s32 offen offset:0 sc1
    v_mfma_f32_16x16x32_bf16 v[116:119], v[68:71], a[68:71], v[116:119]
    v_mfma_f32_16x16x32_bf16 v[120:123], v[68:71], a[72:75], v[120:123]
    v_mfma_f32_16x16x32_bf16 v[124:127], v[68:71], a[76:79], v[124:127]
    ds_read_b128 v[68:71], v4 offset:33792
    s_waitcnt lgkmcnt(7)
    v_mfma_f32_16x16x32_bf16 v[128:131], v[72:75], a[64:67], v[128:131]
    buffer_load_dwordx4 a[132:135], v5, s[8:11], s32 offen offset:0 sc1
    v_mfma_f32_16x16x32_bf16 v[132:135], v[72:75], a[68:71], v[132:135]
    v_mfma_f32_16x16x32_bf16 v[136:139], v[72:75], a[72:75], v[136:139]
    v_mfma_f32_16x16x32_bf16 v[140:143], v[72:75], a[76:79], v[140:143]
    ds_read_b128 v[72:75], v4 offset:34816
    s_waitcnt lgkmcnt(7)
    v_mfma_f32_16x16x32_bf16 v[144:147], v[76:79], a[64:67], v[144:147]
    buffer_load_dwordx4 a[136:139], v6, s[8:11], s32 offen offset:0 sc1
    v_mfma_f32_16x16x32_bf16 v[148:151], v[76:79], a[68:71], v[148:151]
    v_mfma_f32_16x16x32_bf16 v[152:155], v[76:79], a[72:75], v[152:155]
    v_mfma_f32_16x16x32_bf16 v[156:159], v[76:79], a[76:79], v[156:159]
    ds_read_b128 v[76:79], v4 offset:35840
    s_waitcnt lgkmcnt(7)
    v_mfma_f32_16x16x32_bf16 v[160:163], v[80:83], a[64:67], v[160:163]
    buffer_load_dwordx4 a[140:143], v7, s[8:11], s32 offen offset:0 sc1
    v_mfma_f32_16x16x32_bf16 v[164:167], v[80:83], a[68:71], v[164:167]
    v_mfma_f32_16x16x32_bf16 v[168:171], v[80:83], a[72:75], v[168:171]
    v_mfma_f32_16x16x32_bf16 v[172:175], v[80:83], a[76:79], v[172:175]
    ds_read_b128 v[80:83], v8 offset:0
    s_waitcnt lgkmcnt(7)
    v_mfma_f32_16x16x32_bf16 v[176:179], v[84:87], a[64:67], v[176:179]
    v_mfma_f32_16x16x32_bf16 v[180:183], v[84:87], a[68:71], v[180:183]
    v_mfma_f32_16x16x32_bf16 v[184:187], v[84:87], a[72:75], v[184:187]
    v_mfma_f32_16x16x32_bf16 v[188:191], v[84:87], a[76:79], v[188:191]
    ds_read_b128 v[84:87], v8 offset:1024
    s_waitcnt vmcnt(12) lgkmcnt(7)
    v_mfma_f32_16x16x32_bf16 v[96:99], v[88:91], a[80:83], v[96:99]
    buffer_load_dwordx4 a[144:147], v3, s[8:11], s32 offen offset:1024 sc1
    v_mfma_f32_16x16x32_bf16 v[100:103], v[88:91], a[84:87], v[100:103]
    v_mfma_f32_16x16x32_bf16 v[104:107], v[88:91], a[88:91], v[104:107]
    v_mfma_f32_16x16x32_bf16 v[108:111], v[88:91], a[92:95], v[108:111]
    ds_read_b128 v[88:91], v8 offset:2048
    s_waitcnt lgkmcnt(7)
    v_mfma_f32_16x16x32_bf16 v[112:115], v[92:95], a[80:83], v[112:115]
    buffer_load_dwordx4 a[148:151], v5, s[8:11], s32 offen offset:1024 sc1
    v_mfma_f32_16x16x32_bf16 v[116:119], v[92:95], a[84:87], v[116:119]
    v_mfma_f32_16x16x32_bf16 v[120:123], v[92:95], a[88:91], v[120:123]
    v_mfma_f32_16x16x32_bf16 v[124:127], v[92:95], a[92:95], v[124:127]
    ds_read_b128 v[92:95], v8 offset:3072
    s_waitcnt lgkmcnt(7)
    v_mfma_f32_16x16x32_bf16 v[128:131], v[64:67], a[80:83], v[128:131]
    buffer_load_dwordx4 a[152:155], v6, s[8:11], s32 offen offset:1024 sc1
    v_mfma_f32_16x16x32_bf16 v[132:135], v[64:67], a[84:87], v[132:135]
    v_mfma_f32_16x16x32_bf16 v[136:139], v[64:67], a[88:91], v[136:139]
    v_mfma_f32_16x16x32_bf16 v[140:143], v[64:67], a[92:95], v[140:143]
    ds_read_b128 v[64:67], v8 offset:4096
    s_waitcnt lgkmcnt(7)
    v_mfma_f32_16x16x32_bf16 v[144:147], v[68:71], a[80:83], v[144:147]
    buffer_load_dwordx4 a[156:159], v7, s[8:11], s32 offen offset:1024 sc1
    v_mfma_f32_16x16x32_bf16 v[148:151], v[68:71], a[84:87], v[148:151]
    v_mfma_f32_16x16x32_bf16 v[152:155], v[68:71], a[88:91], v[152:155]
    v_mfma_f32_16x16x32_bf16 v[156:159], v[68:71], a[92:95], v[156:159]
    ds_read_b128 v[68:71], v8 offset:5120
    s_waitcnt lgkmcnt(7)
    v_mfma_f32_16x16x32_bf16 v[160:163], v[72:75], a[80:83], v[160:163]
    v_mfma_f32_16x16x32_bf16 v[164:167], v[72:75], a[84:87], v[164:167]
    v_mfma_f32_16x16x32_bf16 v[168:171], v[72:75], a[88:91], v[168:171]
    v_mfma_f32_16x16x32_bf16 v[172:175], v[72:75], a[92:95], v[172:175]
    ds_read_b128 v[72:75], v8 offset:6144
    s_waitcnt lgkmcnt(7)
    v_mfma_f32_16x16x32_bf16 v[176:179], v[76:79], a[80:83], v[176:179]
    v_mfma_f32_16x16x32_bf16 v[180:183], v[76:79], a[84:87], v[180:183]
    v_mfma_f32_16x16x32_bf16 v[184:187], v[76:79], a[88:91], v[184:187]
    v_mfma_f32_16x16x32_bf16 v[188:191], v[76:79], a[92:95], v[188:191]
    ds_read_b128 v[76:79], v8 offset:7168
    s_waitcnt vmcnt(12) lgkmcnt(7)
    v_mfma_f32_16x16x32_bf16 v[96:99], v[80:83], a[96:99], v[96:99]
    buffer_load_dwordx4 a[160:163], v3, s[8:11], s32 offen offset:2048 sc1
    v_mfma_f32_16x16x32_bf16 v[100:103], v[80:83], a[100:103], v[100:103]
    v_mfma_f32_16x16x32_bf16 v[104:107], v[80:83], a[104:107], v[104:107]
    v_mfma_f32_16x16x32_bf16 v[108:111], v[80:83], a[108:111], v[108:111]
    ds_read_b128 v[80:83], v8 offset:8192
    s_waitcnt lgkmcnt(7)
    v_mfma_f32_16x16x32_bf16 v[112:115], v[84:87], a[96:99], v[112:115]
    buffer_load_dwordx4 a[164:167], v5, s[8:11], s32 offen offset:2048 sc1
    v_mfma_f32_16x16x32_bf16 v[116:119], v[84:87], a[100:103], v[116:119]
    v_mfma_f32_16x16x32_bf16 v[120:123], v[84:87], a[104:107], v[120:123]
    s_add_u32 m0, s26, 0
    s_add_u32 s30, s30, 12288
    v_mfma_f32_16x16x32_bf16 v[124:127], v[84:87], a[108:111], v[124:127]
    ds_read_b128 v[84:87], v8 offset:9216
    s_waitcnt lgkmcnt(7)
    v_mfma_f32_16x16x32_bf16 v[128:131], v[88:91], a[96:99], v[128:131]
    buffer_load_dwordx4 v3, s[12:15], s30 offen offset:0 sc1 lds
    v_mfma_f32_16x16x32_bf16 v[132:135], v[88:91], a[100:103], v[132:135]
    buffer_load_dwordx4 a[168:171], v6, s[8:11], s32 offen offset:2048 sc1
    v_mfma_f32_16x16x32_bf16 v[136:139], v[88:91], a[104:107], v[136:139]
    v_mfma_f32_16x16x32_bf16 v[140:143], v[88:91], a[108:111], v[140:143]
    ds_read_b128 v[88:91], v8 offset:10240
    s_waitcnt lgkmcnt(7)
    v_mfma_f32_16x16x32_bf16 v[144:147], v[92:95], a[96:99], v[144:147]
    buffer_load_dwordx4 a[172:175], v7, s[8:11], s32 offen offset:2048 sc1
    v_mfma_f32_16x16x32_bf16 v[148:151], v[92:95], a[100:103], v[148:151]
    v_mfma_f32_16x16x32_bf16 v[152:155], v[92:95], a[104:107], v[152:155]
    v_mfma_f32_16x16x32_bf16 v[156:159], v[92:95], a[108:111], v[156:159]
    ds_read_b128 v[92:95], v8 offset:11264
    s_waitcnt lgkmcnt(7)
    v_mfma_f32_16x16x32_bf16 v[160:163], v[64:67], a[96:99], v[160:163]
    v_mfma_f32_16x16x32_bf16 v[164:167], v[64:67], a[100:103], v[164:167]
    v_mfma_f32_16x16x32_bf16 v[168:171], v[64:67], a[104:107], v[168:171]
    v_mfma_f32_16x16x32_bf16 v[172:175], v[64:67], a[108:111], v[172:175]
    ds_read_b128 v[64:67], v8 offset:12288
    s_waitcnt lgkmcnt(7)
    v_mfma_f32_16x16x32_bf16 v[176:179], v[68:71], a[96:99], v[176:179]
    buffer_load_dwordx4 v3, s[12:15], s30 offen offset:1024 sc1 lds
    v_mfma_f32_16x16x32_bf16 v[180:183], v[68:71], a[100:103], v[180:183]
    v_mfma_f32_16x16x32_bf16 v[184:187], v[68:71], a[104:107], v[184:187]
    v_mfma_f32_16x16x32_bf16 v[188:191], v[68:71], a[108:111], v[188:191]
    ds_read_b128 v[68:71], v8 offset:13312
    s_waitcnt vmcnt(14) lgkmcnt(7)
    v_mfma_f32_16x16x32_bf16 v[96:99], v[72:75], a[112:115], v[96:99]
    buffer_load_dwordx4 a[176:179], v3, s[8:11], s32 offen offset:3072 sc1
    v_mfma_f32_16x16x32_bf16 v[100:103], v[72:75], a[116:119], v[100:103]
    v_mfma_f32_16x16x32_bf16 v[104:107], v[72:75], a[120:123], v[104:107]
    v_mfma_f32_16x16x32_bf16 v[108:111], v[72:75], a[124:127], v[108:111]
    ds_read_b128 v[72:75], v8 offset:14336
    s_waitcnt lgkmcnt(7)
    v_mfma_f32_16x16x32_bf16 v[112:115], v[76:79], a[112:115], v[112:115]
    buffer_load_dwordx4 a[180:183], v5, s[8:11], s32 offen offset:3072 sc1
    v_mfma_f32_16x16x32_bf16 v[116:119], v[76:79], a[116:119], v[116:119]
    v_mfma_f32_16x16x32_bf16 v[120:123], v[76:79], a[120:123], v[120:123]
    v_mfma_f32_16x16x32_bf16 v[124:127], v[76:79], a[124:127], v[124:127]
    ds_read_b128 v[76:79], v8 offset:15360
    s_waitcnt lgkmcnt(7)
    v_mfma_f32_16x16x32_bf16 v[128:131], v[80:83], a[112:115], v[128:131]
    buffer_load_dwordx4 v3, s[12:15], s30 offen offset:2048 sc1 lds
    v_mfma_f32_16x16x32_bf16 v[132:135], v[80:83], a[116:119], v[132:135]
    buffer_load_dwordx4 a[184:187], v6, s[8:11], s32 offen offset:3072 sc1
    v_mfma_f32_16x16x32_bf16 v[136:139], v[80:83], a[120:123], v[136:139]
    v_mfma_f32_16x16x32_bf16 v[140:143], v[80:83], a[124:127], v[140:143]
    ds_read_b128 v[80:83], v8 offset:16384
    s_waitcnt lgkmcnt(7)
    v_mfma_f32_16x16x32_bf16 v[144:147], v[84:87], a[112:115], v[144:147]
    buffer_load_dwordx4 a[188:191], v7, s[8:11], s32 offen offset:3072 sc1
    v_mfma_f32_16x16x32_bf16 v[148:151], v[84:87], a[116:119], v[148:151]
    v_mfma_f32_16x16x32_bf16 v[152:155], v[84:87], a[120:123], v[152:155]
    v_mfma_f32_16x16x32_bf16 v[156:159], v[84:87], a[124:127], v[156:159]
    ds_read_b128 v[84:87], v8 offset:17408
    s_waitcnt lgkmcnt(7)
    v_mfma_f32_16x16x32_bf16 v[160:163], v[88:91], a[112:115], v[160:163]
    v_mfma_f32_16x16x32_bf16 v[164:167], v[88:91], a[116:119], v[164:167]
    v_mfma_f32_16x16x32_bf16 v[168:171], v[88:91], a[120:123], v[168:171]
    v_mfma_f32_16x16x32_bf16 v[172:175], v[88:91], a[124:127], v[172:175]
    ds_read_b128 v[88:91], v8 offset:18432
    s_waitcnt lgkmcnt(7)
    v_mfma_f32_16x16x32_bf16 v[176:179], v[92:95], a[112:115], v[176:179]
    v_mfma_f32_16x16x32_bf16 v[180:183], v[92:95], a[116:119], v[180:183]
    v_mfma_f32_16x16x32_bf16 v[184:187], v[92:95], a[120:123], v[184:187]
    v_mfma_f32_16x16x32_bf16 v[188:191], v[92:95], a[124:127], v[188:191]
    ds_read_b128 v[92:95], v8 offset:19456
    s_waitcnt vmcnt(15) lgkmcnt(7)
    v_mfma_f32_16x16x32_bf16 v[96:99], v[64:67], a[128:131], v[96:99]
    s_add_u32 s32, s32, 4096
    v_mfma_f32_16x16x32_bf16 v[100:103], v[64:67], a[132:135], v[100:103]
    v_mfma_f32_16x16x32_bf16 v[104:107], v[64:67], a[136:139], v[104:107]
    v_mfma_f32_16x16x32_bf16 v[108:111], v[64:67], a[140:143], v[108:111]
    ds_read_b128 v[64:67], v8 offset:20480
    s_waitcnt lgkmcnt(7)
    v_mfma_f32_16x16x32_bf16 v[112:115], v[68:71], a[128:131], v[112:115]
    buffer_load_dwordx4 a[192:195], v3, s[8:11], s32 offen offset:0 sc1
    v_mfma_f32_16x16x32_bf16 v[116:119], v[68:71], a[132:135], v[116:119]
    s_add_u32 m0, s26, 12288
    s_add_u32 s30, s30, 12288
    v_mfma_f32_16x16x32_bf16 v[120:123], v[68:71], a[136:139], v[120:123]
    buffer_load_dwordx4 v3, s[12:15], s30 offen offset:0 sc1 lds
    v_mfma_f32_16x16x32_bf16 v[124:127], v[68:71], a[140:143], v[124:127]
    ds_read_b128 v[68:71], v8 offset:21504
    s_waitcnt lgkmcnt(7)
    v_mfma_f32_16x16x32_bf16 v[128:131], v[72:75], a[128:131], v[128:131]
    buffer_load_dwordx4 a[196:199], v5, s[8:11], s32 offen offset:0 sc1
    v_mfma_f32_16x16x32_bf16 v[132:135], v[72:75], a[132:135], v[132:135]
    v_mfma_f32_16x16x32_bf16 v[136:139], v[72:75], a[136:139], v[136:139]
    v_mfma_f32_16x16x32_bf16 v[140:143], v[72:75], a[140:143], v[140:143]
    ds_read_b128 v[72:75], v8 offset:22528
    s_waitcnt lgkmcnt(7)
    v_mfma_f32_16x16x32_bf16 v[144:147], v[76:79], a[128:131], v[144:147]
    buffer_load_dwordx4 a[200:203], v6, s[8:11], s32 offen offset:0 sc1
    v_mfma_f32_16x16x32_bf16 v[148:151], v[76:79], a[132:135], v[148:151]
    v_mfma_f32_16x16x32_bf16 v[152:155], v[76:79], a[136:139], v[152:155]
    v_mfma_f32_16x16x32_bf16 v[156:159], v[76:79], a[140:143], v[156:159]
    ds_read_b128 v[76:79], v8 offset:23552
    s_waitcnt lgkmcnt(7)
    v_mfma_f32_16x16x32_bf16 v[160:163], v[80:83], a[128:131], v[160:163]
    buffer_load_dwordx4 a[204:207], v7, s[8:11], s32 offen offset:0 sc1
    v_mfma_f32_16x16x32_bf16 v[164:167], v[80:83], a[132:135], v[164:167]
    v_mfma_f32_16x16x32_bf16 v[168:171], v[80:83], a[136:139], v[168:171]
    buffer_load_dwordx4 v3, s[12:15], s30 offen offset:1024 sc1 lds
    v_mfma_f32_16x16x32_bf16 v[172:175], v[80:83], a[140:143], v[172:175]
    ds_read_b128 v[80:83], v8 offset:24576
    s_waitcnt lgkmcnt(7)
    v_mfma_f32_16x16x32_bf16 v[176:179], v[84:87], a[128:131], v[176:179]
    v_mfma_f32_16x16x32_bf16 v[180:183], v[84:87], a[132:135], v[180:183]
    v_mfma_f32_16x16x32_bf16 v[184:187], v[84:87], a[136:139], v[184:187]
    v_mfma_f32_16x16x32_bf16 v[188:191], v[84:87], a[140:143], v[188:191]
    ds_read_b128 v[84:87], v8 offset:25600
    s_waitcnt vmcnt(17) lgkmcnt(7)
    v_mfma_f32_16x16x32_bf16 v[96:99], v[88:91], a[144:147], v[96:99]
    buffer_load_dwordx4 a[208:211], v3, s[8:11], s32 offen offset:1024 sc1
    v_mfma_f32_16x16x32_bf16 v[100:103], v[88:91], a[148:151], v[100:103]
    v_mfma_f32_16x16x32_bf16 v[104:107], v[88:91], a[152:155], v[104:107]
    v_mfma_f32_16x16x32_bf16 v[108:111], v[88:91], a[156:159], v[108:111]
    ds_read_b128 v[88:91], v8 offset:26624
    s_waitcnt lgkmcnt(7)
    v_mfma_f32_16x16x32_bf16 v[112:115], v[92:95], a[144:147], v[112:115]
    buffer_load_dwordx4 a[212:215], v5, s[8:11], s32 offen offset:1024 sc1
    v_mfma_f32_16x16x32_bf16 v[116:119], v[92:95], a[148:151], v[116:119]
    v_mfma_f32_16x16x32_bf16 v[120:123], v[92:95], a[152:155], v[120:123]
    buffer_load_dwordx4 v3, s[12:15], s30 offen offset:2048 sc1 lds
    v_mfma_f32_16x16x32_bf16 v[124:127], v[92:95], a[156:159], v[124:127]
    ds_read_b128 v[92:95], v8 offset:27648
    s_waitcnt lgkmcnt(7)
    v_mfma_f32_16x16x32_bf16 v[128:131], v[64:67], a[144:147], v[128:131]
    buffer_load_dwordx4 a[216:219], v6, s[8:11], s32 offen offset:1024 sc1
    v_mfma_f32_16x16x32_bf16 v[132:135], v[64:67], a[148:151], v[132:135]
    v_mfma_f32_16x16x32_bf16 v[136:139], v[64:67], a[152:155], v[136:139]
    v_mfma_f32_16x16x32_bf16 v[140:143], v[64:67], a[156:159], v[140:143]
    ds_read_b128 v[64:67], v8 offset:28672
    s_waitcnt lgkmcnt(7)
    v_mfma_f32_16x16x32_bf16 v[144:147], v[68:71], a[144:147], v[144:147]
    buffer_load_dwordx4 a[220:223], v7, s[8:11], s32 offen offset:1024 sc1
    v_mfma_f32_16x16x32_bf16 v[148:151], v[68:71], a[148:151], v[148:151]
    v_mfma_f32_16x16x32_bf16 v[152:155], v[68:71], a[152:155], v[152:155]
    v_mfma_f32_16x16x32_bf16 v[156:159], v[68:71], a[156:159], v[156:159]
    ds_read_b128 v[68:71], v8 offset:29696
    s_waitcnt lgkmcnt(7)
    v_mfma_f32_16x16x32_bf16 v[160:163], v[72:75], a[144:147], v[160:163]
    v_mfma_f32_16x16x32_bf16 v[164:167], v[72:75], a[148:151], v[164:167]
    v_mfma_f32_16x16x32_bf16 v[168:171], v[72:75], a[152:155], v[168:171]
    v_mfma_f32_16x16x32_bf16 v[172:175], v[72:75], a[156:159], v[172:175]
    ds_read_b128 v[72:75], v8 offset:30720
    s_waitcnt lgkmcnt(7)
    v_mfma_f32_16x16x32_bf16 v[176:179], v[76:79], a[144:147], v[176:179]
    v_mfma_f32_16x16x32_bf16 v[180:183], v[76:79], a[148:151], v[180:183]
    v_mfma_f32_16x16x32_bf16 v[184:187], v[76:79], a[152:155], v[184:187]
    v_mfma_f32_16x16x32_bf16 v[188:191], v[76:79], a[156:159], v[188:191]
    ds_read_b128 v[76:79], v8 offset:31744
    s_waitcnt vmcnt(17) lgkmcnt(7)
    v_mfma_f32_16x16x32_bf16 v[96:99], v[80:83], a[160:163], v[96:99]
    buffer_load_dwordx4 a[224:227], v3, s[8:11], s32 offen offset:2048 sc1
    v_mfma_f32_16x16x32_bf16 v[100:103], v[80:83], a[164:167], v[100:103]
    v_mfma_f32_16x16x32_bf16 v[104:107], v[80:83], a[168:171], v[104:107]
    v_mfma_f32_16x16x32_bf16 v[108:111], v[80:83], a[172:175], v[108:111]
    ds_read_b128 v[80:83], v8 offset:32768
    s_waitcnt lgkmcnt(7)
    v_mfma_f32_16x16x32_bf16 v[112:115], v[84:87], a[160:163], v[112:115]
    buffer_load_dwordx4 a[228:231], v5, s[8:11], s32 offen offset:2048 sc1
    v_mfma_f32_16x16x32_bf16 v[116:119], v[84:87], a[164:167], v[116:119]
    s_add_u32 m0, s26, 24576
    s_add_u32 s30, s30, 12288
    v_mfma_f32_16x16x32_bf16 v[120:123], v[84:87], a[168:171], v[120:123]
    buffer_load_dwordx4 v3, s[12:15], s30 offen offset:0 sc1 lds
    v_mfma_f32_16x16x32_bf16 v[124:127], v[84:87], a[172:175], v[124:127]
    ds_read_b128 v[84:87], v8 offset:33792
    s_waitcnt lgkmcnt(7)
    v_mfma_f32_16x16x32_bf16 v[128:131], v[88:91], a[160:163], v[128:131]
    buffer_load_dwordx4 a[232:235], v6, s[8:11], s32 offen offset:2048 sc1
    v_mfma_f32_16x16x32_bf16 v[132:135], v[88:91], a[164:167], v[132:135]
    v_mfma_f32_16x16x32_bf16 v[136:139], v[88:91], a[168:171], v[136:139]
    v_mfma_f32_16x16x32_bf16 v[140:143], v[88:91], a[172:175], v[140:143]
    ds_read_b128 v[88:91], v8 offset:34816
    s_waitcnt lgkmcnt(7)
    v_mfma_f32_16x16x32_bf16 v[144:147], v[92:95], a[160:163], v[144:147]
    buffer_load_dwordx4 a[236:239], v7, s[8:11], s32 offen offset:2048 sc1
    v_mfma_f32_16x16x32_bf16 v[148:151], v[92:95], a[164:167], v[148:151]
    v_mfma_f32_16x16x32_bf16 v[152:155], v[92:95], a[168:171], v[152:155]
    v_mfma_f32_16x16x32_bf16 v[156:159], v[92:95], a[172:175], v[156:159]
    ds_read_b128 v[92:95], v8 offset:35840
    s_waitcnt lgkmcnt(7)
    v_mfma_f32_16x16x32_bf16 v[160:163], v[64:67], a[160:163], v[160:163]
    v_mfma_f32_16x16x32_bf16 v[164:167], v[64:67], a[164:167], v[164:167]
    s_waitcnt vmcnt(18)
    s_barrier
    v_mfma_f32_16x16x32_bf16 v[168:171], v[64:67], a[168:171], v[168:171]
    buffer_load_dwordx4 v3, s[12:15], s30 offen offset:1024 sc1 lds
    v_mfma_f32_16x16x32_bf16 v[172:175], v[64:67], a[172:175], v[172:175]
    ds_read_b128 v[64:67], v9 offset:0
    s_waitcnt lgkmcnt(7)
    v_mfma_f32_16x16x32_bf16 v[176:179], v[68:71], a[160:163], v[176:179]
    v_mfma_f32_16x16x32_bf16 v[180:183], v[68:71], a[164:167], v[180:183]
    v_mfma_f32_16x16x32_bf16 v[184:187], v[68:71], a[168:171], v[184:187]
    v_mfma_f32_16x16x32_bf16 v[188:191], v[68:71], a[172:175], v[188:191]
    ds_read_b128 v[68:71], v9 offset:1024
    s_waitcnt vmcnt(17) lgkmcnt(7)
    v_mfma_f32_16x16x32_bf16 v[96:99], v[72:75], a[176:179], v[96:99]
    buffer_load_dwordx4 a[240:243], v3, s[8:11], s32 offen offset:3072 sc1
    v_mfma_f32_16x16x32_bf16 v[100:103], v[72:75], a[180:183], v[100:103]
    v_mfma_f32_16x16x32_bf16 v[104:107], v[72:75], a[184:187], v[104:107]
    v_mfma_f32_16x16x32_bf16 v[108:111], v[72:75], a[188:191], v[108:111]
    ds_read_b128 v[72:75], v9 offset:2048
    s_waitcnt lgkmcnt(7)
    v_mfma_f32_16x16x32_bf16 v[112:115], v[76:79], a[176:179], v[112:115]
    buffer_load_dwordx4 a[244:247], v5, s[8:11], s32 offen offset:3072 sc1
    v_mfma_f32_16x16x32_bf16 v[116:119], v[76:79], a[180:183], v[116:119]
    v_mfma_f32_16x16x32_bf16 v[120:123], v[76:79], a[184:187], v[120:123]
    buffer_load_dwordx4 v3, s[12:15], s30 offen offset:2048 sc1 lds
    v_mfma_f32_16x16x32_bf16 v[124:127], v[76:79], a[188:191], v[124:127]
    ds_read_b128 v[76:79], v9 offset:3072
    s_waitcnt lgkmcnt(7)
    v_mfma_f32_16x16x32_bf16 v[128:131], v[80:83], a[176:179], v[128:131]
    buffer_load_dwordx4 a[248:251], v6, s[8:11], s32 offen offset:3072 sc1
    v_mfma_f32_16x16x32_bf16 v[132:135], v[80:83], a[180:183], v[132:135]
    v_mfma_f32_16x16x32_bf16 v[136:139], v[80:83], a[184:187], v[136:139]
    v_mfma_f32_16x16x32_bf16 v[140:143], v[80:83], a[188:191], v[140:143]
    ds_read_b128 v[80:83], v9 offset:4096
    s_waitcnt lgkmcnt(7)
    v_mfma_f32_16x16x32_bf16 v[144:147], v[84:87], a[176:179], v[144:147]
    buffer_load_dwordx4 a[252:255], v7, s[8:11], s32 offen offset:3072 sc1
    v_mfma_f32_16x16x32_bf16 v[148:151], v[84:87], a[180:183], v[148:151]
    v_mfma_f32_16x16x32_bf16 v[152:155], v[84:87], a[184:187], v[152:155]
    v_mfma_f32_16x16x32_bf16 v[156:159], v[84:87], a[188:191], v[156:159]
    ds_read_b128 v[84:87], v9 offset:5120
    s_waitcnt lgkmcnt(7)
    v_mfma_f32_16x16x32_bf16 v[160:163], v[88:91], a[176:179], v[160:163]
    v_mfma_f32_16x16x32_bf16 v[164:167], v[88:91], a[180:183], v[164:167]
    v_mfma_f32_16x16x32_bf16 v[168:171], v[88:91], a[184:187], v[168:171]
    v_mfma_f32_16x16x32_bf16 v[172:175], v[88:91], a[188:191], v[172:175]
    ds_read_b128 v[88:91], v9 offset:6144
    s_waitcnt lgkmcnt(7)
    v_mfma_f32_16x16x32_bf16 v[176:179], v[92:95], a[176:179], v[176:179]
    v_mfma_f32_16x16x32_bf16 v[180:183], v[92:95], a[180:183], v[180:183]
    v_mfma_f32_16x16x32_bf16 v[184:187], v[92:95], a[184:187], v[184:187]
    v_mfma_f32_16x16x32_bf16 v[188:191], v[92:95], a[188:191], v[188:191]
    ds_read_b128 v[92:95], v9 offset:7168
    s_waitcnt vmcnt(17) lgkmcnt(7)
    v_mfma_f32_16x16x32_bf16 v[96:99], v[64:67], a[192:195], v[96:99]
    s_add_u32 s32, s32, 4096
    v_mfma_f32_16x16x32_bf16 v[100:103], v[64:67], a[196:199], v[100:103]
    v_mfma_f32_16x16x32_bf16 v[104:107], v[64:67], a[200:203], v[104:107]
    v_mfma_f32_16x16x32_bf16 v[108:111], v[64:67], a[204:207], v[108:111]
    ds_read_b128 v[64:67], v9 offset:8192
    s_waitcnt lgkmcnt(7)
    v_mfma_f32_16x16x32_bf16 v[112:115], v[68:71], a[192:195], v[112:115]
    s_add_u32 m0, s26, 36864
    s_add_u32 s30, s30, 12288
    v_mfma_f32_16x16x32_bf16 v[116:119], v[68:71], a[196:199], v[116:119]
    buffer_load_dwordx4 v3, s[12:15], s30 offen offset:0 sc1 lds
    v_mfma_f32_16x16x32_bf16 v[120:123], v[68:71], a[200:203], v[120:123]
    buffer_load_dwordx4 v[224:227], v3, s[8:11], s32 offen offset:0 sc1
    v_mfma_f32_16x16x32_bf16 v[124:127], v[68:71], a[204:207], v[124:127]
    ds_read_b128 v[68:71], v9 offset:9216
    s_waitcnt lgkmcnt(7)
    v_mfma_f32_16x16x32_bf16 v[128:131], v[72:75], a[192:195], v[128:131]
    v_mfma_f32_16x16x32_bf16 v[132:135], v[72:75], a[196:199], v[132:135]
    buffer_load_dwordx4 v[228:231], v5, s[8:11], s32 offen offset:0 sc1
    v_mfma_f32_16x16x32_bf16 v[136:139], v[72:75], a[200:203], v[136:139]
    v_mfma_f32_16x16x32_bf16 v[140:143], v[72:75], a[204:207], v[140:143]
    ds_read_b128 v[72:75], v9 offset:10240
    s_waitcnt lgkmcnt(7)
    v_mfma_f32_16x16x32_bf16 v[144:147], v[76:79], a[192:195], v[144:147]
    buffer_load_dwordx4 v[232:235], v6, s[8:11], s32 offen offset:0 sc1
    v_mfma_f32_16x16x32_bf16 v[148:151], v[76:79], a[196:199], v[148:151]
    v_mfma_f32_16x16x32_bf16 v[152:155], v[76:79], a[200:203], v[152:155]
    v_mfma_f32_16x16x32_bf16 v[156:159], v[76:79], a[204:207], v[156:159]
    ds_read_b128 v[76:79], v9 offset:11264
    s_waitcnt lgkmcnt(7)
    v_mfma_f32_16x16x32_bf16 v[160:163], v[80:83], a[192:195], v[160:163]
    buffer_load_dwordx4 v[236:239], v7, s[8:11], s32 offen offset:0 sc1
    v_mfma_f32_16x16x32_bf16 v[164:167], v[80:83], a[196:199], v[164:167]
    buffer_load_dwordx4 v3, s[12:15], s30 offen offset:1024 sc1 lds
    v_mfma_f32_16x16x32_bf16 v[168:171], v[80:83], a[200:203], v[168:171]
    s_waitcnt vmcnt(19)
    s_barrier
    v_mfma_f32_16x16x32_bf16 v[172:175], v[80:83], a[204:207], v[172:175]
    ds_read_b128 v[80:83], v9 offset:12288
    s_waitcnt lgkmcnt(7)
    v_mfma_f32_16x16x32_bf16 v[176:179], v[84:87], a[192:195], v[176:179]
    v_mfma_f32_16x16x32_bf16 v[180:183], v[84:87], a[196:199], v[180:183]
    v_mfma_f32_16x16x32_bf16 v[184:187], v[84:87], a[200:203], v[184:187]
    v_mfma_f32_16x16x32_bf16 v[188:191], v[84:87], a[204:207], v[188:191]
    ds_read_b128 v[84:87], v9 offset:13312
    s_waitcnt vmcnt(17) lgkmcnt(7)
    v_mfma_f32_16x16x32_bf16 v[96:99], v[88:91], a[208:211], v[96:99]
    buffer_load_dwordx4 v[240:243], v3, s[8:11], s32 offen offset:1024 sc1
    v_mfma_f32_16x16x32_bf16 v[100:103], v[88:91], a[212:215], v[100:103]
    v_mfma_f32_16x16x32_bf16 v[104:107], v[88:91], a[216:219], v[104:107]
    v_mfma_f32_16x16x32_bf16 v[108:111], v[88:91], a[220:223], v[108:111]
    ds_read_b128 v[88:91], v9 offset:14336
    s_waitcnt lgkmcnt(7)
    v_mfma_f32_16x16x32_bf16 v[112:115], v[92:95], a[208:211], v[112:115]
    buffer_load_dwordx4 v[244:247], v5, s[8:11], s32 offen offset:1024 sc1
    v_mfma_f32_16x16x32_bf16 v[116:119], v[92:95], a[212:215], v[116:119]
    buffer_load_dwordx4 v3, s[12:15], s30 offen offset:2048 sc1 lds
    v_mfma_f32_16x16x32_bf16 v[120:123], v[92:95], a[216:219], v[120:123]
    v_mfma_f32_16x16x32_bf16 v[124:127], v[92:95], a[220:223], v[124:127]
    ds_read_b128 v[92:95], v9 offset:15360
    s_waitcnt lgkmcnt(7)
    v_mfma_f32_16x16x32_bf16 v[128:131], v[64:67], a[208:211], v[128:131]
    buffer_load_dwordx4 v[248:251], v6, s[8:11], s32 offen offset:1024 sc1
    v_mfma_f32_16x16x32_bf16 v[132:135], v[64:67], a[212:215], v[132:135]
    v_mfma_f32_16x16x32_bf16 v[136:139], v[64:67], a[216:219], v[136:139]
    v_mfma_f32_16x16x32_bf16 v[140:143], v[64:67], a[220:223], v[140:143]
    ds_read_b128 v[64:67], v9 offset:16384
    s_waitcnt lgkmcnt(7)
    v_mfma_f32_16x16x32_bf16 v[144:147], v[68:71], a[208:211], v[144:147]
    buffer_load_dwordx4 v[252:255], v7, s[8:11], s32 offen offset:1024 sc1
    v_mfma_f32_16x16x32_bf16 v[148:151], v[68:71], a[212:215], v[148:151]
    v_mfma_f32_16x16x32_bf16 v[152:155], v[68:71], a[216:219], v[152:155]
    v_mfma_f32_16x16x32_bf16 v[156:159], v[68:71], a[220:223], v[156:159]
    ds_read_b128 v[68:71], v9 offset:17408
    s_waitcnt lgkmcnt(7)
    v_mfma_f32_16x16x32_bf16 v[160:163], v[72:75], a[208:211], v[160:163]
    v_mfma_f32_16x16x32_bf16 v[164:167], v[72:75], a[212:215], v[164:167]
    v_mfma_f32_16x16x32_bf16 v[168:171], v[72:75], a[216:219], v[168:171]
    v_mfma_f32_16x16x32_bf16 v[172:175], v[72:75], a[220:223], v[172:175]
    ds_read_b128 v[72:75], v9 offset:18432
    s_waitcnt lgkmcnt(7)
    v_mfma_f32_16x16x32_bf16 v[176:179], v[76:79], a[208:211], v[176:179]
    v_mfma_f32_16x16x32_bf16 v[180:183], v[76:79], a[212:215], v[180:183]
    v_mfma_f32_16x16x32_bf16 v[184:187], v[76:79], a[216:219], v[184:187]
    v_mfma_f32_16x16x32_bf16 v[188:191], v[76:79], a[220:223], v[188:191]
    ds_read_b128 v[76:79], v9 offset:19456
    s_waitcnt vmcnt(17) lgkmcnt(7)
    v_mfma_f32_16x16x32_bf16 v[96:99], v[80:83], a[224:227], v[96:99]
    v_mfma_f32_16x16x32_bf16 v[100:103], v[80:83], a[228:231], v[100:103]
    v_mfma_f32_16x16x32_bf16 v[104:107], v[80:83], a[232:235], v[104:107]
    v_mfma_f32_16x16x32_bf16 v[108:111], v[80:83], a[236:239], v[108:111]
    ds_read_b128 v[80:83], v9 offset:20480
    s_waitcnt lgkmcnt(7)
    v_mfma_f32_16x16x32_bf16 v[112:115], v[84:87], a[224:227], v[112:115]
    s_add_u32 m0, s26, 49152
    s_add_u32 s30, s30, 12288
    v_mfma_f32_16x16x32_bf16 v[116:119], v[84:87], a[228:231], v[116:119]
    buffer_load_dwordx4 v3, s[12:15], s30 offen offset:0 sc1 lds
    v_mfma_f32_16x16x32_bf16 v[120:123], v[84:87], a[232:235], v[120:123]
    v_mfma_f32_16x16x32_bf16 v[124:127], v[84:87], a[236:239], v[124:127]
    ds_read_b128 v[84:87], v9 offset:21504
    s_waitcnt lgkmcnt(7)
    v_mfma_f32_16x16x32_bf16 v[128:131], v[88:91], a[224:227], v[128:131]
    v_mfma_f32_16x16x32_bf16 v[132:135], v[88:91], a[228:231], v[132:135]
    v_mfma_f32_16x16x32_bf16 v[136:139], v[88:91], a[232:235], v[136:139]
    v_mfma_f32_16x16x32_bf16 v[140:143], v[88:91], a[236:239], v[140:143]
    ds_read_b128 v[88:91], v9 offset:22528
    s_waitcnt lgkmcnt(7)
    v_mfma_f32_16x16x32_bf16 v[144:147], v[92:95], a[224:227], v[144:147]
    buffer_load_dwordx4 v3, s[12:15], s30 offen offset:1024 sc1 lds
    v_mfma_f32_16x16x32_bf16 v[148:151], v[92:95], a[228:231], v[148:151]
    v_mfma_f32_16x16x32_bf16 v[152:155], v[92:95], a[232:235], v[152:155]
    v_mfma_f32_16x16x32_bf16 v[156:159], v[92:95], a[236:239], v[156:159]
    ds_read_b128 v[92:95], v9 offset:23552
    s_waitcnt lgkmcnt(7)
    v_mfma_f32_16x16x32_bf16 v[160:163], v[64:67], a[224:227], v[160:163]
    v_mfma_f32_16x16x32_bf16 v[164:167], v[64:67], a[228:231], v[164:167]
    s_waitcnt vmcnt(15)
    s_barrier
    v_mfma_f32_16x16x32_bf16 v[168:171], v[64:67], a[232:235], v[168:171]
    buffer_load_dwordx4 v3, s[12:15], s30 offen offset:2048 sc1 lds
    v_mfma_f32_16x16x32_bf16 v[172:175], v[64:67], a[236:239], v[172:175]
    ds_read_b128 v[64:67], v9 offset:24576
    s_waitcnt lgkmcnt(7)
    v_mfma_f32_16x16x32_bf16 v[176:179], v[68:71], a[224:227], v[176:179]
    v_mfma_f32_16x16x32_bf16 v[180:183], v[68:71], a[228:231], v[180:183]
    v_mfma_f32_16x16x32_bf16 v[184:187], v[68:71], a[232:235], v[184:187]
    v_mfma_f32_16x16x32_bf16 v[188:191], v[68:71], a[236:239], v[188:191]
    ds_read_b128 v[68:71], v9 offset:25600
    s_waitcnt vmcnt(14) lgkmcnt(7)
    v_mfma_f32_16x16x32_bf16 v[96:99], v[72:75], a[240:243], v[96:99]
    v_mfma_f32_16x16x32_bf16 v[100:103], v[72:75], a[244:247], v[100:103]
    s_add_u32 m0, s26, 61440
    s_add_u32 s30, s30, 12288
    v_mfma_f32_16x16x32_bf16 v[104:107], v[72:75], a[248:251], v[104:107]
    buffer_load_dwordx4 v3, s[12:15], s30 offen offset:0 sc1 lds
    v_mfma_f32_16x16x32_bf16 v[108:111], v[72:75], a[252:255], v[108:111]
    ds_read_b128 v[72:75], v9 offset:26624
    s_waitcnt lgkmcnt(7)
    v_mfma_f32_16x16x32_bf16 v[112:115], v[76:79], a[240:243], v[112:115]
    v_mfma_f32_16x16x32_bf16 v[116:119], v[76:79], a[244:247], v[116:119]
    v_mfma_f32_16x16x32_bf16 v[120:123], v[76:79], a[248:251], v[120:123]
    v_mfma_f32_16x16x32_bf16 v[124:127], v[76:79], a[252:255], v[124:127]
    ds_read_b128 v[76:79], v9 offset:27648
    s_waitcnt lgkmcnt(7)
    v_mfma_f32_16x16x32_bf16 v[128:131], v[80:83], a[240:243], v[128:131]
    buffer_load_dwordx4 v3, s[12:15], s30 offen offset:1024 sc1 lds
    v_mfma_f32_16x16x32_bf16 v[132:135], v[80:83], a[244:247], v[132:135]
    v_mfma_f32_16x16x32_bf16 v[136:139], v[80:83], a[248:251], v[136:139]
    v_mfma_f32_16x16x32_bf16 v[140:143], v[80:83], a[252:255], v[140:143]
    ds_read_b128 v[80:83], v9 offset:28672
    s_waitcnt lgkmcnt(7)
    v_mfma_f32_16x16x32_bf16 v[144:147], v[84:87], a[240:243], v[144:147]
    v_mfma_f32_16x16x32_bf16 v[148:151], v[84:87], a[244:247], v[148:151]
    v_mfma_f32_16x16x32_bf16 v[152:155], v[84:87], a[248:251], v[152:155]
    buffer_load_dwordx4 v3, s[12:15], s30 offen offset:2048 sc1 lds
    v_mfma_f32_16x16x32_bf16 v[156:159], v[84:87], a[252:255], v[156:159]
    ds_read_b128 v[84:87], v9 offset:29696
    s_waitcnt lgkmcnt(7)
    v_mfma_f32_16x16x32_bf16 v[160:163], v[88:91], a[240:243], v[160:163]
    v_mfma_f32_16x16x32_bf16 v[164:167], v[88:91], a[244:247], v[164:167]
    v_mfma_f32_16x16x32_bf16 v[168:171], v[88:91], a[248:251], v[168:171]
    v_mfma_f32_16x16x32_bf16 v[172:175], v[88:91], a[252:255], v[172:175]
    ds_read_b128 v[88:91], v9 offset:30720
    s_waitcnt lgkmcnt(7)
    v_mfma_f32_16x16x32_bf16 v[176:179], v[92:95], a[240:243], v[176:179]
    v_mfma_f32_16x16x32_bf16 v[180:183], v[92:95], a[244:247], v[180:183]
    v_mfma_f32_16x16x32_bf16 v[184:187], v[92:95], a[248:251], v[184:187]
    v_mfma_f32_16x16x32_bf16 v[188:191], v[92:95], a[252:255], v[188:191]
    ds_read_b128 v[92:95], v9 offset:31744
    s_waitcnt vmcnt(12) lgkmcnt(7)
    v_mfma_f32_16x16x32_bf16 v[96:99], v[64:67], v[224:227], v[96:99]
    s_add_u32 m0, s25, 0
    s_add_u32 s30, s30, 12288
    v_mfma_f32_16x16x32_bf16 v[100:103], v[64:67], v[228:231], v[100:103]
    buffer_load_dwordx4 v3, s[12:15], s30 offen offset:0 sc1 lds
    v_mfma_f32_16x16x32_bf16 v[104:107], v[64:67], v[232:235], v[104:107]
    v_mfma_f32_16x16x32_bf16 v[108:111], v[64:67], v[236:239], v[108:111]
    ds_read_b128 v[64:67], v9 offset:32768
    s_waitcnt lgkmcnt(7)
    v_mfma_f32_16x16x32_bf16 v[112:115], v[68:71], v[224:227], v[112:115]
    v_mfma_f32_16x16x32_bf16 v[116:119], v[68:71], v[228:231], v[116:119]
    v_mfma_f32_16x16x32_bf16 v[120:123], v[68:71], v[232:235], v[120:123]
    v_mfma_f32_16x16x32_bf16 v[124:127], v[68:71], v[236:239], v[124:127]
    ds_read_b128 v[68:71], v9 offset:33792
    s_waitcnt lgkmcnt(7)
    v_mfma_f32_16x16x32_bf16 v[128:131], v[72:75], v[224:227], v[128:131]
    buffer_load_dwordx4 v3, s[12:15], s30 offen offset:1024 sc1 lds
    v_mfma_f32_16x16x32_bf16 v[132:135], v[72:75], v[228:231], v[132:135]
    v_mfma_f32_16x16x32_bf16 v[136:139], v[72:75], v[232:235], v[136:139]
    v_mfma_f32_16x16x32_bf16 v[140:143], v[72:75], v[236:239], v[140:143]
    ds_read_b128 v[72:75], v9 offset:34816
    s_waitcnt lgkmcnt(7)
    v_mfma_f32_16x16x32_bf16 v[144:147], v[76:79], v[224:227], v[144:147]
    v_mfma_f32_16x16x32_bf16 v[148:151], v[76:79], v[228:231], v[148:151]
    v_mfma_f32_16x16x32_bf16 v[152:155], v[76:79], v[232:235], v[152:155]
    buffer_load_dwordx4 v3, s[12:15], s30 offen offset:2048 sc1 lds
    v_mfma_f32_16x16x32_bf16 v[156:159], v[76:79], v[236:239], v[156:159]
    ds_read_b128 v[76:79], v9 offset:35840
    s_waitcnt lgkmcnt(7)
    v_mfma_f32_16x16x32_bf16 v[160:163], v[80:83], v[224:227], v[160:163]
    v_mfma_f32_16x16x32_bf16 v[164:167], v[80:83], v[228:231], v[164:167]
    v_mfma_f32_16x16x32_bf16 v[168:171], v[80:83], v[232:235], v[168:171]
    s_waitcnt vmcnt(11)
    s_barrier
    v_mfma_f32_16x16x32_bf16 v[172:175], v[80:83], v[236:239], v[172:175]
    ds_read_b128 v[80:83], v10 offset:0
    s_waitcnt lgkmcnt(7)
    v_mfma_f32_16x16x32_bf16 v[176:179], v[84:87], v[224:227], v[176:179]
    v_mfma_f32_16x16x32_bf16 v[180:183], v[84:87], v[228:231], v[180:183]
    s_add_u32 m0, s25, 12288
    s_add_u32 s30, s30, 12288
    v_mfma_f32_16x16x32_bf16 v[184:187], v[84:87], v[232:235], v[184:187]
    buffer_load_dwordx4 v3, s[12:15], s30 offen offset:0 sc1 lds
    v_mfma_f32_16x16x32_bf16 v[188:191], v[84:87], v[236:239], v[188:191]
    ds_read_b128 v[84:87], v10 offset:2048
    s_waitcnt vmcnt(10) lgkmcnt(7)
    v_mfma_f32_16x16x32_bf16 v[96:99], v[88:91], v[240:243], v[96:99]
    v_mfma_f32_16x16x32_bf16 v[100:103], v[88:91], v[244:247], v[100:103]
    v_mfma_f32_16x16x32_bf16 v[104:107], v[88:91], v[248:251], v[104:107]
    v_mfma_f32_16x16x32_bf16 v[108:111], v[88:91], v[252:255], v[108:111]
    ds_read_b128 v[88:91], v10 offset:4096
    s_waitcnt lgkmcnt(7)
    v_mfma_f32_16x16x32_bf16 v[112:115], v[92:95], v[240:243], v[112:115]
    buffer_load_dwordx4 v3, s[12:15], s30 offen offset:1024 sc1 lds
    v_mfma_f32_16x16x32_bf16 v[116:119], v[92:95], v[244:247], v[116:119]
    v_mfma_f32_16x16x32_bf16 v[120:123], v[92:95], v[248:251], v[120:123]
    v_mfma_f32_16x16x32_bf16 v[124:127], v[92:95], v[252:255], v[124:127]
    ds_read_b128 v[92:95], v10 offset:1024
    s_waitcnt lgkmcnt(7)
    v_mfma_f32_16x16x32_bf16 v[128:131], v[64:67], v[240:243], v[128:131]
    v_mfma_f32_16x16x32_bf16 v[132:135], v[64:67], v[244:247], v[132:135]
    v_mfma_f32_16x16x32_bf16 v[136:139], v[64:67], v[248:251], v[136:139]
    buffer_load_dwordx4 v3, s[12:15], s30 offen offset:2048 sc1 lds
    v_mfma_f32_16x16x32_bf16 v[140:143], v[64:67], v[252:255], v[140:143]
    ds_read_b128 v[64:67], v10 offset:3072
    s_waitcnt lgkmcnt(7)
    v_mfma_f32_16x16x32_bf16 v[144:147], v[68:71], v[240:243], v[144:147]
    v_mfma_f32_16x16x32_bf16 v[148:151], v[68:71], v[244:247], v[148:151]
    v_mfma_f32_16x16x32_bf16 v[152:155], v[68:71], v[248:251], v[152:155]
    v_mfma_f32_16x16x32_bf16 v[156:159], v[68:71], v[252:255], v[156:159]
    ds_read_b128 v[68:71], v10 offset:5120
    s_waitcnt lgkmcnt(7)
    v_mfma_f32_16x16x32_bf16 v[160:163], v[72:75], v[240:243], v[160:163]
    v_mfma_f32_16x16x32_bf16 v[164:167], v[72:75], v[244:247], v[164:167]
    v_mfma_f32_16x16x32_bf16 v[168:171], v[72:75], v[248:251], v[168:171]
    s_add_u32 m0, s25, 24576
    s_add_u32 s30, s30, 12288
    v_mfma_f32_16x16x32_bf16 v[172:175], v[72:75], v[252:255], v[172:175]
    ds_read_b128 v[72:75], v10 offset:6144
    s_waitcnt lgkmcnt(7)
    v_mfma_f32_16x16x32_bf16 v[176:179], v[76:79], v[240:243], v[176:179]
    buffer_load_dwordx4 v3, s[12:15], s30 offen offset:0 sc1 lds
    v_mfma_f32_16x16x32_bf16 v[180:183], v[76:79], v[244:247], v[180:183]
    v_mfma_f32_16x16x32_bf16 v[184:187], v[76:79], v[248:251], v[184:187]
    v_mfma_f32_16x16x32_bf16 v[188:191], v[76:79], v[252:255], v[188:191]
    ds_read_b128 v[76:79], v10 offset:8192
    s_waitcnt lgkmcnt(7)
    v_mfma_f32_16x16x32_bf16 v[192:195], v[80:83], a[0:3], 0
    s_waitcnt lgkmcnt(6)
    v_mfma_f32_16x16x32_bf16 v[192:195], v[84:87], a[16:19], v[192:195]
    s_waitcnt lgkmcnt(5)
    v_mfma_f32_16x16x32_bf16 v[192:195], v[88:91], a[32:35], v[192:195]
    buffer_load_dwordx4 v3, s[12:15], s30 offen offset:1024 sc1 lds
    v_mfma_f32_16x16x32_bf16 v[196:199], v[80:83], a[4:7], 0
    v_mfma_f32_16x16x32_bf16 v[196:199], v[84:87], a[20:23], v[196:199]
    v_mfma_f32_16x16x32_bf16 v[196:199], v[88:91], a[36:39], v[196:199]
    v_mfma_f32_16x16x32_bf16 v[200:203], v[80:83], a[8:11], 0
    v_max_f32 v96, 0, v96
    v_max_f32 v97, 0, v97
    v_mfma_f32_16x16x32_bf16 v[200:203], v[84:87], a[24:27], v[200:203]
    v_max_f32 v98, 0, v98
    v_max_f32 v99, 0, v99
    v_mfma_f32_16x16x32_bf16 v[200:203], v[88:91], a[40:43], v[200:203]
    buffer_load_dwordx4 v3, s[12:15], s30 offen offset:2048 sc1 lds
    v_mfma_f32_16x16x32_bf16 v[204:207], v[80:83], a[12:15], 0
    ds_read_b128 v[80:83], v10 offset:10240
    v_mul_f32 v96, v96, v112
    v_mfma_f32_16x16x32_bf16 v[204:207], v[84:87], a[28:31], v[204:207]
    ds_read_b128 v[84:87], v10 offset:7168
    v_mul_f32 v97, v97, v113
    v_mfma_f32_16x16x32_bf16 v[204:207], v[88:91], a[44:47], v[204:207]
    ds_read_b128 v[88:91], v10 offset:9216
    s_waitcnt lgkmcnt(7)
    v_mfma_f32_16x16x32_bf16 v[208:211], v[92:95], a[0:3], 0
    v_mul_f32 v98, v98, v114
    s_waitcnt lgkmcnt(6)
    v_mfma_f32_16x16x32_bf16 v[208:211], v[64:67], a[16:19], v[208:211]
    v_mul_f32 v99, v99, v115
    s_waitcnt lgkmcnt(5)
    v_mfma_f32_16x16x32_bf16 v[208:211], v[68:71], a[32:35], v[208:211]
    v_cvt_pk_bf16_f32 v48, v96, v97
    v_cvt_pk_bf16_f32 v49, v98, v99
    v_mfma_f32_16x16x32_bf16 v[212:215], v[92:95], a[4:7], 0
    v_max_f32 v100, 0, v100
    v_max_f32 v101, 0, v101
    v_mfma_f32_16x16x32_bf16 v[212:215], v[64:67], a[20:23], v[212:215]
    s_add_u32 m0, s25, 36864
    s_add_u32 s30, s30, 12288
    v_mfma_f32_16x16x32_bf16 v[212:215], v[68:71], a[36:39], v[212:215]
    buffer_load_dwordx4 v3, s[12:15], s30 offen offset:0 sc1 lds
    v_mfma_f32_16x16x32_bf16 v[216:219], v[92:95], a[8:11], 0
    v_max_f32 v102, 0, v102
    v_max_f32 v103, 0, v103
    v_mfma_f32_16x16x32_bf16 v[216:219], v[64:67], a[24:27], v[216:219]
    v_mul_f32 v100, v100, v116
    v_mul_f32 v101, v101, v117
    v_mfma_f32_16x16x32_bf16 v[216:219], v[68:71], a[40:43], v[216:219]
    s_waitcnt vmcnt(10)
    s_barrier
    v_mfma_f32_16x16x32_bf16 v[220:223], v[92:95], a[12:15], 0
    ds_read_b128 v[92:95], v10 offset:11264
    v_mul_f32 v102, v102, v118
    v_mfma_f32_16x16x32_bf16 v[220:223], v[64:67], a[28:31], v[220:223]
    ds_read_b128 v[64:67], v10 offset:12288
    v_mul_f32 v103, v103, v119
    v_mfma_f32_16x16x32_bf16 v[220:223], v[68:71], a[44:47], v[220:223]
    ds_read_b128 v[68:71], v10 offset:14336
    s_waitcnt lgkmcnt(7)
    v_mfma_f32_16x16x32_bf16 v[192:195], v[72:75], a[48:51], v[192:195]
    v_cvt_pk_bf16_f32 v52, v100, v101
    s_waitcnt lgkmcnt(6)
    v_mfma_f32_16x16x32_bf16 v[192:195], v[76:79], a[64:67], v[192:195]
    v_cvt_pk_bf16_f32 v53, v102, v103
    s_waitcnt lgkmcnt(5)
    v_mfma_f32_16x16x32_bf16 v[192:195], v[80:83], a[80:83], v[192:195]
    buffer_load_dwordx4 v3, s[12:15], s30 offen offset:1024 sc1 lds
    v_mfma_f32_16x16x32_bf16 v[196:199], v[72:75], a[52:55], v[196:199]
    v_max_f32 v104, 0, v104
    v_max_f32 v105, 0, v105
    v_mfma_f32_16x16x32_bf16 v[196:199], v[76:79], a[68:71], v[196:199]
    v_max_f32 v106, 0, v106
    v_max_f32 v107, 0, v107
    v_mfma_f32_16x16x32_bf16 v[196:199], v[80:83], a[84:87], v[196:199]
    v_mul_f32 v104, v104, v120
    v_mul_f32 v105, v105, v121
    v_mfma_f32_16x16x32_bf16 v[200:203], v[72:75], a[56:59], v[200:203]
    v_mul_f32 v106, v106, v122
    v_mul_f32 v107, v107, v123
    v_mfma_f32_16x16x32_bf16 v[200:203], v[76:79], a[72:75], v[200:203]
    v_cvt_pk_bf16_f32 v56, v104, v105
    v_cvt_pk_bf16_f32 v57, v106, v107
    v_mfma_f32_16x16x32_bf16 v[200:203], v[80:83], a[88:91], v[200:203]
    buffer_load_dwordx4 v3, s[12:15], s30 offen offset:2048 sc1 lds
    v_mfma_f32_16x16x32_bf16 v[204:207], v[72:75], a[60:63], v[204:207]
    ds_read_b128 v[72:75], v10 offset:16384
    v_max_f32 v108, 0, v108
    v_mfma_f32_16x16x32_bf16 v[204:207], v[76:79], a[76:79], v[204:207]
    ds_read_b128 v[76:79], v10 offset:13312
    v_max_f32 v109, 0, v109
    v_mfma_f32_16x16x32_bf16 v[204:207], v[80:83], a[92:95], v[204:207]
    ds_read_b128 v[80:83], v10 offset:15360
    s_waitcnt lgkmcnt(7)
    v_mfma_f32_16x16x32_bf16 v[208:211], v[84:87], a[48:51], v[208:211]
    v_max_f32 v110, 0, v110
    s_waitcnt lgkmcnt(6)
    v_mfma_f32_16x16x32_bf16 v[208:211], v[88:91], a[64:67], v[208:211]
    v_max_f32 v111, 0, v111
    s_waitcnt lgkmcnt(5)
    v_mfma_f32_16x16x32_bf16 v[208:211], v[92:95], a[80:83], v[208:211]
    s_add_u32 m0, s25, 49152
    s_add_u32 s30, s30, 12288
    v_mfma_f32_16x16x32_bf16 v[212:215], v[84:87], a[52:55], v[212:215]
    buffer_load_dwordx4 v3, s[12:15], s30 offen offset:0 sc1 lds
    v_mfma_f32_16x16x32_bf16 v[212:215], v[88:91], a[68:71], v[212:215]
    v_mul_f32 v108, v108, v124
    v_mul_f32 v109, v109, v125
    v_mfma_f32_16x16x32_bf16 v[212:215], v[92:95], a[84:87], v[212:215]
    v_mul_f32 v110, v110, v126
    v_mul_f32 v111, v111, v127
    v_mfma_f32_16x16x32_bf16 v[216:219], v[84:87], a[56:59], v[216:219]
    v_cvt_pk_bf16_f32 v60, v108, v109
    v_cvt_pk_bf16_f32 v61, v110, v111
    v_mfma_f32_16x16x32_bf16 v[216:219], v[88:91], a[72:75], v[216:219]
    v_max_f32 v128, 0, v128
    v_max_f32 v129, 0, v129
    v_mfma_f32_16x16x32_bf16 v[216:219], v[92:95], a[88:91], v[216:219]
    v_max_f32 v130, 0, v130
    v_max_f32 v131, 0, v131
    v_mfma_f32_16x16x32_bf16 v[220:223], v[84:87], a[60:63], v[220:223]
    ds_read_b128 v[84:87], v10 offset:17408
    v_mul_f32 v128, v128, v144
    v_mfma_f32_16x16x32_bf16 v[220:223], v[88:91], a[76:79], v[220:223]
    ds_read_b128 v[88:91], v10 offset:18432
    v_mul_f32 v129, v129, v145
    v_mfma_f32_16x16x32_bf16 v[220:223], v[92:95], a[92:95], v[220:223]
    ds_read_b128 v[92:95], v10 offset:20480
    s_waitcnt lgkmcnt(7)
    v_mfma_f32_16x16x32_bf16 v[192:195], v[64:67], a[96:99], v[192:195]
    v_mul_f32 v130, v130, v146
    s_waitcnt lgkmcnt(6)
    v_mfma_f32_16x16x32_bf16 v[192:195], v[68:71], a[112:115], v[192:195]
    v_mul_f32 v131, v131, v147
    s_waitcnt lgkmcnt(5)
    v_mfma_f32_16x16x32_bf16 v[192:195], v[72:75], a[128:131], v[192:195]
    buffer_load_dwordx4 v3, s[12:15], s30 offen offset:1024 sc1 lds
    v_mfma_f32_16x16x32_bf16 v[196:199], v[64:67], a[100:103], v[196:199]
    v_cvt_pk_bf16_f32 v50, v128, v129
    v_cvt_pk_bf16_f32 v51, v130, v131
    v_mfma_f32_16x16x32_bf16 v[196:199], v[68:71], a[116:119], v[196:199]
    buffer_store_dwordx4 v[48:51], v3, s[36:39], s35 offen sc1
    v_mfma_f32_16x16x32_bf16 v[196:199], v[72:75], a[132:135], v[196:199]
    v_max_f32 v132, 0, v132
    v_max_f32 v133, 0, v133
    v_mfma_f32_16x16x32_bf16 v[200:203], v[64:67], a[104:107], v[200:203]
    v_max_f32 v134, 0, v134
    v_max_f32 v135, 0, v135
    v_mfma_f32_16x16x32_bf16 v[200:203], v[68:71], a[120:123], v[200:203]
    v_mul_f32 v132, v132, v148
    v_mul_f32 v133, v133, v149
    v_mfma_f32_16x16x32_bf16 v[200:203], v[72:75], a[136:139], v[200:203]
    v_mul_f32 v134, v134, v150
    v_mul_f32 v135, v135, v151
    v_mfma_f32_16x16x32_bf16 v[204:207], v[64:67], a[108:111], v[204:207]
    ds_read_b128 v[64:67], v10 offset:22528
    v_cvt_pk_bf16_f32 v54, v132, v133
    v_mfma_f32_16x16x32_bf16 v[204:207], v[68:71], a[124:127], v[204:207]
    ds_read_b128 v[68:71], v10 offset:19456
    v_cvt_pk_bf16_f32 v55, v134, v135
    v_mfma_f32_16x16x32_bf16 v[204:207], v[72:75], a[140:143], v[204:207]
    ds_read_b128 v[72:75], v10 offset:21504
    s_waitcnt lgkmcnt(7)
    v_mfma_f32_16x16x32_bf16 v[208:211], v[76:79], a[96:99], v[208:211]
    s_waitcnt lgkmcnt(6)
    v_mfma_f32_16x16x32_bf16 v[208:211], v[80:83], a[112:115], v[208:211]
    s_waitcnt lgkmcnt(5)
    v_mfma_f32_16x16x32_bf16 v[208:211], v[84:87], a[128:131], v[208:211]
    buffer_load_dwordx4 v3, s[12:15], s30 offen offset:2048 sc1 lds
    v_mfma_f32_16x16x32_bf16 v[212:215], v[76:79], a[100:103], v[212:215]
    buffer_store_dwordx4 v[52:55], v11, s[36:39], s35 offen sc1
    v_mfma_f32_16x16x32_bf16 v[212:215], v[80:83], a[116:119], v[212:215]
    v_max_f32 v136, 0, v136
    v_max_f32 v137, 0, v137
    v_mfma_f32_16x16x32_bf16 v[212:215], v[84:87], a[132:135], v[212:215]
    v_max_f32 v138, 0, v138
    v_max_f32 v139, 0, v139
    v_mfma_f32_16x16x32_bf16 v[216:219], v[76:79], a[104:107], v[216:219]
    v_mul_f32 v136, v136, v152
    v_mul_f32 v137, v137, v153
    v_mfma_f32_16x16x32_bf16 v[216:219], v[80:83], a[120:123], v[216:219]
    v_mul_f32 v138, v138, v154
    v_mul_f32 v139, v139, v155
    v_mfma_f32_16x16x32_bf16 v[216:219], v[84:87], a[136:139], v[216:219]
    v_cvt_pk_bf16_f32 v58, v136, v137
    v_cvt_pk_bf16_f32 v59, v138, v139
    v_mfma_f32_16x16x32_bf16 v[220:223], v[76:79], a[108:111], v[220:223]
    ds_read_b128 v[76:79], v10 offset:23552
    v_mfma_f32_16x16x32_bf16 v[220:223], v[80:83], a[124:127], v[220:223]
    ds_read_b128 v[80:83], v10 offset:24576
    v_mfma_f32_16x16x32_bf16 v[220:223], v[84:87], a[140:143], v[220:223]
    ds_read_b128 v[84:87], v10 offset:26624
    s_waitcnt lgkmcnt(7)
    v_mfma_f32_16x16x32_bf16 v[192:195], v[88:91], a[144:147], v[192:195]
    s_waitcnt lgkmcnt(6)
    v_mfma_f32_16x16x32_bf16 v[192:195], v[92:95], a[160:163], v[192:195]
    s_add_u32 m0, s25, 61440
    s_waitcnt lgkmcnt(5)
    v_mfma_f32_16x16x32_bf16 v[192:195], v[64:67], a[176:179], v[192:195]
    s_add_u32 s30, s30, 12288
    v_mfma_f32_16x16x32_bf16 v[196:199], v[88:91], a[148:151], v[196:199]
    buffer_load_dwordx4 v3, s[12:15], s30 offen offset:0 sc1 lds
    v_mfma_f32_16x16x32_bf16 v[196:199], v[92:95], a[164:167], v[196:199]
    buffer_store_dwordx4 v[56:59], v12, s[36:39], s35 offen sc1
    v_mfma_f32_16x16x32_bf16 v[196:199], v[64:67], a[180:183], v[196:199]
    v_max_f32 v140, 0, v140
    v_max_f32 v141, 0, v141
    v_mfma_f32_16x16x32_bf16 v[200:203], v[88:91], a[152:155], v[200:203]
    v_max_f32 v142, 0, v142
    v_max_f32 v143, 0, v143
    v_mfma_f32_16x16x32_bf16 v[200:203], v[92:95], a[168:171], v[200:203]
    v_mul_f32 v140, v140, v156
    v_mul_f32 v141, v141, v157
    v_mfma_f32_16x16x32_bf16 v[200:203], v[64:67], a[184:187], v[200:203]
    v_mul_f32 v142, v142, v158
    v_mul_f32 v143, v143, v159
    v_mfma_f32_16x16x32_bf16 v[204:207], v[88:91], a[156:159], v[204:207]
    ds_read_b128 v[88:91], v10 offset:28672
    v_cvt_pk_bf16_f32 v62, v140, v141
    v_mfma_f32_16x16x32_bf16 v[204:207], v[92:95], a[172:175], v[204:207]
    ds_read_b128 v[92:95], v10 offset:25600
    v_cvt_pk_bf16_f32 v63, v142, v143
    v_mfma_f32_16x16x32_bf16 v[204:207], v[64:67], a[188:191], v[204:207]
    ds_read_b128 v[64:67], v10 offset:27648
    s_waitcnt lgkmcnt(7)
    v_mfma_f32_16x16x32_bf16 v[208:211], v[68:71], a[144:147], v[208:211]
    s_waitcnt lgkmcnt(6)
    v_mfma_f32_16x16x32_bf16 v[208:211], v[72:75], a[160:163], v[208:211]
    s_waitcnt lgkmcnt(5)
    v_mfma_f32_16x16x32_bf16 v[208:211], v[76:79], a[176:179], v[208:211]
    buffer_load_dwordx4 v3, s[12:15], s30 offen offset:1024 sc1 lds
    v_mfma_f32_16x16x32_bf16 v[212:215], v[68:71], a[148:151], v[212:215]
    buffer_store_dwordx4 v[60:63], v13, s[36:39], s35 offen sc1
    v_mfma_f32_16x16x32_bf16 v[212:215], v[72:75], a[164:167], v[212:215]
    s_add_u32 s35, s35, 8192
    v_mfma_f32_16x16x32_bf16 v[212:215], v[76:79], a[180:183], v[212:215]
    v_mfma_f32_16x16x32_bf16 v[216:219], v[68:71], a[152:155], v[216:219]
    v_mfma_f32_16x16x32_bf16 v[216:219], v[72:75], a[168:171], v[216:219]
    v_mfma_f32_16x16x32_bf16 v[216:219], v[76:79], a[184:187], v[216:219]
    v_mfma_f32_16x16x32_bf16 v[220:223], v[68:71], a[156:159], v[220:223]
    ds_read_b128 v[68:71], v10 offset:29696
    v_mfma_f32_16x16x32_bf16 v[220:223], v[72:75], a[172:175], v[220:223]
    ds_read_b128 v[72:75], v10 offset:30720
    v_mfma_f32_16x16x32_bf16 v[220:223], v[76:79], a[188:191], v[220:223]
    ds_read_b128 v[76:79], v10 offset:32768
    s_waitcnt lgkmcnt(7)
    v_mfma_f32_16x16x32_bf16 v[192:195], v[80:83], a[192:195], v[192:195]
    s_waitcnt lgkmcnt(6)
    v_mfma_f32_16x16x32_bf16 v[192:195], v[84:87], a[208:211], v[192:195]
    s_waitcnt lgkmcnt(5)
    v_mfma_f32_16x16x32_bf16 v[192:195], v[88:91], a[224:227], v[192:195]
    buffer_load_dwordx4 v3, s[12:15], s30 offen offset:2048 sc1 lds
    v_mfma_f32_16x16x32_bf16 v[196:199], v[80:83], a[196:199], v[196:199]
    v_mfma_f32_16x16x32_bf16 v[196:199], v[84:87], a[212:215], v[196:199]
    v_mfma_f32_16x16x32_bf16 v[196:199], v[88:91], a[228:231], v[196:199]
    v_mfma_f32_16x16x32_bf16 v[200:203], v[80:83], a[200:203], v[200:203]
    v_mfma_f32_16x16x32_bf16 v[200:203], v[84:87], a[216:219], v[200:203]
    v_mfma_f32_16x16x32_bf16 v[200:203], v[88:91], a[232:235], v[200:203]
    v_mfma_f32_16x16x32_bf16 v[204:207], v[80:83], a[204:207], v[204:207]
    ds_read_b128 v[80:83], v10 offset:34816
    v_mfma_f32_16x16x32_bf16 v[204:207], v[84:87], a[220:223], v[204:207]
    ds_read_b128 v[84:87], v10 offset:31744
    v_mfma_f32_16x16x32_bf16 v[204:207], v[88:91], a[236:239], v[204:207]
    ds_read_b128 v[88:91], v10 offset:33792
    s_waitcnt lgkmcnt(7)
    v_mfma_f32_16x16x32_bf16 v[208:211], v[92:95], a[192:195], v[208:211]
    s_waitcnt lgkmcnt(6)
    v_mfma_f32_16x16x32_bf16 v[208:211], v[64:67], a[208:211], v[208:211]
    s_add_u32 m0, s26, 0
    s_waitcnt lgkmcnt(5)
    v_mfma_f32_16x16x32_bf16 v[208:211], v[68:71], a[224:227], v[208:211]
    s_add_u32 s30, s30, 12288
    v_mfma_f32_16x16x32_bf16 v[212:215], v[92:95], a[196:199], v[212:215]
    buffer_load_dwordx4 v3, s[12:15], s30 offen offset:0 sc1 lds
    v_mfma_f32_16x16x32_bf16 v[212:215], v[64:67], a[212:215], v[212:215]
    v_mfma_f32_16x16x32_bf16 v[212:215], v[68:71], a[228:231], v[212:215]
    v_mfma_f32_16x16x32_bf16 v[216:219], v[92:95], a[200:203], v[216:219]
    v_mfma_f32_16x16x32_bf16 v[216:219], v[64:67], a[216:219], v[216:219]
    v_mfma_f32_16x16x32_bf16 v[216:219], v[68:71], a[232:235], v[216:219]
    s_waitcnt vmcnt(11)
    s_barrier
    v_mfma_f32_16x16x32_bf16 v[220:223], v[92:95], a[204:207], v[220:223]
    ds_read_b128 v[92:95], v10 offset:35840
    v_mfma_f32_16x16x32_bf16 v[220:223], v[64:67], a[220:223], v[220:223]
    ds_read_b128 v[64:67], v4 offset:0
    v_mfma_f32_16x16x32_bf16 v[220:223], v[68:71], a[236:239], v[220:223]
    ds_read_b128 v[68:71], v4 offset:2048
    s_waitcnt lgkmcnt(7)
    v_mfma_f32_16x16x32_bf16 v[192:195], v[72:75], a[240:243], v[192:195]
    s_waitcnt lgkmcnt(6)
    v_mfma_f32_16x16x32_bf16 v[192:195], v[76:79], v[224:227], v[192:195]
    s_waitcnt lgkmcnt(5)
    v_mfma_f32_16x16x32_bf16 v[192:195], v[80:83], v[240:243], v[192:195]
    buffer_load_dwordx4 v3, s[12:15], s30 offen offset:1024 sc1 lds
    v_mfma_f32_16x16x32_bf16 v[196:199], v[72:75], a[244:247], v[196:199]
    v_mfma_f32_16x16x32_bf16 v[196:199], v[76:79], v[228:231], v[196:199]
    v_mfma_f32_16x16x32_bf16 v[196:199], v[80:83], v[244:247], v[196:199]
    v_mfma_f32_16x16x32_bf16 v[200:203], v[72:75], a[248:251], v[200:203]
    v_mfma_f32_16x16x32_bf16 v[200:203], v[76:79], v[232:235], v[200:203]
    v_mfma_f32_16x16x32_bf16 v[200:203], v[80:83], v[248:251], v[200:203]
    v_mfma_f32_16x16x32_bf16 v[204:207], v[72:75], a[252:255], v[204:207]
    ds_read_b128 v[72:75], v4 offset:4096
    v_mfma_f32_16x16x32_bf16 v[204:207], v[76:79], v[236:239], v[204:207]
    ds_read_b128 v[76:79], v4 offset:1024
    v_mfma_f32_16x16x32_bf16 v[204:207], v[80:83], v[252:255], v[204:207]
    ds_read_b128 v[80:83], v4 offset:3072
    s_waitcnt lgkmcnt(7)
    v_mfma_f32_16x16x32_bf16 v[208:211], v[84:87], a[240:243], v[208:211]
    s_waitcnt lgkmcnt(6)
    v_mfma_f32_16x16x32_bf16 v[208:211], v[88:91], v[224:227], v[208:211]
    s_waitcnt lgkmcnt(5)
    v_mfma_f32_16x16x32_bf16 v[208:211], v[92:95], v[240:243], v[208:211]
    buffer_load_dwordx4 v3, s[12:15], s30 offen offset:2048 sc1 lds
    v_mfma_f32_16x16x32_bf16 v[212:215], v[84:87], a[244:247], v[212:215]
    v_mfma_f32_16x16x32_bf16 v[212:215], v[88:91], v[228:231], v[212:215]
    v_mfma_f32_16x16x32_bf16 v[212:215], v[92:95], v[244:247], v[212:215]
    v_mfma_f32_16x16x32_bf16 v[216:219], v[84:87], a[248:251], v[216:219]
    v_mfma_f32_16x16x32_bf16 v[216:219], v[88:91], v[232:235], v[216:219]
    v_mfma_f32_16x16x32_bf16 v[216:219], v[92:95], v[248:251], v[216:219]
    v_mfma_f32_16x16x32_bf16 v[220:223], v[84:87], a[252:255], v[220:223]
    ds_read_b128 v[84:87], v4 offset:5120
    v_mfma_f32_16x16x32_bf16 v[220:223], v[88:91], v[236:239], v[220:223]
    ds_read_b128 v[88:91], v4 offset:6144
    v_mfma_f32_16x16x32_bf16 v[220:223], v[92:95], v[252:255], v[220:223]
    ds_read_b128 v[92:95], v4 offset:8192
    s_waitcnt lgkmcnt(7)
    v_mfma_f32_16x16x32_bf16 v[96:99], v[64:67], a[0:3], 0
    s_waitcnt lgkmcnt(6)
    v_mfma_f32_16x16x32_bf16 v[96:99], v[68:71], a[16:19], v[96:99]
    s_add_u32 m0, s26, 12288
    s_waitcnt lgkmcnt(5)
    v_mfma_f32_16x16x32_bf16 v[96:99], v[72:75], a[32:35], v[96:99]
    s_add_u32 s30, s30, 12288
    v_mfma_f32_16x16x32_bf16 v[100:103], v[64:67], a[4:7], 0
    buffer_load_dwordx4 v3, s[12:15], s30 offen offset:0 sc1 lds
    v_mfma_f32_16x16x32_bf16 v[100:103], v[68:71], a[20:23], v[100:103]
    v_mfma_f32_16x16x32_bf16 v[100:103], v[72:75], a[36:39], v[100:103]
    v_mfma_f32_16x16x32_bf16 v[104:107], v[64:67], a[8:11], 0
    v_max_f32 v160, 0, v160
    v_max_f32 v161, 0, v161
    v_mfma_f32_16x16x32_bf16 v[104:107], v[68:71], a[24:27], v[104:107]
    v_max_f32 v162, 0, v162
    v_max_f32 v163, 0, v163
    v_mfma_f32_16x16x32_bf16 v[104:107], v[72:75], a[40:43], v[104:107]
    v_mul_f32 v160, v160, v176
    v_mul_f32 v161, v161, v177
    v_mfma_f32_16x16x32_bf16 v[108:111], v[64:67], a[12:15], 0
    ds_read_b128 v[64:67], v4 offset:10240
    v_mul_f32 v162, v162, v178
    v_mfma_f32_16x16x32_bf16 v[108:111], v[68:71], a[28:31], v[108:111]
    ds_read_b128 v[68:71], v4 offset:7168
    v_mul_f32 v163, v163, v179
    v_mfma_f32_16x16x32_bf16 v[108:111], v[72:75], a[44:47], v[108:111]
    ds_read_b128 v[72:75], v4 offset:9216
    s_waitcnt lgkmcnt(7)
    v_mfma_f32_16x16x32_bf16 v[112:115], v[76:79], a[0:3], 0
    v_cvt_pk_bf16_f32 v48, v160, v161
    s_waitcnt lgkmcnt(6)
    v_mfma_f32_16x16x32_bf16 v[112:115], v[80:83], a[16:19], v[112:115]
    v_cvt_pk_bf16_f32 v49, v162, v163
    s_waitcnt lgkmcnt(5)
    v_mfma_f32_16x16x32_bf16 v[112:115], v[84:87], a[32:35], v[112:115]
    buffer_load_dwordx4 v3, s[12:15], s30 offen offset:1024 sc1 lds
    v_mfma_f32_16x16x32_bf16 v[116:119], v[76:79], a[4:7], 0
    v_max_f32 v164, 0, v164
    v_max_f32 v165, 0, v165
    v_mfma_f32_16x16x32_bf16 v[116:119], v[80:83], a[20:23], v[116:119]
    v_max_f32 v166, 0, v166
    v_max_f32 v167, 0, v167
    v_mfma_f32_16x16x32_bf16 v[116:119], v[84:87], a[36:39], v[116:119]
    v_mul_f32 v164, v164, v180
    v_mul_f32 v165, v165, v181
    v_mfma_f32_16x16x32_bf16 v[120:123], v[76:79], a[8:11], 0
    v_mul_f32 v166, v166, v182
    v_mul_f32 v167, v167, v183
    v_mfma_f32_16x16x32_bf16 v[120:123], v[80:83], a[24:27], v[120:123]
    v_cvt_pk_bf16_f32 v52, v164, v165
    v_cvt_pk_bf16_f32 v53, v166, v167
    v_mfma_f32_16x16x32_bf16 v[120:123], v[84:87], a[40:43], v[120:123]
    v_max_f32 v168, 0, v168
    v_max_f32 v169, 0, v169
    v_mfma_f32_16x16x32_bf16 v[124:127], v[76:79], a[12:15], 0
    ds_read_b128 v[76:79], v4 offset:11264
    v_max_f32 v170, 0, v170
    v_mfma_f32_16x16x32_bf16 v[124:127], v[80:83], a[28:31], v[124:127]
    ds_read_b128 v[80:83], v4 offset:12288
    v_max_f32 v171, 0, v171
    v_mfma_f32_16x16x32_bf16 v[124:127], v[84:87], a[44:47], v[124:127]
    ds_read_b128 v[84:87], v4 offset:14336
    s_waitcnt lgkmcnt(7)
    v_mfma_f32_16x16x32_bf16 v[96:99], v[88:91], a[48:51], v[96:99]
    v_mul_f32 v168, v168, v184
    s_waitcnt lgkmcnt(6)
    v_mfma_f32_16x16x32_bf16 v[96:99], v[92:95], a[64:67], v[96:99]
    v_mul_f32 v169, v169, v185
    s_waitcnt lgkmcnt(5)
    v_mfma_f32_16x16x32_bf16 v[96:99], v[64:67], a[80:83], v[96:99]
    buffer_load_dwordx4 v3, s[12:15], s30 offen offset:2048 sc1 lds
    v_mfma_f32_16x16x32_bf16 v[100:103], v[88:91], a[52:55], v[100:103]
    v_mul_f32 v170, v170, v186
    v_mul_f32 v171, v171, v187
    v_mfma_f32_16x16x32_bf16 v[100:103], v[92:95], a[68:71], v[100:103]
    v_cvt_pk_bf16_f32 v56, v168, v169
    v_cvt_pk_bf16_f32 v57, v170, v171
    v_mfma_f32_16x16x32_bf16 v[100:103], v[64:67], a[84:87], v[100:103]
    v_max_f32 v172, 0, v172
    v_max_f32 v173, 0, v173
    v_mfma_f32_16x16x32_bf16 v[104:107], v[88:91], a[56:59], v[104:107]
    v_max_f32 v174, 0, v174
    v_max_f32 v175, 0, v175
    v_mfma_f32_16x16x32_bf16 v[104:107], v[92:95], a[72:75], v[104:107]
    v_mul_f32 v172, v172, v188
    v_mul_f32 v173, v173, v189
    v_mfma_f32_16x16x32_bf16 v[104:107], v[64:67], a[88:91], v[104:107]
    v_mul_f32 v174, v174, v190
    v_mul_f32 v175, v175, v191
    v_mfma_f32_16x16x32_bf16 v[108:111], v[88:91], a[60:63], v[108:111]
    ds_read_b128 v[88:91], v4 offset:16384
    v_cvt_pk_bf16_f32 v60, v172, v173
    v_mfma_f32_16x16x32_bf16 v[108:111], v[92:95], a[76:79], v[108:111]
    ds_read_b128 v[92:95], v4 offset:13312
    v_cvt_pk_bf16_f32 v61, v174, v175
    v_mfma_f32_16x16x32_bf16 v[108:111], v[64:67], a[92:95], v[108:111]
    ds_read_b128 v[64:67], v4 offset:15360
    s_waitcnt lgkmcnt(7)
    v_mfma_f32_16x16x32_bf16 v[112:115], v[68:71], a[48:51], v[112:115]
    v_max_f32 v192, 0, v192
    s_waitcnt lgkmcnt(6)
    v_mfma_f32_16x16x32_bf16 v[112:115], v[72:75], a[64:67], v[112:115]
    s_add_u32 m0, s26, 24576
    s_waitcnt lgkmcnt(5)
    v_mfma_f32_16x16x32_bf16 v[112:115], v[76:79], a[80:83], v[112:115]
    s_add_u32 s30, s30, 12288
    v_max_f32 v193, 0, v193
    v_mfma_f32_16x16x32_bf16 v[116:119], v[68:71], a[52:55], v[116:119]
    buffer_load_dwordx4 v3, s[12:15], s30 offen offset:0 sc1 lds
    v_mfma_f32_16x16x32_bf16 v[116:119], v[72:75], a[68:71], v[116:119]
    v_max_f32 v194, 0, v194
    v_max_f32 v195, 0, v195
    v_mfma_f32_16x16x32_bf16 v[116:119], v[76:79], a[84:87], v[116:119]
    v_mul_f32 v192, v192, v208
    v_mul_f32 v193, v193, v209
    v_mfma_f32_16x16x32_bf16 v[120:123], v[68:71], a[56:59], v[120:123]
    v_mul_f32 v194, v194, v210
    v_mul_f32 v195, v195, v211
    v_mfma_f32_16x16x32_bf16 v[120:123], v[72:75], a[72:75], v[120:123]
    v_cvt_pk_bf16_f32 v50, v192, v193
    v_cvt_pk_bf16_f32 v51, v194, v195
    v_mfma_f32_16x16x32_bf16 v[120:123], v[76:79], a[88:91], v[120:123]
    buffer_store_dwordx4 v[48:51], v3, s[36:39], s35 offen sc1
    v_mfma_f32_16x16x32_bf16 v[124:127], v[68:71], a[60:63], v[124:127]
    ds_read_b128 v[68:71], v4 offset:17408
    v_max_f32 v196, 0, v196
    v_mfma_f32_16x16x32_bf16 v[124:127], v[72:75], a[76:79], v[124:127]
    ds_read_b128 v[72:75], v4 offset:18432
    v_max_f32 v197, 0, v197
    v_mfma_f32_16x16x32_bf16 v[124:127], v[76:79], a[92:95], v[124:127]
    ds_read_b128 v[76:79], v4 offset:20480
    s_waitcnt lgkmcnt(7)
    v_mfma_f32_16x16x32_bf16 v[96:99], v[80:83], a[96:99], v[96:99]
    v_max_f32 v198, 0, v198
    s_waitcnt lgkmcnt(6)
    v_mfma_f32_16x16x32_bf16 v[96:99], v[84:87], a[112:115], v[96:99]
    v_max_f32 v199, 0, v199
    s_waitcnt lgkmcnt(5)
    v_mfma_f32_16x16x32_bf16 v[96:99], v[88:91], a[128:131], v[96:99]
    buffer_load_dwordx4 v3, s[12:15], s30 offen offset:1024 sc1 lds
    v_mfma_f32_16x16x32_bf16 v[100:103], v[80:83], a[100:103], v[100:103]
    v_mul_f32 v196, v196, v212
    v_mul_f32 v197, v197, v213
    v_mfma_f32_16x16x32_bf16 v[100:103], v[84:87], a[116:119], v[100:103]
    v_mul_f32 v198, v198, v214
    v_mul_f32 v199, v199, v215
    v_mfma_f32_16x16x32_bf16 v[100:103], v[88:91], a[132:135], v[100:103]
    v_cvt_pk_bf16_f32 v54, v196, v197
    v_cvt_pk_bf16_f32 v55, v198, v199
    v_mfma_f32_16x16x32_bf16 v[104:107], v[80:83], a[104:107], v[104:107]
    buffer_store_dwordx4 v[52:55], v11, s[36:39], s35 offen sc1
    v_mfma_f32_16x16x32_bf16 v[104:107], v[84:87], a[120:123], v[104:107]
    v_max_f32 v200, 0, v200
    v_max_f32 v201, 0, v201
    v_mfma_f32_16x16x32_bf16 v[104:107], v[88:91], a[136:139], v[104:107]
    v_max_f32 v202, 0, v202
    v_max_f32 v203, 0, v203
    v_mfma_f32_16x16x32_bf16 v[108:111], v[80:83], a[108:111], v[108:111]
    ds_read_b128 v[80:83], v4 offset:22528
    v_mul_f32 v200, v200, v216
    v_mfma_f32_16x16x32_bf16 v[108:111], v[84:87], a[124:127], v[108:111]
    ds_read_b128 v[84:87], v4 offset:19456
    v_mul_f32 v201, v201, v217
    v_mfma_f32_16x16x32_bf16 v[108:111], v[88:91], a[140:143], v[108:111]
    ds_read_b128 v[88:91], v4 offset:21504
    s_waitcnt lgkmcnt(7)
    v_mfma_f32_16x16x32_bf16 v[112:115], v[92:95], a[96:99], v[112:115]
    v_mul_f32 v202, v202, v218
    s_waitcnt lgkmcnt(6)
    v_mfma_f32_16x16x32_bf16 v[112:115], v[64:67], a[112:115], v[112:115]
    v_mul_f32 v203, v203, v219
    s_waitcnt lgkmcnt(5)
    v_mfma_f32_16x16x32_bf16 v[112:115], v[68:71], a[128:131], v[112:115]
    buffer_load_dwordx4 v3, s[12:15], s30 offen offset:2048 sc1 lds
    v_mfma_f32_16x16x32_bf16 v[116:119], v[92:95], a[100:103], v[116:119]
    v_cvt_pk_bf16_f32 v58, v200, v201
    v_cvt_pk_bf16_f32 v59, v202, v203
    v_mfma_f32_16x16x32_bf16 v[116:119], v[64:67], a[116:119], v[116:119]
    buffer_store_dwordx4 v[56:59], v12, s[36:39], s35 offen sc1
    v_mfma_f32_16x16x32_bf16 v[116:119], v[68:71], a[132:135], v[116:119]
    v_max_f32 v204, 0, v204
    v_max_f32 v205, 0, v205
    v_mfma_f32_16x16x32_bf16 v[120:123], v[92:95], a[104:107], v[120:123]
    v_max_f32 v206, 0, v206
    v_max_f32 v207, 0, v207
    v_mfma_f32_16x16x32_bf16 v[120:123], v[64:67], a[120:123], v[120:123]
    v_mul_f32 v204, v204, v220
    v_mul_f32 v205, v205, v221
    v_mfma_f32_16x16x32_bf16 v[120:123], v[68:71], a[136:139], v[120:123]
    v_mul_f32 v206, v206, v222
    v_mul_f32 v207, v207, v223
    v_mfma_f32_16x16x32_bf16 v[124:127], v[92:95], a[108:111], v[124:127]
    ds_read_b128 v[92:95], v4 offset:23552
    v_cvt_pk_bf16_f32 v62, v204, v205
    v_mfma_f32_16x16x32_bf16 v[124:127], v[64:67], a[124:127], v[124:127]
    ds_read_b128 v[64:67], v4 offset:24576
    v_cvt_pk_bf16_f32 v63, v206, v207
    v_mfma_f32_16x16x32_bf16 v[124:127], v[68:71], a[140:143], v[124:127]
    ds_read_b128 v[68:71], v4 offset:26624
    s_waitcnt lgkmcnt(7)
    v_mfma_f32_16x16x32_bf16 v[96:99], v[72:75], a[144:147], v[96:99]
    s_waitcnt lgkmcnt(6)
    v_mfma_f32_16x16x32_bf16 v[96:99], v[76:79], a[160:163], v[96:99]
    s_add_u32 m0, s26, 36864
    s_waitcnt lgkmcnt(5)
    v_mfma_f32_16x16x32_bf16 v[96:99], v[80:83], a[176:179], v[96:99]
    s_add_u32 s30, s30, 12288
    v_mfma_f32_16x16x32_bf16 v[100:103], v[72:75], a[148:151], v[100:103]
    buffer_load_dwordx4 v3, s[12:15], s30 offen offset:0 sc1 lds
    v_mfma_f32_16x16x32_bf16 v[100:103], v[76:79], a[164:167], v[100:103]
    buffer_store_dwordx4 v[60:63], v13, s[36:39], s35 offen sc1
    v_mfma_f32_16x16x32_bf16 v[100:103], v[80:83], a[180:183], v[100:103]
    s_add_u32 s35, s35, 8192
    v_mfma_f32_16x16x32_bf16 v[104:107], v[72:75], a[152:155], v[104:107]
    v_mfma_f32_16x16x32_bf16 v[104:107], v[76:79], a[168:171], v[104:107]
    v_mfma_f32_16x16x32_bf16 v[104:107], v[80:83], a[184:187], v[104:107]
    v_mfma_f32_16x16x32_bf16 v[108:111], v[72:75], a[156:159], v[108:111]
    ds_read_b128 v[72:75], v4 offset:28672
    v_mfma_f32_16x16x32_bf16 v[108:111], v[76:79], a[172:175], v[108:111]
    ds_read_b128 v[76:79], v4 offset:25600
    v_mfma_f32_16x16x32_bf16 v[108:111], v[80:83], a[188:191], v[108:111]
    ds_read_b128 v[80:83], v4 offset:27648
    s_waitcnt lgkmcnt(7)
    v_mfma_f32_16x16x32_bf16 v[112:115], v[84:87], a[144:147], v[112:115]
    s_waitcnt lgkmcnt(6)
    v_mfma_f32_16x16x32_bf16 v[112:115], v[88:91], a[160:163], v[112:115]
    s_waitcnt lgkmcnt(5)
    v_mfma_f32_16x16x32_bf16 v[112:115], v[92:95], a[176:179], v[112:115]
    buffer_load_dwordx4 v3, s[12:15], s30 offen offset:1024 sc1 lds
    v_mfma_f32_16x16x32_bf16 v[116:119], v[84:87], a[148:151], v[116:119]
    v_mfma_f32_16x16x32_bf16 v[116:119], v[88:91], a[164:167], v[116:119]
    v_mfma_f32_16x16x32_bf16 v[116:119], v[92:95], a[180:183], v[116:119]
    v_mfma_f32_16x16x32_bf16 v[120:123], v[84:87], a[152:155], v[120:123]
    v_mfma_f32_16x16x32_bf16 v[120:123], v[88:91], a[168:171], v[120:123]
    v_mfma_f32_16x16x32_bf16 v[120:123], v[92:95], a[184:187], v[120:123]
    v_mfma_f32_16x16x32_bf16 v[124:127], v[84:87], a[156:159], v[124:127]
    ds_read_b128 v[84:87], v4 offset:29696
    v_mfma_f32_16x16x32_bf16 v[124:127], v[88:91], a[172:175], v[124:127]
    ds_read_b128 v[88:91], v4 offset:30720
    v_mfma_f32_16x16x32_bf16 v[124:127], v[92:95], a[188:191], v[124:127]
    ds_read_b128 v[92:95], v4 offset:32768
    s_waitcnt lgkmcnt(7)
    v_mfma_f32_16x16x32_bf16 v[96:99], v[64:67], a[192:195], v[96:99]
    s_waitcnt lgkmcnt(6)
    v_mfma_f32_16x16x32_bf16 v[96:99], v[68:71], a[208:211], v[96:99]
    s_waitcnt lgkmcnt(5)
    v_mfma_f32_16x16x32_bf16 v[96:99], v[72:75], a[224:227], v[96:99]
    buffer_load_dwordx4 v3, s[12:15], s30 offen offset:2048 sc1 lds
    v_mfma_f32_16x16x32_bf16 v[100:103], v[64:67], a[196:199], v[100:103]
    v_mfma_f32_16x16x32_bf16 v[100:103], v[68:71], a[212:215], v[100:103]
    v_mfma_f32_16x16x32_bf16 v[100:103], v[72:75], a[228:231], v[100:103]
    v_mfma_f32_16x16x32_bf16 v[104:107], v[64:67], a[200:203], v[104:107]
    v_mfma_f32_16x16x32_bf16 v[104:107], v[68:71], a[216:219], v[104:107]
    v_mfma_f32_16x16x32_bf16 v[104:107], v[72:75], a[232:235], v[104:107]
    v_mfma_f32_16x16x32_bf16 v[108:111], v[64:67], a[204:207], v[108:111]
    ds_read_b128 v[64:67], v4 offset:34816
    v_mfma_f32_16x16x32_bf16 v[108:111], v[68:71], a[220:223], v[108:111]
    ds_read_b128 v[68:71], v4 offset:31744
    v_mfma_f32_16x16x32_bf16 v[108:111], v[72:75], a[236:239], v[108:111]
    ds_read_b128 v[72:75], v4 offset:33792
    s_waitcnt lgkmcnt(7)
    v_mfma_f32_16x16x32_bf16 v[112:115], v[76:79], a[192:195], v[112:115]
    s_waitcnt lgkmcnt(6)
    v_mfma_f32_16x16x32_bf16 v[112:115], v[80:83], a[208:211], v[112:115]
    s_add_u32 m0, s26, 49152
    s_waitcnt lgkmcnt(5)
    v_mfma_f32_16x16x32_bf16 v[112:115], v[84:87], a[224:227], v[112:115]
    s_add_u32 s30, s30, 12288
    v_mfma_f32_16x16x32_bf16 v[116:119], v[76:79], a[196:199], v[116:119]
    buffer_load_dwordx4 v3, s[12:15], s30 offen offset:0 sc1 lds
    v_mfma_f32_16x16x32_bf16 v[116:119], v[80:83], a[212:215], v[116:119]
    v_mfma_f32_16x16x32_bf16 v[116:119], v[84:87], a[228:231], v[116:119]
    v_mfma_f32_16x16x32_bf16 v[120:123], v[76:79], a[200:203], v[120:123]
    v_mfma_f32_16x16x32_bf16 v[120:123], v[80:83], a[216:219], v[120:123]
    v_mfma_f32_16x16x32_bf16 v[120:123], v[84:87], a[232:235], v[120:123]
    v_mfma_f32_16x16x32_bf16 v[124:127], v[76:79], a[204:207], v[124:127]
    ds_read_b128 v[76:79], v4 offset:35840
    v_mfma_f32_16x16x32_bf16 v[124:127], v[80:83], a[220:223], v[124:127]
    ds_read_b128 v[80:83], v8 offset:0
    v_mfma_f32_16x16x32_bf16 v[124:127], v[84:87], a[236:239], v[124:127]
    ds_read_b128 v[84:87], v8 offset:2048
    s_waitcnt lgkmcnt(7)
    v_mfma_f32_16x16x32_bf16 v[96:99], v[88:91], a[240:243], v[96:99]
    s_waitcnt lgkmcnt(6)
    v_mfma_f32_16x16x32_bf16 v[96:99], v[92:95], v[224:227], v[96:99]
    s_waitcnt lgkmcnt(5)
    v_mfma_f32_16x16x32_bf16 v[96:99], v[64:67], v[240:243], v[96:99]
    buffer_load_dwordx4 v3, s[12:15], s30 offen offset:1024 sc1 lds
    v_mfma_f32_16x16x32_bf16 v[100:103], v[88:91], a[244:247], v[100:103]
    v_mfma_f32_16x16x32_bf16 v[100:103], v[92:95], v[228:231], v[100:103]
    v_mfma_f32_16x16x32_bf16 v[100:103], v[64:67], v[244:247], v[100:103]
    v_mfma_f32_16x16x32_bf16 v[104:107], v[88:91], a[248:251], v[104:107]
    v_mfma_f32_16x16x32_bf16 v[104:107], v[92:95], v[232:235], v[104:107]
    v_mfma_f32_16x16x32_bf16 v[104:107], v[64:67], v[248:251], v[104:107]
    v_mfma_f32_16x16x32_bf16 v[108:111], v[88:91], a[252:255], v[108:111]
    ds_read_b128 v[88:91], v8 offset:4096
    v_mfma_f32_16x16x32_bf16 v[108:111], v[92:95], v[236:239], v[108:111]
    ds_read_b128 v[92:95], v8 offset:1024
    v_mfma_f32_16x16x32_bf16 v[108:111], v[64:67], v[252:255], v[108:111]
    ds_read_b128 v[64:67], v8 offset:3072
    s_waitcnt lgkmcnt(7)
    v_mfma_f32_16x16x32_bf16 v[112:115], v[68:71], a[240:243], v[112:115]
    s_waitcnt lgkmcnt(6)
    v_mfma_f32_16x16x32_bf16 v[112:115], v[72:75], v[224:227], v[112:115]
    s_waitcnt lgkmcnt(5)
    v_mfma_f32_16x16x32_bf16 v[112:115], v[76:79], v[240:243], v[112:115]
    buffer_load_dwordx4 v3, s[12:15], s30 offen offset:2048 sc1 lds
    v_mfma_f32_16x16x32_bf16 v[116:119], v[68:71], a[244:247], v[116:119]
    v_mfma_f32_16x16x32_bf16 v[116:119], v[72:75], v[228:231], v[116:119]
    v_mfma_f32_16x16x32_bf16 v[116:119], v[76:79], v[244:247], v[116:119]
    v_mfma_f32_16x16x32_bf16 v[120:123], v[68:71], a[248:251], v[120:123]
    v_mfma_f32_16x16x32_bf16 v[120:123], v[72:75], v[232:235], v[120:123]
    v_mfma_f32_16x16x32_bf16 v[120:123], v[76:79], v[248:251], v[120:123]
    v_mfma_f32_16x16x32_bf16 v[124:127], v[68:71], a[252:255], v[124:127]
    ds_read_b128 v[68:71], v8 offset:5120
    v_mfma_f32_16x16x32_bf16 v[124:127], v[72:75], v[236:239], v[124:127]
    ds_read_b128 v[72:75], v8 offset:6144
    v_mfma_f32_16x16x32_bf16 v[124:127], v[76:79], v[252:255], v[124:127]
    ds_read_b128 v[76:79], v8 offset:8192
    s_waitcnt lgkmcnt(7)
    v_mfma_f32_16x16x32_bf16 v[128:131], v[80:83], a[0:3], 0
    s_waitcnt lgkmcnt(6)
    v_mfma_f32_16x16x32_bf16 v[128:131], v[84:87], a[16:19], v[128:131]
    s_waitcnt lgkmcnt(5)
    v_mfma_f32_16x16x32_bf16 v[128:131], v[88:91], a[32:35], v[128:131]
    v_mfma_f32_16x16x32_bf16 v[132:135], v[80:83], a[4:7], 0
    v_mfma_f32_16x16x32_bf16 v[132:135], v[84:87], a[20:23], v[132:135]
    v_mfma_f32_16x16x32_bf16 v[132:135], v[88:91], a[36:39], v[132:135]
    v_mfma_f32_16x16x32_bf16 v[136:139], v[80:83], a[8:11], 0
    v_max_f32 v96, 0, v96
    v_mfma_f32_16x16x32_bf16 v[136:139], v[84:87], a[24:27], v[136:139]
    v_max_f32 v97, 0, v97
    v_mfma_f32_16x16x32_bf16 v[136:139], v[88:91], a[40:43], v[136:139]
    v_max_f32 v98, 0, v98
    v_mfma_f32_16x16x32_bf16 v[140:143], v[80:83], a[12:15], 0
    ds_read_b128 v[80:83], v8 offset:10240
    v_max_f32 v99, 0, v99
    v_mfma_f32_16x16x32_bf16 v[140:143], v[84:87], a[28:31], v[140:143]
    ds_read_b128 v[84:87], v8 offset:7168
    v_mul_f32 v96, v96, v112
    v_mfma_f32_16x16x32_bf16 v[140:143], v[88:91], a[44:47], v[140:143]
    ds_read_b128 v[88:91], v8 offset:9216
    s_waitcnt lgkmcnt(7)
    v_mfma_f32_16x16x32_bf16 v[144:147], v[92:95], a[0:3], 0
    v_mul_f32 v97, v97, v113
    s_waitcnt lgkmcnt(6)
    v_mfma_f32_16x16x32_bf16 v[144:147], v[64:67], a[16:19], v[144:147]
    v_mul_f32 v98, v98, v114
    s_waitcnt lgkmcnt(5)
    v_mfma_f32_16x16x32_bf16 v[144:147], v[68:71], a[32:35], v[144:147]
    v_mul_f32 v99, v99, v115
    v_mfma_f32_16x16x32_bf16 v[148:151], v[92:95], a[4:7], 0
    buffer_load_dword v22, v42, s[56:59], 0 offen sc1
    v_mfma_f32_16x16x32_bf16 v[148:151], v[64:67], a[20:23], v[148:151]
    v_cvt_pk_bf16_f32 v48, v96, v97
    v_mfma_f32_16x16x32_bf16 v[148:151], v[68:71], a[36:39], v[148:151]
    v_cvt_pk_bf16_f32 v49, v98, v99
    v_mfma_f32_16x16x32_bf16 v[152:155], v[92:95], a[8:11], 0
    v_max_f32 v100, 0, v100
    v_mfma_f32_16x16x32_bf16 v[152:155], v[64:67], a[24:27], v[152:155]
    v_max_f32 v101, 0, v101
    v_mfma_f32_16x16x32_bf16 v[152:155], v[68:71], a[40:43], v[152:155]
    s_waitcnt vmcnt(14)
    s_barrier
    v_mfma_f32_16x16x32_bf16 v[156:159], v[92:95], a[12:15], 0
    ds_read_b128 v[92:95], v8 offset:11264
    s_add_u32 m0, s26, 61440
    v_mfma_f32_16x16x32_bf16 v[156:159], v[64:67], a[28:31], v[156:159]
    ds_read_b128 v[64:67], v8 offset:12288
    s_add_u32 s30, s30, 12288
    v_mfma_f32_16x16x32_bf16 v[156:159], v[68:71], a[44:47], v[156:159]
    ds_read_b128 v[68:71], v8 offset:14336
    s_waitcnt lgkmcnt(7)
    v_mfma_f32_16x16x32_bf16 v[128:131], v[72:75], a[48:51], v[128:131]
    v_max_f32 v102, 0, v102
    s_waitcnt lgkmcnt(6)
    v_mfma_f32_16x16x32_bf16 v[128:131], v[76:79], a[64:67], v[128:131]
    v_max_f32 v103, 0, v103
    s_waitcnt lgkmcnt(5)
    v_mfma_f32_16x16x32_bf16 v[128:131], v[80:83], a[80:83], v[128:131]
    buffer_load_dwordx4 v3, s[12:15], s30 offen offset:0 sc1 lds
    v_mfma_f32_16x16x32_bf16 v[132:135], v[72:75], a[52:55], v[132:135]
    v_mul_f32 v100, v100, v116
    v_mfma_f32_16x16x32_bf16 v[132:135], v[76:79], a[68:71], v[132:135]
    v_mul_f32 v101, v101, v117
    v_mfma_f32_16x16x32_bf16 v[132:135], v[80:83], a[84:87], v[132:135]
    v_mul_f32 v102, v102, v118
    v_mfma_f32_16x16x32_bf16 v[136:139], v[72:75], a[56:59], v[136:139]
    buffer_load_dwordx4 v3, s[12:15], s30 offen offset:1024 sc1 lds
    v_mfma_f32_16x16x32_bf16 v[136:139], v[76:79], a[72:75], v[136:139]
    v_mul_f32 v103, v103, v119
    v_mfma_f32_16x16x32_bf16 v[136:139], v[80:83], a[88:91], v[136:139]
    v_cvt_pk_bf16_f32 v52, v100, v101
    v_mfma_f32_16x16x32_bf16 v[140:143], v[72:75], a[60:63], v[140:143]
    ds_read_b128 v[72:75], v8 offset:16384
    v_cvt_pk_bf16_f32 v53, v102, v103
    v_mfma_f32_16x16x32_bf16 v[140:143], v[76:79], a[76:79], v[140:143]
    ds_read_b128 v[76:79], v8 offset:13312
    v_max_f32 v104, 0, v104
    v_mfma_f32_16x16x32_bf16 v[140:143], v[80:83], a[92:95], v[140:143]
    ds_read_b128 v[80:83], v8 offset:15360
    s_waitcnt lgkmcnt(7)
    v_mfma_f32_16x16x32_bf16 v[144:147], v[84:87], a[48:51], v[144:147]
    v_max_f32 v105, 0, v105
    s_waitcnt lgkmcnt(6)
    v_mfma_f32_16x16x32_bf16 v[144:147], v[88:91], a[64:67], v[144:147]
    v_max_f32 v106, 0, v106
    s_waitcnt lgkmcnt(5)
    v_mfma_f32_16x16x32_bf16 v[144:147], v[92:95], a[80:83], v[144:147]
    buffer_load_dwordx4 v3, s[12:15], s30 offen offset:2048 sc1 lds
    v_mfma_f32_16x16x32_bf16 v[148:151], v[84:87], a[52:55], v[148:151]
    s_add_u32 m0, s25, 0
    s_add_u32 s30, s30, 12288
    v_mfma_f32_16x16x32_bf16 v[148:151], v[88:91], a[68:71], v[148:151]
    buffer_load_dwordx4 v3, s[12:15], s30 offen offset:0 sc1 lds
    v_mfma_f32_16x16x32_bf16 v[148:151], v[92:95], a[84:87], v[148:151]
    v_max_f32 v107, 0, v107
    v_mfma_f32_16x16x32_bf16 v[152:155], v[84:87], a[56:59], v[152:155]
    v_mul_f32 v104, v104, v120
    v_mfma_f32_16x16x32_bf16 v[152:155], v[88:91], a[72:75], v[152:155]
    v_mul_f32 v105, v105, v121
    v_mfma_f32_16x16x32_bf16 v[152:155], v[92:95], a[88:91], v[152:155]
    v_mul_f32 v106, v106, v122
    v_mfma_f32_16x16x32_bf16 v[156:159], v[84:87], a[60:63], v[156:159]
    ds_read_b128 v[84:87], v8 offset:17408
    v_mul_f32 v107, v107, v123
    v_mfma_f32_16x16x32_bf16 v[156:159], v[88:91], a[76:79], v[156:159]
    ds_read_b128 v[88:91], v8 offset:18432
    v_cvt_pk_bf16_f32 v56, v104, v105
    v_mfma_f32_16x16x32_bf16 v[156:159], v[92:95], a[92:95], v[156:159]
    ds_read_b128 v[92:95], v8 offset:20480
    s_waitcnt lgkmcnt(7)
    v_mfma_f32_16x16x32_bf16 v[128:131], v[64:67], a[96:99], v[128:131]
    v_cvt_pk_bf16_f32 v57, v106, v107
    s_waitcnt lgkmcnt(6)
    v_mfma_f32_16x16x32_bf16 v[128:131], v[68:71], a[112:115], v[128:131]
    v_max_f32 v108, 0, v108
    s_waitcnt lgkmcnt(5)
    v_mfma_f32_16x16x32_bf16 v[128:131], v[72:75], a[128:131], v[128:131]
    buffer_load_dwordx4 v3, s[12:15], s30 offen offset:1024 sc1 lds
    v_mfma_f32_16x16x32_bf16 v[132:135], v[64:67], a[100:103], v[132:135]
    v_max_f32 v109, 0, v109
    v_mfma_f32_16x16x32_bf16 v[132:135], v[68:71], a[116:119], v[132:135]
    v_max_f32 v110, 0, v110
    v_mfma_f32_16x16x32_bf16 v[132:135], v[72:75], a[132:135], v[132:135]
    v_max_f32 v111, 0, v111
    v_mfma_f32_16x16x32_bf16 v[136:139], v[64:67], a[104:107], v[136:139]
    v_mul_f32 v108, v108, v124
    v_mfma_f32_16x16x32_bf16 v[136:139], v[68:71], a[120:123], v[136:139]
    v_mul_f32 v109, v109, v125
    v_mfma_f32_16x16x32_bf16 v[136:139], v[72:75], a[136:139], v[136:139]
    v_mul_f32 v110, v110, v126
    v_mfma_f32_16x16x32_bf16 v[140:143], v[64:67], a[108:111], v[140:143]
    ds_read_b128 v[64:67], v8 offset:22528
    v_mul_f32 v111, v111, v127
    v_mfma_f32_16x16x32_bf16 v[140:143], v[68:71], a[124:127], v[140:143]
    ds_read_b128 v[68:71], v8 offset:19456
    v_cvt_pk_bf16_f32 v60, v108, v109
    v_mfma_f32_16x16x32_bf16 v[140:143], v[72:75], a[140:143], v[140:143]
    ds_read_b128 v[72:75], v8 offset:21504
    s_waitcnt lgkmcnt(7)
    v_mfma_f32_16x16x32_bf16 v[144:147], v[76:79], a[96:99], v[144:147]
    v_cvt_pk_bf16_f32 v61, v110, v111
    s_waitcnt lgkmcnt(6)
    v_mfma_f32_16x16x32_bf16 v[144:147], v[80:83], a[112:115], v[144:147]
    s_waitcnt lgkmcnt(5)
    v_mfma_f32_16x16x32_bf16 v[144:147], v[84:87], a[128:131], v[144:147]
    buffer_load_dwordx4 v3, s[12:15], s30 offen offset:2048 sc1 lds
    v_mfma_f32_16x16x32_bf16 v[148:151], v[76:79], a[100:103], v[148:151]
    v_mfma_f32_16x16x32_bf16 v[148:151], v[80:83], a[116:119], v[148:151]
    v_mfma_f32_16x16x32_bf16 v[148:151], v[84:87], a[132:135], v[148:151]
    v_mfma_f32_16x16x32_bf16 v[152:155], v[76:79], a[104:107], v[152:155]
    v_mfma_f32_16x16x32_bf16 v[152:155], v[80:83], a[120:123], v[152:155]
    v_mfma_f32_16x16x32_bf16 v[152:155], v[84:87], a[136:139], v[152:155]
    v_mfma_f32_16x16x32_bf16 v[156:159], v[76:79], a[108:111], v[156:159]
    ds_read_b128 v[76:79], v8 offset:23552
    v_mfma_f32_16x16x32_bf16 v[156:159], v[80:83], a[124:127], v[156:159]
    ds_read_b128 v[80:83], v8 offset:24576
    s_waitcnt vmcnt(6)
    v_cmp_ne_u32 vcc, v21, v22
    s_cbranch_vccnz f_slow2
f_back2:
    v_mfma_f32_16x16x32_bf16 v[156:159], v[84:87], a[140:143], v[156:159]
    ds_read_b128 v[84:87], v8 offset:26624
    s_waitcnt lgkmcnt(7)
    v_mfma_f32_16x16x32_bf16 v[128:131], v[88:91], a[144:147], v[128:131]
    s_add_u32 m0, s25, 12288
    s_waitcnt lgkmcnt(6)
    v_mfma_f32_16x16x32_bf16 v[128:131], v[92:95], a[160:163], v[128:131]
    s_add_u32 s30, s30, 12288
    s_waitcnt lgkmcnt(5)
    v_mfma_f32_16x16x32_bf16 v[128:131], v[64:67], a[176:179], v[128:131]
    buffer_load_dwordx4 v3, s[12:15], s30 offen offset:0 sc1 lds
    v_mfma_f32_16x16x32_bf16 v[132:135], v[88:91], a[148:151], v[132:135]
    v_mfma_f32_16x16x32_bf16 v[132:135], v[92:95], a[164:167], v[132:135]
    v_mfma_f32_16x16x32_bf16 v[132:135], v[64:67], a[180:183], v[132:135]
    v_mfma_f32_16x16x32_bf16 v[136:139], v[88:91], a[152:155], v[136:139]
    v_mfma_f32_16x16x32_bf16 v[136:139], v[92:95], a[168:171], v[136:139]
    v_mfma_f32_16x16x32_bf16 v[136:139], v[64:67], a[184:187], v[136:139]
    v_mfma_f32_16x16x32_bf16 v[140:143], v[88:91], a[156:159], v[140:143]
    ds_read_b128 v[88:91], v8 offset:28672
    v_mfma_f32_16x16x32_bf16 v[140:143], v[92:95], a[172:175], v[140:143]
    ds_read_b128 v[92:95], v8 offset:25600
    v_mfma_f32_16x16x32_bf16 v[140:143], v[64:67], a[188:191], v[140:143]
    ds_read_b128 v[64:67], v8 offset:27648
    s_waitcnt lgkmcnt(7)
    v_mfma_f32_16x16x32_bf16 v[144:147], v[68:71], a[144:147], v[144:147]
    s_waitcnt lgkmcnt(6)
    v_mfma_f32_16x16x32_bf16 v[144:147], v[72:75], a[160:163], v[144:147]
    s_waitcnt lgkmcnt(5)
    v_mfma_f32_16x16x32_bf16 v[144:147], v[76:79], a[176:179], v[144:147]
    buffer_load_dwordx4 v3, s[12:15], s30 offen offset:1024 sc1 lds
    v_mfma_f32_16x16x32_bf16 v[148:151], v[68:71], a[148:151], v[148:151]
    v_mfma_f32_16x16x32_bf16 v[148:151], v[72:75], a[164:167], v[148:151]
    v_mfma_f32_16x16x32_bf16 v[148:151], v[76:79], a[180:183], v[148:151]
    v_mfma_f32_16x16x32_bf16 v[152:155], v[68:71], a[152:155], v[152:155]
    v_mfma_f32_16x16x32_bf16 v[152:155], v[72:75], a[168:171], v[152:155]
    v_mfma_f32_16x16x32_bf16 v[152:155], v[76:79], a[184:187], v[152:155]
    v_mfma_f32_16x16x32_bf16 v[156:159], v[68:71], a[156:159], v[156:159]
    ds_read_b128 v[68:71], v8 offset:29696
    v_mfma_f32_16x16x32_bf16 v[156:159], v[72:75], a[172:175], v[156:159]
    ds_read_b128 v[72:75], v8 offset:30720
    v_mfma_f32_16x16x32_bf16 v[156:159], v[76:79], a[188:191], v[156:159]
    ds_read_b128 v[76:79], v8 offset:32768
    s_waitcnt lgkmcnt(7)
    v_mfma_f32_16x16x32_bf16 v[128:131], v[80:83], a[192:195], v[128:131]
    s_waitcnt lgkmcnt(6)
    v_mfma_f32_16x16x32_bf16 v[128:131], v[84:87], a[208:211], v[128:131]
    s_waitcnt lgkmcnt(5)
    v_mfma_f32_16x16x32_bf16 v[128:131], v[88:91], a[224:227], v[128:131]
    buffer_load_dwordx4 v3, s[12:15], s30 offen offset:2048 sc1 lds
    v_mfma_f32_16x16x32_bf16 v[132:135], v[80:83], a[196:199], v[132:135]
    v_mfma_f32_16x16x32_bf16 v[132:135], v[84:87], a[212:215], v[132:135]
    v_mfma_f32_16x16x32_bf16 v[132:135], v[88:91], a[228:231], v[132:135]
    v_mfma_f32_16x16x32_bf16 v[136:139], v[80:83], a[200:203], v[136:139]
    v_mfma_f32_16x16x32_bf16 v[136:139], v[84:87], a[216:219], v[136:139]
    v_mfma_f32_16x16x32_bf16 v[136:139], v[88:91], a[232:235], v[136:139]
    v_mfma_f32_16x16x32_bf16 v[140:143], v[80:83], a[204:207], v[140:143]
    ds_read_b128 v[80:83], v8 offset:34816
    v_mfma_f32_16x16x32_bf16 v[140:143], v[84:87], a[220:223], v[140:143]
    ds_read_b128 v[84:87], v8 offset:31744
    v_mfma_f32_16x16x32_bf16 v[140:143], v[88:91], a[236:239], v[140:143]
    ds_read_b128 v[88:91], v8 offset:33792
    s_waitcnt lgkmcnt(7)
    v_mfma_f32_16x16x32_bf16 v[144:147], v[92:95], a[192:195], v[144:147]
    s_add_u32 m0, s25, 24576
    s_waitcnt lgkmcnt(6)
    v_mfma_f32_16x16x32_bf16 v[144:147], v[64:67], a[208:211], v[144:147]
    s_add_u32 s30, s30, 12288
    s_waitcnt lgkmcnt(5)
    v_mfma_f32_16x16x32_bf16 v[144:147], v[68:71], a[224:227], v[144:147]
    buffer_load_dwordx4 v3, s[12:15], s30 offen offset:0 sc1 lds
    v_mfma_f32_16x16x32_bf16 v[148:151], v[92:95], a[196:199], v[148:151]
    v_mfma_f32_16x16x32_bf16 v[148:151], v[64:67], a[212:215], v[148:151]
    v_mfma_f32_16x16x32_bf16 v[148:151], v[68:71], a[228:231], v[148:151]
    v_mfma_f32_16x16x32_bf16 v[152:155], v[92:95], a[200:203], v[152:155]
    v_mfma_f32_16x16x32_bf16 v[152:155], v[64:67], a[216:219], v[152:155]
    v_mfma_f32_16x16x32_bf16 v[152:155], v[68:71], a[232:235], v[152:155]
    v_mfma_f32_16x16x32_bf16 v[156:159], v[92:95], a[204:207], v[156:159]
    ds_read_b128 v[92:95], v8 offset:35840
    v_mfma_f32_16x16x32_bf16 v[156:159], v[64:67], a[220:223], v[156:159]
    ds_read_b128 v[64:67], v9 offset:0
    v_mfma_f32_16x16x32_bf16 v[156:159], v[68:71], a[236:239], v[156:159]
    ds_read_b128 v[68:71], v9 offset:2048
    s_waitcnt lgkmcnt(7)
    v_mfma_f32_16x16x32_bf16 v[128:131], v[72:75], a[240:243], v[128:131]
    s_waitcnt lgkmcnt(6)
    v_mfma_f32_16x16x32_bf16 v[128:131], v[76:79], v[224:227], v[128:131]
    s_waitcnt lgkmcnt(5)
    v_mfma_f32_16x16x32_bf16 v[128:131], v[80:83], v[240:243], v[128:131]
    buffer_load_dwordx4 v3, s[12:15], s30 offen offset:1024 sc1 lds
    v_mfma_f32_16x16x32_bf16 v[132:135], v[72:75], a[244:247], v[132:135]
    v_mfma_f32_16x16x32_bf16 v[132:135], v[76:79], v[228:231], v[132:135]
    v_mfma_f32_16x16x32_bf16 v[132:135], v[80:83], v[244:247], v[132:135]
    v_mfma_f32_16x16x32_bf16 v[136:139], v[72:75], a[248:251], v[136:139]
    v_mfma_f32_16x16x32_bf16 v[136:139], v[76:79], v[232:235], v[136:139]
    v_mfma_f32_16x16x32_bf16 v[136:139], v[80:83], v[248:251], v[136:139]
    v_mfma_f32_16x16x32_bf16 v[140:143], v[72:75], a[252:255], v[140:143]
    ds_read_b128 v[72:75], v9 offset:4096
    v_mfma_f32_16x16x32_bf16 v[140:143], v[76:79], v[236:239], v[140:143]
    ds_read_b128 v[76:79], v9 offset:1024
    v_mfma_f32_16x16x32_bf16 v[140:143], v[80:83], v[252:255], v[140:143]
    ds_read_b128 v[80:83], v9 offset:3072
    s_waitcnt lgkmcnt(7)
    v_mfma_f32_16x16x32_bf16 v[144:147], v[84:87], a[240:243], v[144:147]
    s_waitcnt lgkmcnt(6)
    v_mfma_f32_16x16x32_bf16 v[144:147], v[88:91], v[224:227], v[144:147]
    s_waitcnt lgkmcnt(5)
    v_mfma_f32_16x16x32_bf16 v[144:147], v[92:95], v[240:243], v[144:147]
    buffer_load_dwordx4 v3, s[12:15], s30 offen offset:2048 sc1 lds
    v_mfma_f32_16x16x32_bf16 v[148:151], v[84:87], a[244:247], v[148:151]
    v_mfma_f32_16x16x32_bf16 v[148:151], v[88:91], v[228:231], v[148:151]
    v_mfma_f32_16x16x32_bf16 v[148:151], v[92:95], v[244:247], v[148:151]
    v_mfma_f32_16x16x32_bf16 v[152:155], v[84:87], a[248:251], v[152:155]
    v_mfma_f32_16x16x32_bf16 v[152:155], v[88:91], v[232:235], v[152:155]
    v_mfma_f32_16x16x32_bf16 v[152:155], v[92:95], v[248:251], v[152:155]
    v_mfma_f32_16x16x32_bf16 v[156:159], v[84:87], a[252:255], v[156:159]
    ds_read_b128 v[84:87], v9 offset:5120
    v_mfma_f32_16x16x32_bf16 v[156:159], v[88:91], v[236:239], v[156:159]
    ds_read_b128 v[88:91], v9 offset:6144
    v_mfma_f32_16x16x32_bf16 v[156:159], v[92:95], v[252:255], v[156:159]
    ds_read_b128 v[92:95], v9 offset:8192
    s_waitcnt lgkmcnt(7)
    v_mfma_f32_16x16x32_bf16 v[96:99], v[64:67], a[0:3], 0
    s_waitcnt lgkmcnt(6)
    v_mfma_f32_16x16x32_bf16 v[96:99], v[68:71], a[16:19], v[96:99]
    s_waitcnt lgkmcnt(5)
    v_mfma_f32_16x16x32_bf16 v[96:99], v[72:75], a[32:35], v[96:99]
    v_mfma_f32_16x16x32_bf16 v[100:103], v[64:67], a[4:7], 0
    v_mfma_f32_16x16x32_bf16 v[100:103], v[68:71], a[20:23], v[100:103]
    v_mfma_f32_16x16x32_bf16 v[100:103], v[72:75], a[36:39], v[100:103]
    v_mfma_f32_16x16x32_bf16 v[104:107], v[64:67], a[8:11], 0
    v_max_f32 v128, 0, v128
    v_max_f32 v129, 0, v129
    v_mfma_f32_16x16x32_bf16 v[104:107], v[68:71], a[24:27], v[104:107]
    v_max_f32 v130, 0, v130
    v_max_f32 v131, 0, v131
    v_mfma_f32_16x16x32_bf16 v[104:107], v[72:75], a[40:43], v[104:107]
    v_mul_f32 v128, v128, v144
    v_mul_f32 v129, v129, v145
    v_mfma_f32_16x16x32_bf16 v[108:111], v[64:67], a[12:15], 0
    ds_read_b128 v[64:67], v9 offset:10240
    v_mul_f32 v130, v130, v146
    v_mfma_f32_16x16x32_bf16 v[108:111], v[68:71], a[28:31], v[108:111]
    ds_read_b128 v[68:71], v9 offset:7168
    v_mul_f32 v131, v131, v147
    v_mfma_f32_16x16x32_bf16 v[108:111], v[72:75], a[44:47], v[108:111]
    ds_read_b128 v[72:75], v9 offset:9216
    s_waitcnt lgkmcnt(7)
    v_mfma_f32_16x16x32_bf16 v[112:115], v[76:79], a[0:3], 0
    v_cvt_pk_bf16_f32 v50, v128, v129
    s_waitcnt lgkmcnt(6)
    v_mfma_f32_16x16x32_bf16 v[112:115], v[80:83], a[16:19], v[112:115]
    v_cvt_pk_bf16_f32 v51, v130, v131
    s_waitcnt lgkmcnt(5)
    v_mfma_f32_16x16x32_bf16 v[112:115], v[84:87], a[32:35], v[112:115]
    buffer_store_dwordx4 v[48:51], v3, s[36:39], s35 offen sc1
    v_mfma_f32_16x16x32_bf16 v[116:119], v[76:79], a[4:7], 0
    v_max_f32 v132, 0, v132
    v_max_f32 v133, 0, v133
    v_mfma_f32_16x16x32_bf16 v[116:119], v[80:83], a[20:23], v[116:119]
    v_max_f32 v134, 0, v134
    v_max_f32 v135, 0, v135
    v_mfma_f32_16x16x32_bf16 v[116:119], v[84:87], a[36:39], v[116:119]
    v_mul_f32 v132, v132, v148
    v_mul_f32 v133, v133, v149
    v_mfma_f32_16x16x32_bf16 v[120:123], v[76:79], a[8:11], 0
    v_mul_f32 v134, v134, v150
    v_mul_f32 v135, v135, v151
    v_mfma_f32_16x16x32_bf16 v[120:123], v[80:83], a[24:27], v[120:123]
    v_cvt_pk_bf16_f32 v54, v132, v133
    v_cvt_pk_bf16_f32 v55, v134, v135
    v_mfma_f32_16x16x32_bf16 v[120:123], v[84:87], a[40:43], v[120:123]
    buffer_store_dwordx4 v[52:55], v11, s[36:39], s35 offen sc1
    v_mfma_f32_16x16x32_bf16 v[124:127], v[76:79], a[12:15], 0
    ds_read_b128 v[76:79], v9 offset:11264
    v_max_f32 v136, 0, v136
    v_mfma_f32_16x16x32_bf16 v[124:127], v[80:83], a[28:31], v[124:127]
    ds_read_b128 v[80:83], v9 offset:12288
    v_max_f32 v137, 0, v137
    v_mfma_f32_16x16x32_bf16 v[124:127], v[84:87], a[44:47], v[124:127]
    ds_read_b128 v[84:87], v9 offset:14336
    s_waitcnt lgkmcnt(7)
    v_mfma_f32_16x16x32_bf16 v[96:99], v[88:91], a[48:51], v[96:99]
    v_max_f32 v138, 0, v138
    s_waitcnt lgkmcnt(6)
    v_mfma_f32_16x16x32_bf16 v[96:99], v[92:95], a[64:67], v[96:99]
    v_max_f32 v139, 0, v139
    s_waitcnt lgkmcnt(5)
    v_mfma_f32_16x16x32_bf16 v[96:99], v[64:67], a[80:83], v[96:99]
    v_mul_f32 v136, v136, v152
    v_mul_f32 v137, v137, v153
    v_mfma_f32_16x16x32_bf16 v[100:103], v[88:91], a[52:55], v[100:103]
    v_mul_f32 v138, v138, v154
    v_mul_f32 v139, v139, v155
    v_mfma_f32_16x16x32_bf16 v[100:103], v[92:95], a[68:71], v[100:103]
    v_cvt_pk_bf16_f32 v58, v136, v137
    v_cvt_pk_bf16_f32 v59, v138, v139
    v_mfma_f32_16x16x32_bf16 v[100:103], v[64:67], a[84:87], v[100:103]
    buffer_store_dwordx4 v[56:59], v12, s[36:39], s35 offen sc1
    v_mfma_f32_16x16x32_bf16 v[104:107], v[88:91], a[56:59], v[104:107]
    v_max_f32 v140, 0, v140
    v_max_f32 v141, 0, v141
    v_mfma_f32_16x16x32_bf16 v[104:107], v[92:95], a[72:75], v[104:107]
    v_max_f32 v142, 0, v142
    v_max_f32 v143, 0, v143
    v_mfma_f32_16x16x32_bf16 v[104:107], v[64:67], a[88:91], v[104:107]
    v_mul_f32 v140, v140, v156
    v_mul_f32 v141, v141, v157
    v_mfma_f32_16x16x32_bf16 v[108:111], v[88:91], a[60:63], v[108:111]
    ds_read_b128 v[88:91], v9 offset:16384
    v_mul_f32 v142, v142, v158
    v_mfma_f32_16x16x32_bf16 v[108:111], v[92:95], a[76:79], v[108:111]
    ds_read_b128 v[92:95], v9 offset:13312
    v_mul_f32 v143, v143, v159
    v_mfma_f32_16x16x32_bf16 v[108:111], v[64:67], a[92:95], v[108:111]
    ds_read_b128 v[64:67], v9 offset:15360
    s_waitcnt lgkmcnt(7)
    v_mfma_f32_16x16x32_bf16 v[112:115], v[68:71], a[48:51], v[112:115]
    v_cvt_pk_bf16_f32 v62, v140, v141
    s_waitcnt lgkmcnt(6)
    v_mfma_f32_16x16x32_bf16 v[112:115], v[72:75], a[64:67], v[112:115]
    v_cvt_pk_bf16_f32 v63, v142, v143
    s_waitcnt lgkmcnt(5)
    v_mfma_f32_16x16x32_bf16 v[112:115], v[76:79], a[80:83], v[112:115]
    buffer_store_dwordx4 v[60:63], v13, s[36:39], s35 offen sc1
    v_mfma_f32_16x16x32_bf16 v[116:119], v[68:71], a[52:55], v[116:119]
    s_add_u32 s35, s35, 8192
    v_mfma_f32_16x16x32_bf16 v[116:119], v[72:75], a[68:71], v[116:119]
    v_mfma_f32_16x16x32_bf16 v[116:119], v[76:79], a[84:87], v[116:119]
    v_mfma_f32_16x16x32_bf16 v[120:123], v[68:71], a[56:59], v[120:123]
    v_mfma_f32_16x16x32_bf16 v[120:123], v[72:75], a[72:75], v[120:123]
    v_mfma_f32_16x16x32_bf16 v[120:123], v[76:79], a[88:91], v[120:123]
    v_mfma_f32_16x16x32_bf16 v[124:127], v[68:71], a[60:63], v[124:127]
    ds_read_b128 v[68:71], v9 offset:17408
    v_mfma_f32_16x16x32_bf16 v[124:127], v[72:75], a[76:79], v[124:127]
    ds_read_b128 v[72:75], v9 offset:18432
    v_mfma_f32_16x16x32_bf16 v[124:127], v[76:79], a[92:95], v[124:127]
    ds_read_b128 v[76:79], v9 offset:20480
    s_waitcnt lgkmcnt(7)
    v_mfma_f32_16x16x32_bf16 v[96:99], v[80:83], a[96:99], v[96:99]
    s_waitcnt lgkmcnt(6)
    v_mfma_f32_16x16x32_bf16 v[96:99], v[84:87], a[112:115], v[96:99]
    s_waitcnt lgkmcnt(5)
    v_mfma_f32_16x16x32_bf16 v[96:99], v[88:91], a[128:131], v[96:99]
    v_mfma_f32_16x16x32_bf16 v[100:103], v[80:83], a[100:103], v[100:103]
    v_mfma_f32_16x16x32_bf16 v[100:103], v[84:87], a[116:119], v[100:103]
    v_mfma_f32_16x16x32_bf16 v[100:103], v[88:91], a[132:135], v[100:103]
    v_mfma_f32_16x16x32_bf16 v[104:107], v[80:83], a[104:107], v[104:107]
    v_mfma_f32_16x16x32_bf16 v[104:107], v[84:87], a[120:123], v[104:107]
    v_mfma_f32_16x16x32_bf16 v[104:107], v[88:91], a[136:139], v[104:107]
    v_mfma_f32_16x16x32_bf16 v[108:111], v[80:83], a[108:111], v[108:111]
    ds_read_b128 v[80:83], v9 offset:22528
    v_mfma_f32_16x16x32_bf16 v[108:111], v[84:87], a[124:127], v[108:111]
    ds_read_b128 v[84:87], v9 offset:19456
    v_mfma_f32_16x16x32_bf16 v[108:111], v[88:91], a[140:143], v[108:111]
    ds_read_b128 v[88:91], v9 offset:21504
    s_waitcnt lgkmcnt(7)
    v_mfma_f32_16x16x32_bf16 v[112:115], v[92:95], a[96:99], v[112:115]
    s_waitcnt lgkmcnt(6)
    v_mfma_f32_16x16x32_bf16 v[112:115], v[64:67], a[112:115], v[112:115]
    s_waitcnt lgkmcnt(5)
    v_mfma_f32_16x16x32_bf16 v[112:115], v[68:71], a[128:131], v[112:115]
    v_mfma_f32_16x16x32_bf16 v[116:119], v[92:95], a[100:103], v[116:119]
    v_mfma_f32_16x16x32_bf16 v[116:119], v[64:67], a[116:119], v[116:119]
    v_mfma_f32_16x16x32_bf16 v[116:119], v[68:71], a[132:135], v[116:119]
    v_mfma_f32_16x16x32_bf16 v[120:123], v[92:95], a[104:107], v[120:123]
    v_mfma_f32_16x16x32_bf16 v[120:123], v[64:67], a[120:123], v[120:123]
    v_mfma_f32_16x16x32_bf16 v[120:123], v[68:71], a[136:139], v[120:123]
    s_barrier
    v_mfma_f32_16x16x32_bf16 v[124:127], v[92:95], a[108:111], v[124:127]
    ds_read_b128 v[92:95], v9 offset:23552
    s_add_u32 m0, s25, 36864
    v_mfma_f32_16x16x32_bf16 v[124:127], v[64:67], a[124:127], v[124:127]
    ds_read_b128 v[64:67], v9 offset:24576
    s_mov_b32 s30, s33
    v_mfma_f32_16x16x32_bf16 v[124:127], v[68:71], a[140:143], v[124:127]
    ds_read_b128 v[68:71], v9 offset:26624
    s_waitcnt lgkmcnt(7)
    v_mfma_f32_16x16x32_bf16 v[96:99], v[72:75], a[144:147], v[96:99]
    s_waitcnt lgkmcnt(6)
    v_mfma_f32_16x16x32_bf16 v[96:99], v[76:79], a[160:163], v[96:99]
    s_waitcnt lgkmcnt(5)
    v_mfma_f32_16x16x32_bf16 v[96:99], v[80:83], a[176:179], v[96:99]
    buffer_load_dwordx4 v3, s[12:15], s30 offen offset:0 sc1 lds
    v_mfma_f32_16x16x32_bf16 v[100:103], v[72:75], a[148:151], v[100:103]
    v_mfma_f32_16x16x32_bf16 v[100:103], v[76:79], a[164:167], v[100:103]
    buffer_load_dwordx4 v3, s[12:15], s30 offen offset:1024 sc1 lds
    v_mfma_f32_16x16x32_bf16 v[100:103], v[80:83], a[180:183], v[100:103]
    v_mfma_f32_16x16x32_bf16 v[104:107], v[72:75], a[152:155], v[104:107]
    buffer_load_dwordx4 v3, s[12:15], s30 offen offset:2048 sc1 lds
    v_mfma_f32_16x16x32_bf16 v[104:107], v[76:79], a[168:171], v[104:107]
    s_add_u32 m0, s25, 49152
    s_add_u32 s30, s30, 12288
    v_mfma_f32_16x16x32_bf16 v[104:107], v[80:83], a[184:187], v[104:107]
    buffer_load_dwordx4 v3, s[12:15], s30 offen offset:0 sc1 lds
    v_mfma_f32_16x16x32_bf16 v[108:111], v[72:75], a[156:159], v[108:111]
    ds_read_b128 v[72:75], v9 offset:28672
    v_mfma_f32_16x16x32_bf16 v[108:111], v[76:79], a[172:175], v[108:111]
    ds_read_b128 v[76:79], v9 offset:25600
    v_mfma_f32_16x16x32_bf16 v[108:111], v[80:83], a[188:191], v[108:111]
    ds_read_b128 v[80:83], v9 offset:27648
    s_waitcnt lgkmcnt(7)
    v_mfma_f32_16x16x32_bf16 v[112:115], v[84:87], a[144:147], v[112:115]
    s_waitcnt lgkmcnt(6)
    v_mfma_f32_16x16x32_bf16 v[112:115], v[88:91], a[160:163], v[112:115]
    s_waitcnt lgkmcnt(5)
    v_mfma_f32_16x16x32_bf16 v[112:115], v[92:95], a[176:179], v[112:115]
    buffer_load_dwordx4 v3, s[12:15], s30 offen offset:1024 sc1 lds
    v_mfma_f32_16x16x32_bf16 v[116:119], v[84:87], a[148:151], v[116:119]
    v_mfma_f32_16x16x32_bf16 v[116:119], v[88:91], a[164:167], v[116:119]
    buffer_load_dwordx4 v3, s[12:15], s30 offen offset:2048 sc1 lds
    v_mfma_f32_16x16x32_bf16 v[116:119], v[92:95], a[180:183], v[116:119]
    s_add_u32 m0, s25, 61440
    s_add_u32 s30, s30, 12288
    v_mfma_f32_16x16x32_bf16 v[120:123], v[84:87], a[152:155], v[120:123]
    buffer_load_dwordx4 v3, s[12:15], s30 offen offset:0 sc1 lds
    v_mfma_f32_16x16x32_bf16 v[120:123], v[88:91], a[168:171], v[120:123]
    v_mfma_f32_16x16x32_bf16 v[120:123], v[92:95], a[184:187], v[120:123]
    v_mfma_f32_16x16x32_bf16 v[124:127], v[84:87], a[156:159], v[124:127]
    ds_read_b128 v[84:87], v9 offset:29696
    v_mfma_f32_16x16x32_bf16 v[124:127], v[88:91], a[172:175], v[124:127]
    ds_read_b128 v[88:91], v9 offset:30720
    v_mfma_f32_16x16x32_bf16 v[124:127], v[92:95], a[188:191], v[124:127]
    ds_read_b128 v[92:95], v9 offset:32768
    s_waitcnt lgkmcnt(7)
    v_mfma_f32_16x16x32_bf16 v[96:99], v[64:67], a[192:195], v[96:99]
    s_waitcnt lgkmcnt(6)
    v_mfma_f32_16x16x32_bf16 v[96:99], v[68:71], a[208:211], v[96:99]
    s_waitcnt lgkmcnt(5)
    v_mfma_f32_16x16x32_bf16 v[96:99], v[72:75], a[224:227], v[96:99]
    buffer_load_dwordx4 v3, s[12:15], s30 offen offset:1024 sc1 lds
    v_mfma_f32_16x16x32_bf16 v[100:103], v[64:67], a[196:199], v[100:103]
    s_waitcnt vmcnt(8)
    s_mov_b64 exec, 1
    buffer_store_dword v21, off, s[40:43], s52 offset:0 sc1
    s_mov_b64 exec, -1
    v_mfma_f32_16x16x32_bf16 v[100:103], v[68:71], a[212:215], v[100:103]
    v_mfma_f32_16x16x32_bf16 v[100:103], v[72:75], a[228:231], v[100:103]
    v_mfma_f32_16x16x32_bf16 v[104:107], v[64:67], a[200:203], v[104:107]
    v_mfma_f32_16x16x32_bf16 v[104:107], v[68:71], a[216:219], v[104:107]
    buffer_load_dwordx4 v3, s[12:15], s30 offen offset:2048 sc1 lds
    v_mfma_f32_16x16x32_bf16 v[104:107], v[72:75], a[232:235], v[104:107]
    v_mfma_f32_16x16x32_bf16 v[108:111], v[64:67], a[204:207], v[108:111]
    ds_read_b128 v[64:67], v9 offset:34816
    v_mfma_f32_16x16x32_bf16 v[108:111], v[68:71], a[220:223], v[108:111]
    ds_read_b128 v[68:71], v9 offset:31744
    v_mfma_f32_16x16x32_bf16 v[108:111], v[72:75], a[236:239], v[108:111]
    ds_read_b128 v[72:75], v9 offset:33792
    s_waitcnt lgkmcnt(7)
    v_mfma_f32_16x16x32_bf16 v[112:115], v[76:79], a[192:195], v[112:115]
    s_add_u32 m0, s26, 0
    s_waitcnt lgkmcnt(6)
    v_mfma_f32_16x16x32_bf16 v[112:115], v[80:83], a[208:211], v[112:115]
    s_add_u32 s30, s30, 12288
    s_waitcnt lgkmcnt(5)
    v_mfma_f32_16x16x32_bf16 v[112:115], v[84:87], a[224:227], v[112:115]
    buffer_load_dwordx4 v3, s[12:15], s30 offen offset:0 sc1 lds
    v_mfma_f32_16x16x32_bf16 v[116:119], v[76:79], a[196:199], v[116:119]
    v_mfma_f32_16x16x32_bf16 v[116:119], v[80:83], a[212:215], v[116:119]
    v_mfma_f32_16x16x32_bf16 v[116:119], v[84:87], a[228:231], v[116:119]
    v_mfma_f32_16x16x32_bf16 v[120:123], v[76:79], a[200:203], v[120:123]
    v_mfma_f32_16x16x32_bf16 v[120:123], v[80:83], a[216:219], v[120:123]
    v_mfma_f32_16x16x32_bf16 v[120:123], v[84:87], a[232:235], v[120:123]
    v_mfma_f32_16x16x32_bf16 v[124:127], v[76:79], a[204:207], v[124:127]
    ds_read_b128 v[76:79], v9 offset:35840
    v_mfma_f32_16x16x32_bf16 v[124:127], v[80:83], a[220:223], v[124:127]
    ds_read_b128 v[80:83], v10 offset:0
    v_mfma_f32_16x16x32_bf16 v[124:127], v[84:87], a[236:239], v[124:127]
    ds_read_b128 v[84:87], v10 offset:4096
    s_waitcnt lgkmcnt(7)
    v_mfma_f32_16x16x32_bf16 v[96:99], v[88:91], a[240:243], v[96:99]
    s_waitcnt lgkmcnt(6)
    v_mfma_f32_16x16x32_bf16 v[96:99], v[92:95], v[224:227], v[96:99]
    s_waitcnt lgkmcnt(5)
    v_mfma_f32_16x16x32_bf16 v[96:99], v[64:67], v[240:243], v[96:99]
    buffer_load_dwordx4 v3, s[12:15], s30 offen offset:1024 sc1 lds
    v_mfma_f32_16x16x32_bf16 v[100:103], v[88:91], a[244:247], v[100:103]
    v_mfma_f32_16x16x32_bf16 v[100:103], v[92:95], v[228:231], v[100:103]
    v_mfma_f32_16x16x32_bf16 v[100:103], v[64:67], v[244:247], v[100:103]
    v_mfma_f32_16x16x32_bf16 v[104:107], v[88:91], a[248:251], v[104:107]
    v_mfma_f32_16x16x32_bf16 v[104:107], v[92:95], v[232:235], v[104:107]
    v_mfma_f32_16x16x32_bf16 v[104:107], v[64:67], v[248:251], v[104:107]
    v_mfma_f32_16x16x32_bf16 v[108:111], v[88:91], a[252:255], v[108:111]
    ds_read_b128 v[88:91], v10 offset:8192
    v_mfma_f32_16x16x32_bf16 v[108:111], v[92:95], v[236:239], v[108:111]
    ds_read_b128 v[92:95], v10 offset:1024
    v_mfma_f32_16x16x32_bf16 v[108:111], v[64:67], v[252:255], v[108:111]
    ds_read_b128 v[64:67], v10 offset:5120
    s_waitcnt lgkmcnt(7)
    v_mfma_f32_16x16x32_bf16 v[112:115], v[68:71], a[240:243], v[112:115]
    s_waitcnt lgkmcnt(6)
    v_mfma_f32_16x16x32_bf16 v[112:115], v[72:75], v[224:227], v[112:115]
    s_waitcnt lgkmcnt(5)
    v_mfma_f32_16x16x32_bf16 v[112:115], v[76:79], v[240:243], v[112:115]
    buffer_load_dwordx4 v3, s[12:15], s30 offen offset:2048 sc1 lds
    v_mfma_f32_16x16x32_bf16 v[116:119], v[68:71], a[244:247], v[116:119]
    v_mfma_f32_16x16x32_bf16 v[116:119], v[72:75], v[228:231], v[116:119]
    v_mfma_f32_16x16x32_bf16 v[116:119], v[76:79], v[244:247], v[116:119]
    v_mfma_f32_16x16x32_bf16 v[120:123], v[68:71], a[248:251], v[120:123]
    v_mfma_f32_16x16x32_bf16 v[120:123], v[72:75], v[232:235], v[120:123]
    v_mfma_f32_16x16x32_bf16 v[120:123], v[76:79], v[248:251], v[120:123]
    v_mfma_f32_16x16x32_bf16 v[124:127], v[68:71], a[252:255], v[124:127]
    ds_read_b128 v[68:71], v10 offset:9216
    v_mfma_f32_16x16x32_bf16 v[124:127], v[72:75], v[236:239], v[124:127]
    ds_read_b128 v[72:75], v10 offset:2048
    v_mfma_f32_16x16x32_bf16 v[124:127], v[76:79], v[252:255], v[124:127]
    ds_read_b128 v[76:79], v10 offset:6144
    s_waitcnt lgkmcnt(7)
    v_mfma_f32_16x16x32_bf16 v[160:163], v[80:83], a[0:3], 0
    s_waitcnt lgkmcnt(6)
    v_mfma_f32_16x16x32_bf16 v[160:163], v[84:87], a[16:19], v[160:163]
    s_waitcnt lgkmcnt(5)
    v_mfma_f32_16x16x32_bf16 v[160:163], v[88:91], a[32:35], v[160:163]
    v_mfma_f32_16x16x32_bf16 v[164:167], v[80:83], a[4:7], 0
    v_mfma_f32_16x16x32_bf16 v[164:167], v[84:87], a[20:23], v[164:167]
    v_mfma_f32_16x16x32_bf16 v[164:167], v[88:91], a[36:39], v[164:167]
    v_mfma_f32_16x16x32_bf16 v[168:171], v[80:83], a[8:11], 0
    v_max_f32 v96, 0, v96
    v_mfma_f32_16x16x32_bf16 v[168:171], v[84:87], a[24:27], v[168:171]
    v_max_f32 v97, 0, v97
    v_mfma_f32_16x16x32_bf16 v[168:171], v[88:91], a[40:43], v[168:171]
    v_max_f32 v98, 0, v98
    v_mfma_f32_16x16x32_bf16 v[172:175], v[80:83], a[12:15], 0
    ds_read_b128 v[80:83], v10 offset:10240
    v_max_f32 v99, 0, v99
    v_mfma_f32_16x16x32_bf16 v[172:175], v[84:87], a[28:31], v[172:175]
    ds_read_b128 v[84:87], v10 offset:3072
    v_mul_f32 v96, v96, v112
    v_mfma_f32_16x16x32_bf16 v[172:175], v[88:91], a[44:47], v[172:175]
    ds_read_b128 v[88:91], v10 offset:7168
    s_waitcnt lgkmcnt(7)
    v_mfma_f32_16x16x32_bf16 v[176:179], v[92:95], a[0:3], 0
    v_mul_f32 v97, v97, v113
    s_waitcnt lgkmcnt(6)
    v_mfma_f32_16x16x32_bf16 v[176:179], v[64:67], a[16:19], v[176:179]
    v_mul_f32 v98, v98, v114
    s_waitcnt lgkmcnt(5)
    v_mfma_f32_16x16x32_bf16 v[176:179], v[68:71], a[32:35], v[176:179]
    buffer_load_dword v22, v19, s[40:43], s53 offen offset:0 sc1
    v_mfma_f32_16x16x32_bf16 v[180:183], v[92:95], a[4:7], 0
    v_mul_f32 v99, v99, v115
    v_mfma_f32_16x16x32_bf16 v[180:183], v[64:67], a[20:23], v[180:183]
    v_cvt_pk_bf16_f32 v48, v96, v97
    v_mfma_f32_16x16x32_bf16 v[180:183], v[68:71], a[36:39], v[180:183]
    v_cvt_pk_bf16_f32 v49, v98, v99
    v_mfma_f32_16x16x32_bf16 v[184:187], v[92:95], a[8:11], 0
    v_max_f32 v100, 0, v100
    v_mfma_f32_16x16x32_bf16 v[184:187], v[64:67], a[24:27], v[184:187]
    v_max_f32 v101, 0, v101
    v_mfma_f32_16x16x32_bf16 v[184:187], v[68:71], a[40:43], v[184:187]
    s_barrier
    v_mfma_f32_16x16x32_bf16 v[188:191], v[92:95], a[12:15], 0
    ds_read_b128 v[92:95], v10 offset:11264
    s_add_u32 m0, s26, 12288
    v_mfma_f32_16x16x32_bf16 v[188:191], v[64:67], a[28:31], v[188:191]
    ds_read_b128 v[64:67], v10 offset:12288
    s_add_u32 s30, s30, 12288
    v_mfma_f32_16x16x32_bf16 v[188:191], v[68:71], a[44:47], v[188:191]
    ds_read_b128 v[68:71], v10 offset:16384
    s_waitcnt lgkmcnt(7)
    v_mfma_f32_16x16x32_bf16 v[192:195], v[72:75], a[0:3], 0
    v_max_f32 v102, 0, v102
    s_waitcnt lgkmcnt(6)
    v_mfma_f32_16x16x32_bf16 v[192:195], v[76:79], a[16:19], v[192:195]
    v_max_f32 v103, 0, v103
    s_waitcnt lgkmcnt(5)
    v_mfma_f32_16x16x32_bf16 v[192:195], v[80:83], a[32:35], v[192:195]
    buffer_load_dwordx4 v3, s[12:15], s30 offen offset:0 sc1 lds
    v_mfma_f32_16x16x32_bf16 v[196:199], v[72:75], a[4:7], 0
    v_mul_f32 v100, v100, v116
    v_mfma_f32_16x16x32_bf16 v[196:199], v[76:79], a[20:23], v[196:199]
    v_mul_f32 v101, v101, v117
    v_mfma_f32_16x16x32_bf16 v[196:199], v[80:83], a[36:39], v[196:199]
    v_mul_f32 v102, v102, v118
    v_mfma_f32_16x16x32_bf16 v[200:203], v[72:75], a[8:11], 0
    v_mul_f32 v103, v103, v119
    v_mfma_f32_16x16x32_bf16 v[200:203], v[76:79], a[24:27], v[200:203]
    v_cvt_pk_bf16_f32 v52, v100, v101
    v_mfma_f32_16x16x32_bf16 v[200:203], v[80:83], a[40:43], v[200:203]
    v_cvt_pk_bf16_f32 v53, v102, v103
    v_mfma_f32_16x16x32_bf16 v[204:207], v[72:75], a[12:15], 0
    ds_read_b128 v[72:75], v10 offset:20480
    v_max_f32 v104, 0, v104
    v_mfma_f32_16x16x32_bf16 v[204:207], v[76:79], a[28:31], v[204:207]
    ds_read_b128 v[76:79], v10 offset:13312
    v_max_f32 v105, 0, v105
    v_mfma_f32_16x16x32_bf16 v[204:207], v[80:83], a[44:47], v[204:207]
    ds_read_b128 v[80:83], v10 offset:17408
    s_waitcnt lgkmcnt(7)
    v_mfma_f32_16x16x32_bf16 v[208:211], v[84:87], a[0:3], 0
    v_max_f32 v106, 0, v106
    s_waitcnt lgkmcnt(6)
    v_mfma_f32_16x16x32_bf16 v[208:211], v[88:91], a[16:19], v[208:211]
    v_max_f32 v107, 0, v107
    s_waitcnt lgkmcnt(5)
    v_mfma_f32_16x16x32_bf16 v[208:211], v[92:95], a[32:35], v[208:211]
    buffer_load_dwordx4 v3, s[12:15], s30 offen offset:1024 sc1 lds
    v_mfma_f32_16x16x32_bf16 v[212:215], v[84:87], a[4:7], 0
    v_mul_f32 v104, v104, v120
    v_mfma_f32_16x16x32_bf16 v[212:215], v[88:91], a[20:23], v[212:215]
    v_mul_f32 v105, v105, v121
    v_mfma_f32_16x16x32_bf16 v[212:215], v[92:95], a[36:39], v[212:215]
    v_mul_f32 v106, v106, v122
    v_mfma_f32_16x16x32_bf16 v[216:219], v[84:87], a[8:11], 0
    v_mul_f32 v107, v107, v123
    v_mfma_f32_16x16x32_bf16 v[216:219], v[88:91], a[24:27], v[216:219]
    v_cvt_pk_bf16_f32 v56, v104, v105
    v_mfma_f32_16x16x32_bf16 v[216:219], v[92:95], a[40:43], v[216:219]
    v_cvt_pk_bf16_f32 v57, v106, v107
    v_mfma_f32_16x16x32_bf16 v[220:223], v[84:87], a[12:15], 0
    ds_read_b128 v[84:87], v10 offset:21504
    v_max_f32 v108, 0, v108
    v_mfma_f32_16x16x32_bf16 v[220:223], v[88:91], a[28:31], v[220:223]
    ds_read_b128 v[88:91], v10 offset:14336
    v_max_f32 v109, 0, v109
    v_mfma_f32_16x16x32_bf16 v[220:223], v[92:95], a[44:47], v[220:223]
    ds_read_b128 v[92:95], v10 offset:18432
    s_waitcnt lgkmcnt(7)
    v_mfma_f32_16x16x32_bf16 v[160:163], v[64:67], a[48:51], v[160:163]
    v_max_f32 v110, 0, v110
    s_waitcnt lgkmcnt(6)
    v_mfma_f32_16x16x32_bf16 v[160:163], v[68:71], a[64:67], v[160:163]
    v_max_f32 v111, 0, v111
    s_waitcnt lgkmcnt(5)
    v_mfma_f32_16x16x32_bf16 v[160:163], v[72:75], a[80:83], v[160:163]
    buffer_load_dwordx4 v3, s[12:15], s30 offen offset:2048 sc1 lds
    v_mfma_f32_16x16x32_bf16 v[164:167], v[64:67], a[52:55], v[164:167]
    s_add_u32 m0, s26, 24576
    s_add_u32 s30, s30, 12288
    v_mfma_f32_16x16x32_bf16 v[164:167], v[68:71], a[68:71], v[164:167]
    buffer_load_dwordx4 v3, s[12:15], s30 offen offset:0 sc1 lds
    v_mfma_f32_16x16x32_bf16 v[164:167], v[72:75], a[84:87], v[164:167]
    v_mul_f32 v108, v108, v124
    v_mfma_f32_16x16x32_bf16 v[168:171], v[64:67], a[56:59], v[168:171]
    v_mul_f32 v109, v109, v125
    v_mfma_f32_16x16x32_bf16 v[168:171], v[68:71], a[72:75], v[168:171]
    v_mul_f32 v110, v110, v126
    v_mfma_f32_16x16x32_bf16 v[168:171], v[72:75], a[88:91], v[168:171]
    v_mul_f32 v111, v111, v127
    v_mfma_f32_16x16x32_bf16 v[172:175], v[64:67], a[60:63], v[172:175]
    ds_read_b128 v[64:67], v10 offset:22528
    v_cvt_pk_bf16_f32 v60, v108, v109
    v_mfma_f32_16x16x32_bf16 v[172:175], v[68:71], a[76:79], v[172:175]
    ds_read_b128 v[68:71], v10 offset:15360
    v_cvt_pk_bf16_f32 v61, v110, v111
    v_mfma_f32_16x16x32_bf16 v[172:175], v[72:75], a[92:95], v[172:175]
    ds_read_b128 v[72:75], v10 offset:19456
    s_waitcnt lgkmcnt(7)
    v_mfma_f32_16x16x32_bf16 v[176:179], v[76:79], a[48:51], v[176:179]
    s_waitcnt vmcnt(4)
    v_cmp_ne_u32 vcc, v21, v22
    s_cbranch_vccnz f_slow0
f_back0:
    s_waitcnt lgkmcnt(6)
    v_mfma_f32_16x16x32_bf16 v[176:179], v[80:83], a[64:67], v[176:179]
    s_waitcnt lgkmcnt(5)
    v_mfma_f32_16x16x32_bf16 v[176:179], v[84:87], a[80:83], v[176:179]
    v_mfma_f32_16x16x32_bf16 v[180:183], v[76:79], a[52:55], v[180:183]
    v_mfma_f32_16x16x32_bf16 v[180:183], v[80:83], a[68:71], v[180:183]
    buffer_load_dwordx4 v3, s[12:15], s30 offen offset:1024 sc1 lds
    v_mfma_f32_16x16x32_bf16 v[180:183], v[84:87], a[84:87], v[180:183]
    v_mfma_f32_16x16x32_bf16 v[184:187], v[76:79], a[56:59], v[184:187]
    v_mfma_f32_16x16x32_bf16 v[184:187], v[80:83], a[72:75], v[184:187]
    v_mfma_f32_16x16x32_bf16 v[184:187], v[84:87], a[88:91], v[184:187]
    buffer_load_dwordx4 a[0:3], v3, s[36:39], s47 offen offset:0 sc1
    v_mfma_f32_16x16x32_bf16 v[188:191], v[76:79], a[60:63], v[188:191]
    ds_read_b128 v[76:79], v10 offset:23552
    v_mfma_f32_16x16x32_bf16 v[188:191], v[80:83], a[76:79], v[188:191]
    ds_read_b128 v[80:83], v10 offset:24576
    v_mfma_f32_16x16x32_bf16 v[188:191], v[84:87], a[92:95], v[188:191]
    ds_read_b128 v[84:87], v10 offset:28672
    s_waitcnt lgkmcnt(7)
    v_mfma_f32_16x16x32_bf16 v[192:195], v[88:91], a[48:51], v[192:195]
    s_waitcnt lgkmcnt(6)
    v_mfma_f32_16x16x32_bf16 v[192:195], v[92:95], a[64:67], v[192:195]
    s_waitcnt lgkmcnt(5)
    v_mfma_f32_16x16x32_bf16 v[192:195], v[64:67], a[80:83], v[192:195]
    buffer_load_dwordx4 a[4:7], v11, s[36:39], s47 offen offset:0 sc1
    v_mfma_f32_16x16x32_bf16 v[196:199], v[88:91], a[52:55], v[196:199]
    v_mfma_f32_16x16x32_bf16 v[196:199], v[92:95], a[68:71], v[196:199]
    buffer_load_dwordx4 v3, s[12:15], s30 offen offset:2048 sc1 lds
    v_mfma_f32_16x16x32_bf16 v[196:199], v[64:67], a[84:87], v[196:199]
    v_mfma_f32_16x16x32_bf16 v[200:203], v[88:91], a[56:59], v[200:203]
    buffer_load_dwordx4 a[8:11], v3, s[36:39], s47 offen offset:1024 sc1
    v_mfma_f32_16x16x32_bf16 v[200:203], v[92:95], a[72:75], v[200:203]
    v_mfma_f32_16x16x32_bf16 v[200:203], v[64:67], a[88:91], v[200:203]
    v_mfma_f32_16x16x32_bf16 v[204:207], v[88:91], a[60:63], v[204:207]
    ds_read_b128 v[88:91], v10 offset:32768
    v_mfma_f32_16x16x32_bf16 v[204:207], v[92:95], a[76:79], v[204:207]
    ds_read_b128 v[92:95], v10 offset:25600
    v_mfma_f32_16x16x32_bf16 v[204:207], v[64:67], a[92:95], v[204:207]
    ds_read_b128 v[64:67], v10 offset:29696
    s_waitcnt lgkmcnt(7)
    v_mfma_f32_16x16x32_bf16 v[208:211], v[68:71], a[48:51], v[208:211]
    s_waitcnt lgkmcnt(6)
    v_mfma_f32_16x16x32_bf16 v[208:211], v[72:75], a[64:67], v[208:211]
    s_waitcnt lgkmcnt(5)
    v_mfma_f32_16x16x32_bf16 v[208:211], v[76:79], a[80:83], v[208:211]
    buffer_load_dwordx4 a[12:15], v11, s[36:39], s47 offen offset:1024 sc1
    v_mfma_f32_16x16x32_bf16 v[212:215], v[68:71], a[52:55], v[212:215]
    v_mfma_f32_16x16x32_bf16 v[212:215], v[72:75], a[68:71], v[212:215]
    v_mfma_f32_16x16x32_bf16 v[212:215], v[76:79], a[84:87], v[212:215]
    v_mfma_f32_16x16x32_bf16 v[216:219], v[68:71], a[56:59], v[216:219]
    buffer_load_dwordx4 a[16:19], v3, s[36:39], s47 offen offset:2048 sc1
    v_mfma_f32_16x16x32_bf16 v[216:219], v[72:75], a[72:75], v[216:219]
    v_mfma_f32_16x16x32_bf16 v[216:219], v[76:79], a[88:91], v[216:219]
    v_mfma_f32_16x16x32_bf16 v[220:223], v[68:71], a[60:63], v[220:223]
    ds_read_b128 v[68:71], v10 offset:33792
    v_mfma_f32_16x16x32_bf16 v[220:223], v[72:75], a[76:79], v[220:223]
    ds_read_b128 v[72:75], v10 offset:26624
    v_mfma_f32_16x16x32_bf16 v[220:223], v[76:79], a[92:95], v[220:223]
    ds_read_b128 v[76:79], v10 offset:30720
    s_waitcnt lgkmcnt(7)
    v_mfma_f32_16x16x32_bf16 v[160:163], v[80:83], a[96:99], v[160:163]
    s_waitcnt lgkmcnt(6)
    v_mfma_f32_16x16x32_bf16 v[160:163], v[84:87], a[112:115], v[160:163]
    s_waitcnt lgkmcnt(5)
    v_mfma_f32_16x16x32_bf16 v[160:163], v[88:91], a[128:131], v[160:163]
    buffer_load_dwordx4 a[20:23], v11, s[36:39], s47 offen offset:2048 sc1
    v_mfma_f32_16x16x32_bf16 v[164:167], v[80:83], a[100:103], v[164:167]
    v_mfma_f32_16x16x32_bf16 v[164:167], v[84:87], a[116:119], v[164:167]
    v_mfma_f32_16x16x32_bf16 v[164:167], v[88:91], a[132:135], v[164:167]
    v_mfma_f32_16x16x32_bf16 v[168:171], v[80:83], a[104:107], v[168:171]
    buffer_load_dwordx4 a[24:27], v3, s[36:39], s47 offen offset:3072 sc1
    v_mfma_f32_16x16x32_bf16 v[168:171], v[84:87], a[120:123], v[168:171]
    v_mfma_f32_16x16x32_bf16 v[168:171], v[88:91], a[136:139], v[168:171]
    v_mfma_f32_16x16x32_bf16 v[172:175], v[80:83], a[108:111], v[172:175]
    ds_read_b128 v[80:83], v10 offset:34816
    v_mfma_f32_16x16x32_bf16 v[172:175], v[84:87], a[124:127], v[172:175]
    ds_read_b128 v[84:87], v10 offset:27648
    v_mfma_f32_16x16x32_bf16 v[172:175], v[88:91], a[140:143], v[172:175]
    ds_read_b128 v[88:91], v10 offset:31744
    s_waitcnt lgkmcnt(7)
    v_mfma_f32_16x16x32_bf16 v[176:179], v[92:95], a[96:99], v[176:179]
    s_waitcnt lgkmcnt(6)
    v_mfma_f32_16x16x32_bf16 v[176:179], v[64:67], a[112:115], v[176:179]
    s_waitcnt lgkmcnt(5)
    v_mfma_f32_16x16x32_bf16 v[176:179], v[68:71], a[128:131], v[176:179]
    buffer_load_dwordx4 a[28:31], v11, s[36:39], s47 offen offset:3072 sc1
    v_mfma_f32_16x16x32_bf16 v[180:183], v[92:95], a[100:103], v[180:183]
    v_mfma_f32_16x16x32_bf16 v[180:183], v[64:67], a[116:119], v[180:183]
    s_add_u32 s47, s47, 4096
    v_mfma_f32_16x16x32_bf16 v[180:183], v[68:71], a[132:135], v[180:183]
    buffer_load_dwordx4 a[32:35], v3, s[36:39], s47 offen offset:0 sc1
    v_mfma_f32_16x16x32_bf16 v[184:187], v[92:95], a[104:107], v[184:187]
    v_mfma_f32_16x16x32_bf16 v[184:187], v[64:67], a[120:123], v[184:187]
    v_mfma_f32_16x16x32_bf16 v[184:187], v[68:71], a[136:139], v[184:187]
    s_barrier
    v_mfma_f32_16x16x32_bf16 v[188:191], v[92:95], a[108:111], v[188:191]
    ds_read_b128 v[92:95], v10 offset:35840
    s_add_u32 m0, s26, 36864
    v_mfma_f32_16x16x32_bf16 v[188:191], v[64:67], a[124:127], v[188:191]
    ds_read_b128 v[64:67], v4 offset:0
    s_add_u32 s30, s30, 12288
    v_mfma_f32_16x16x32_bf16 v[188:191], v[68:71], a[140:143], v[188:191]
    ds_read_b128 v[68:71], v4 offset:4096
    s_waitcnt lgkmcnt(7)
    v_mfma_f32_16x16x32_bf16 v[192:195], v[72:75], a[96:99], v[192:195]
    s_waitcnt lgkmcnt(6)
    v_mfma_f32_16x16x32_bf16 v[192:195], v[76:79], a[112:115], v[192:195]
    s_waitcnt lgkmcnt(5)
    v_mfma_f32_16x16x32_bf16 v[192:195], v[80:83], a[128:131], v[192:195]
    buffer_load_dwordx4 v3, s[12:15], s30 offen offset:0 sc1 lds
    v_mfma_f32_16x16x32_bf16 v[196:199], v[72:75], a[100:103], v[196:199]
    buffer_load_dwordx4 a[36:39], v11, s[36:39], s47 offen offset:0 sc1
    v_mfma_f32_16x16x32_bf16 v[196:199], v[76:79], a[116:119], v[196:199]
    v_mfma_f32_16x16x32_bf16 v[196:199], v[80:83], a[132:135], v[196:199]
    v_mfma_f32_16x16x32_bf16 v[200:203], v[72:75], a[104:107], v[200:203]
    v_mfma_f32_16x16x32_bf16 v[200:203], v[76:79], a[120:123], v[200:203]
    buffer_load_dwordx4 a[40:43], v3, s[36:39], s47 offen offset:1024 sc1
    v_mfma_f32_16x16x32_bf16 v[200:203], v[80:83], a[136:139], v[200:203]
    v_mfma_f32_16x16x32_bf16 v[204:207], v[72:75], a[108:111], v[204:207]
    ds_read_b128 v[72:75], v4 offset:8192
    v_mfma_f32_16x16x32_bf16 v[204:207], v[76:79], a[124:127], v[204:207]
    ds_read_b128 v[76:79], v4 offset:1024
    v_mfma_f32_16x16x32_bf16 v[204:207], v[80:83], a[140:143], v[204:207]
    ds_read_b128 v[80:83], v4 offset:5120
    s_waitcnt lgkmcnt(7)
    v_mfma_f32_16x16x32_bf16 v[208:211], v[84:87], a[96:99], v[208:211]
    s_waitcnt lgkmcnt(6)
    v_mfma_f32_16x16x32_bf16 v[208:211], v[88:91], a[112:115], v[208:211]
    s_waitcnt lgkmcnt(5)
    v_mfma_f32_16x16x32_bf16 v[208:211], v[92:95], a[128:131], v[208:211]
    buffer_load_dwordx4 v3, s[12:15], s30 offen offset:1024 sc1 lds
    v_mfma_f32_16x16x32_bf16 v[212:215], v[84:87], a[100:103], v[212:215]
    buffer_load_dwordx4 a[44:47], v11, s[36:39], s47 offen offset:1024 sc1
    v_mfma_f32_16x16x32_bf16 v[212:215], v[88:91], a[116:119], v[212:215]
    v_mfma_f32_16x16x32_bf16 v[212:215], v[92:95], a[132:135], v[212:215]
    v_mfma_f32_16x16x32_bf16 v[216:219], v[84:87], a[104:107], v[216:219]
    v_mfma_f32_16x16x32_bf16 v[216:219], v[88:91], a[120:123], v[216:219]
    buffer_load_dwordx4 a[48:51], v3, s[36:39], s47 offen offset:2048 sc1
    v_mfma_f32_16x16x32_bf16 v[216:219], v[92:95], a[136:139], v[216:219]
    v_mfma_f32_16x16x32_bf16 v[220:223], v[84:87], a[108:111], v[220:223]
    ds_read_b128 v[84:87], v4 offset:9216
    v_mfma_f32_16x16x32_bf16 v[220:223], v[88:91], a[124:127], v[220:223]
    ds_read_b128 v[88:91], v4 offset:2048
    v_mfma_f32_16x16x32_bf16 v[220:223], v[92:95], a[140:143], v[220:223]
    ds_read_b128 v[92:95], v4 offset:6144
    s_waitcnt lgkmcnt(7)
    v_mfma_f32_16x16x32_bf16 v[160:163], v[64:67], a[144:147], v[160:163]
    s_waitcnt lgkmcnt(6)
    v_mfma_f32_16x16x32_bf16 v[160:163], v[68:71], a[160:163], v[160:163]
    s_waitcnt lgkmcnt(5)
    v_mfma_f32_16x16x32_bf16 v[160:163], v[72:75], a[176:179], v[160:163]
    buffer_load_dwordx4 v3, s[12:15], s30 offen offset:2048 sc1 lds
    v_mfma_f32_16x16x32_bf16 v[164:167], v[64:67], a[148:151], v[164:167]
    s_add_u32 m0, s26, 49152
    s_add_u32 s30, s30, 12288
    v_mfma_f32_16x16x32_bf16 v[164:167], v[68:71], a[164:167], v[164:167]
    buffer_load_dwordx4 v3, s[12:15], s30 offen offset:0 sc1 lds
    v_mfma_f32_16x16x32_bf16 v[164:167], v[72:75], a[180:183], v[164:167]
    buffer_load_dwordx4 a[52:55], v11, s[36:39], s47 offen offset:2048 sc1
    v_mfma_f32_16x16x32_bf16 v[168:171], v[64:67], a[152:155], v[168:171]
    v_mfma_f32_16x16x32_bf16 v[168:171], v[68:71], a[168:171], v[168:171]
    v_mfma_f32_16x16x32_bf16 v[168:171], v[72:75], a[184:187], v[168:171]
    v_mfma_f32_16x16x32_bf16 v[172:175], v[64:67], a[156:159], v[172:175]
    ds_read_b128 v[64:67], v4 offset:10240
    v_mfma_f32_16x16x32_bf16 v[172:175], v[68:71], a[172:175], v[172:175]
    ds_read_b128 v[68:71], v4 offset:3072
    v_mfma_f32_16x16x32_bf16 v[172:175], v[72:75], a[188:191], v[172:175]
    ds_read_b128 v[72:75], v4 offset:7168
    s_waitcnt lgkmcnt(7)
    v_mfma_f32_16x16x32_bf16 v[176:179], v[76:79], a[144:147], v[176:179]
    s_waitcnt lgkmcnt(6)
    v_mfma_f32_16x16x32_bf16 v[176:179], v[80:83], a[160:163], v[176:179]
    s_waitcnt lgkmcnt(5)
    v_mfma_f32_16x16x32_bf16 v[176:179], v[84:87], a[176:179], v[176:179]
    buffer_load_dwordx4 a[56:59], v3, s[36:39], s47 offen offset:3072 sc1
    v_mfma_f32_16x16x32_bf16 v[180:183], v[76:79], a[148:151], v[180:183]
    v_mfma_f32_16x16x32_bf16 v[180:183], v[80:83], a[164:167], v[180:183]
    buffer_load_dwordx4 v3, s[12:15], s30 offen offset:1024 sc1 lds
    v_mfma_f32_16x16x32_bf16 v[180:183], v[84:87], a[180:183], v[180:183]
    v_mfma_f32_16x16x32_bf16 v[184:187], v[76:79], a[152:155], v[184:187]
    buffer_load_dwordx4 a[60:63], v11, s[36:39], s47 offen offset:3072 sc1
    v_mfma_f32_16x16x32_bf16 v[184:187], v[80:83], a[168:171], v[184:187]
    v_mfma_f32_16x16x32_bf16 v[184:187], v[84:87], a[184:187], v[184:187]
    s_add_u32 s47, s47, 4096
    v_mfma_f32_16x16x32_bf16 v[188:191], v[76:79], a[156:159], v[188:191]
    ds_read_b128 v[76:79], v4 offset:11264
    v_mfma_f32_16x16x32_bf16 v[188:191], v[80:83], a[172:175], v[188:191]
    ds_read_b128 v[80:83], v4 offset:12288
    v_mfma_f32_16x16x32_bf16 v[188:191], v[84:87], a[188:191], v[188:191]
    ds_read_b128 v[84:87], v4 offset:16384
    s_waitcnt lgkmcnt(7)
    v_mfma_f32_16x16x32_bf16 v[192:195], v[88:91], a[144:147], v[192:195]
    s_waitcnt lgkmcnt(6)
    v_mfma_f32_16x16x32_bf16 v[192:195], v[92:95], a[160:163], v[192:195]
    s_waitcnt lgkmcnt(5)
    v_mfma_f32_16x16x32_bf16 v[192:195], v[64:67], a[176:179], v[192:195]
    buffer_load_dwordx4 a[64:67], v3, s[36:39], s47 offen offset:0 sc1
    v_mfma_f32_16x16x32_bf16 v[196:199], v[88:91], a[148:151], v[196:199]
    v_mfma_f32_16x16x32_bf16 v[196:199], v[92:95], a[164:167], v[196:199]
    buffer_load_dwordx4 v3, s[12:15], s30 offen offset:2048 sc1 lds
    v_mfma_f32_16x16x32_bf16 v[196:199], v[64:67], a[180:183], v[196:199]
    v_mfma_f32_16x16x32_bf16 v[200:203], v[88:91], a[152:155], v[200:203]
    buffer_load_dwordx4 a[68:71], v11, s[36:39], s47 offen offset:0 sc1
    v_mfma_f32_16x16x32_bf16 v[200:203], v[92:95], a[168:171], v[200:203]
    v_mfma_f32_16x16x32_bf16 v[200:203], v[64:67], a[184:187], v[200:203]
    v_mfma_f32_16x16x32_bf16 v[204:207], v[88:91], a[156:159], v[204:207]
    ds_read_b128 v[88:91], v4 offset:20480
    v_mfma_f32_16x16x32_bf16 v[204:207], v[92:95], a[172:175], v[204:207]
    ds_read_b128 v[92:95], v4 offset:13312
    v_mfma_f32_16x16x32_bf16 v[204:207], v[64:67], a[188:191], v[204:207]
    ds_read_b128 v[64:67], v4 offset:17408
    s_waitcnt lgkmcnt(7)
    v_mfma_f32_16x16x32_bf16 v[208:211], v[68:71], a[144:147], v[208:211]
    s_waitcnt lgkmcnt(6)
    v_mfma_f32_16x16x32_bf16 v[208:211], v[72:75], a[160:163], v[208:211]
    s_waitcnt lgkmcnt(5)
    v_mfma_f32_16x16x32_bf16 v[208:211], v[76:79], a[176:179], v[208:211]
    buffer_load_dwordx4 a[72:75], v3, s[36:39], s47 offen offset:1024 sc1
    v_mfma_f32_16x16x32_bf16 v[212:215], v[68:71], a[148:151], v[212:215]
    v_mfma_f32_16x16x32_bf16 v[212:215], v[72:75], a[164:167], v[212:215]
    v_mfma_f32_16x16x32_bf16 v[212:215], v[76:79], a[180:183], v[212:215]
    v_mfma_f32_16x16x32_bf16 v[216:219], v[68:71], a[152:155], v[216:219]
    buffer_load_dwordx4 a[76:79], v11, s[36:39], s47 offen offset:1024 sc1
    v_mfma_f32_16x16x32_bf16 v[216:219], v[72:75], a[168:171], v[216:219]
    v_mfma_f32_16x16x32_bf16 v[216:219], v[76:79], a[184:187], v[216:219]
    v_mfma_f32_16x16x32_bf16 v[220:223], v[68:71], a[156:159], v[220:223]
    ds_read_b128 v[68:71], v4 offset:21504
    v_mfma_f32_16x16x32_bf16 v[220:223], v[72:75], a[172:175], v[220:223]
    ds_read_b128 v[72:75], v4 offset:14336
    v_mfma_f32_16x16x32_bf16 v[220:223], v[76:79], a[188:191], v[220:223]
    ds_read_b128 v[76:79], v4 offset:18432
    s_waitcnt lgkmcnt(7)
    v_mfma_f32_16x16x32_bf16 v[160:163], v[80:83], a[192:195], v[160:163]
    s_waitcnt lgkmcnt(6)
    v_mfma_f32_16x16x32_bf16 v[160:163], v[84:87], a[208:211], v[160:163]
    s_waitcnt lgkmcnt(5)
    v_mfma_f32_16x16x32_bf16 v[160:163], v[88:91], a[224:227], v[160:163]
    buffer_load_dwordx4 a[80:83], v3, s[36:39], s47 offen offset:2048 sc1
    v_mfma_f32_16x16x32_bf16 v[164:167], v[80:83], a[196:199], v[164:167]
    v_mfma_f32_16x16x32_bf16 v[164:167], v[84:87], a[212:215], v[164:167]
    v_mfma_f32_16x16x32_bf16 v[164:167], v[88:91], a[228:231], v[164:167]
    v_mfma_f32_16x16x32_bf16 v[168:171], v[80:83], a[200:203], v[168:171]
    buffer_load_dwordx4 a[84:87], v11, s[36:39], s47 offen offset:2048 sc1
    v_mfma_f32_16x16x32_bf16 v[168:171], v[84:87], a[216:219], v[168:171]
    v_mfma_f32_16x16x32_bf16 v[168:171], v[88:91], a[232:235], v[168:171]
    v_mfma_f32_16x16x32_bf16 v[172:175], v[80:83], a[204:207], v[172:175]
    ds_read_b128 v[80:83], v4 offset:22528
    v_mfma_f32_16x16x32_bf16 v[172:175], v[84:87], a[220:223], v[172:175]
    ds_read_b128 v[84:87], v4 offset:15360
    v_mfma_f32_16x16x32_bf16 v[172:175], v[88:91], a[236:239], v[172:175]
    ds_read_b128 v[88:91], v4 offset:19456
    s_waitcnt lgkmcnt(7)
    v_mfma_f32_16x16x32_bf16 v[176:179], v[92:95], a[192:195], v[176:179]
    s_waitcnt lgkmcnt(6)
    v_mfma_f32_16x16x32_bf16 v[176:179], v[64:67], a[208:211], v[176:179]
    s_waitcnt lgkmcnt(5)
    v_mfma_f32_16x16x32_bf16 v[176:179], v[68:71], a[224:227], v[176:179]
    buffer_load_dwordx4 a[88:91], v3, s[36:39], s47 offen offset:3072 sc1
    v_mfma_f32_16x16x32_bf16 v[180:183], v[92:95], a[196:199], v[180:183]
    v_mfma_f32_16x16x32_bf16 v[180:183], v[64:67], a[212:215], v[180:183]
    v_mfma_f32_16x16x32_bf16 v[180:183], v[68:71], a[228:231], v[180:183]
    v_mfma_f32_16x16x32_bf16 v[184:187], v[92:95], a[200:203], v[184:187]
    buffer_load_dwordx4 a[92:95], v11, s[36:39], s47 offen offset:3072 sc1
    v_mfma_f32_16x16x32_bf16 v[184:187], v[64:67], a[216:219], v[184:187]
    v_mfma_f32_16x16x32_bf16 v[184:187], v[68:71], a[232:235], v[184:187]
    s_barrier
    v_mfma_f32_16x16x32_bf16 v[188:191], v[92:95], a[204:207], v[188:191]
    ds_read_b128 v[92:95], v4 offset:23552
    s_add_u32 m0, s26, 61440
    v_mfma_f32_16x16x32_bf16 v[188:191], v[64:67], a[220:223], v[188:191]
    ds_read_b128 v[64:67], v4 offset:24576
    s_add_u32 s30, s30, 12288
    v_mfma_f32_16x16x32_bf16 v[188:191], v[68:71], a[236:239], v[188:191]
    ds_read_b128 v[68:71], v4 offset:28672
    s_waitcnt lgkmcnt(7)
    v_mfma_f32_16x16x32_bf16 v[192:195], v[72:75], a[192:195], v[192:195]
    s_add_u32 s47, s47, 4096
    s_waitcnt lgkmcnt(6)
    v_mfma_f32_16x16x32_bf16 v[192:195], v[76:79], a[208:211], v[192:195]
    s_waitcnt lgkmcnt(5)
    v_mfma_f32_16x16x32_bf16 v[192:195], v[80:83], a[224:227], v[192:195]
    buffer_load_dwordx4 v3, s[12:15], s30 offen offset:0 sc1 lds
    v_mfma_f32_16x16x32_bf16 v[196:199], v[72:75], a[196:199], v[196:199]
    buffer_load_dwordx4 a[96:99], v3, s[36:39], s47 offen offset:0 sc1
    v_mfma_f32_16x16x32_bf16 v[196:199], v[76:79], a[212:215], v[196:199]
    v_mfma_f32_16x16x32_bf16 v[196:199], v[80:83], a[228:231], v[196:199]
    v_mfma_f32_16x16x32_bf16 v[200:203], v[72:75], a[200:203], v[200:203]
    v_mfma_f32_16x16x32_bf16 v[200:203], v[76:79], a[216:219], v[200:203]
    buffer_load_dwordx4 a[100:103], v11, s[36:39], s47 offen offset:0 sc1
    v_mfma_f32_16x16x32_bf16 v[200:203], v[80:83], a[232:235], v[200:203]
    v_mfma_f32_16x16x32_bf16 v[204:207], v[72:75], a[204:207], v[204:207]
    ds_read_b128 v[72:75], v4 offset:32768
    v_mfma_f32_16x16x32_bf16 v[204:207], v[76:79], a[220:223], v[204:207]
    ds_read_b128 v[76:79], v4 offset:25600
    v_mfma_f32_16x16x32_bf16 v[204:207], v[80:83], a[236:239], v[204:207]
    ds_read_b128 v[80:83], v4 offset:29696
    s_waitcnt lgkmcnt(7)
    v_mfma_f32_16x16x32_bf16 v[208:211], v[84:87], a[192:195], v[208:211]
    s_waitcnt lgkmcnt(6)
    v_mfma_f32_16x16x32_bf16 v[208:211], v[88:91], a[208:211], v[208:211]
    s_waitcnt lgkmcnt(5)
    v_mfma_f32_16x16x32_bf16 v[208:211], v[92:95], a[224:227], v[208:211]
    buffer_load_dwordx4 v3, s[12:15], s30 offen offset:1024 sc1 lds
    v_mfma_f32_16x16x32_bf16 v[212:215], v[84:87], a[196:199], v[212:215]
    buffer_load_dwordx4 a[104:107], v3, s[36:39], s47 offen offset:1024 sc1
    v_mfma_f32_16x16x32_bf16 v[212:215], v[88:91], a[212:215], v[212:215]
    v_mfma_f32_16x16x32_bf16 v[212:215], v[92:95], a[228:231], v[212:215]
    v_mfma_f32_16x16x32_bf16 v[216:219], v[84:87], a[200:203], v[216:219]
    v_mfma_f32_16x16x32_bf16 v[216:219], v[88:91], a[216:219], v[216:219]
    buffer_load_dwordx4 a[108:111], v11, s[36:39], s47 offen offset:1024 sc1
    v_mfma_f32_16x16x32_bf16 v[216:219], v[92:95], a[232:235], v[216:219]
    v_mfma_f32_16x16x32_bf16 v[220:223], v[84:87], a[204:207], v[220:223]
    ds_read_b128 v[84:87], v4 offset:33792
    v_mfma_f32_16x16x32_bf16 v[220:223], v[88:91], a[220:223], v[220:223]
    ds_read_b128 v[88:91], v4 offset:26624
    v_mfma_f32_16x16x32_bf16 v[220:223], v[92:95], a[236:239], v[220:223]
    ds_read_b128 v[92:95], v4 offset:30720
    s_waitcnt lgkmcnt(7)
    v_mfma_f32_16x16x32_bf16 v[160:163], v[64:67], a[240:243], v[160:163]
    s_waitcnt lgkmcnt(6)
    v_mfma_f32_16x16x32_bf16 v[160:163], v[68:71], v[224:227], v[160:163]
    s_waitcnt lgkmcnt(5)
    v_mfma_f32_16x16x32_bf16 v[160:163], v[72:75], v[240:243], v[160:163]
    buffer_load_dwordx4 v3, s[12:15], s30 offen offset:2048 sc1 lds
    v_mfma_f32_16x16x32_bf16 v[164:167], v[64:67], a[244:247], v[164:167]
    s_add_u32 m0, s25, 0
    s_add_u32 s30, s30, 12288
    v_mfma_f32_16x16x32_bf16 v[164:167], v[68:71], v[228:231], v[164:167]
    buffer_load_dwordx4 v3, s[12:15], s30 offen offset:0 sc1 lds
    v_mfma_f32_16x16x32_bf16 v[164:167], v[72:75], v[244:247], v[164:167]
    buffer_load_dwordx4 a[112:115], v3, s[36:39], s47 offen offset:2048 sc1
    v_mfma_f32_16x16x32_bf16 v[168:171], v[64:67], a[248:251], v[168:171]
    v_mfma_f32_16x16x32_bf16 v[168:171], v[68:71], v[232:235], v[168:171]
    v_mfma_f32_16x16x32_bf16 v[168:171], v[72:75], v[248:251], v[168:171]
    v_mfma_f32_16x16x32_bf16 v[172:175], v[64:67], a[252:255], v[172:175]
    ds_read_b128 v[64:67], v4 offset:34816
    v_mfma_f32_16x16x32_bf16 v[172:175], v[68:71], v[236:239], v[172:175]
    ds_read_b128 v[68:71], v4 offset:27648
    v_mfma_f32_16x16x32_bf16 v[172:175], v[72:75], v[252:255], v[172:175]
    ds_read_b128 v[72:75], v4 offset:31744
    s_waitcnt lgkmcnt(7)
    v_mfma_f32_16x16x32_bf16 v[176:179], v[76:79], a[240:243], v[176:179]
    s_waitcnt lgkmcnt(6)
    v_mfma_f32_16x16x32_bf16 v[176:179], v[80:83], v[224:227], v[176:179]
    s_waitcnt lgkmcnt(5)
    v_mfma_f32_16x16x32_bf16 v[176:179], v[84:87], v[240:243], v[176:179]
    buffer_load_dwordx4 a[116:119], v11, s[36:39], s47 offen offset:2048 sc1
    v_mfma_f32_16x16x32_bf16 v[180:183], v[76:79], a[244:247], v[180:183]
    v_mfma_f32_16x16x32_bf16 v[180:183], v[80:83], v[228:231], v[180:183]
    buffer_load_dwordx4 v3, s[12:15], s30 offen offset:1024 sc1 lds
    v_mfma_f32_16x16x32_bf16 v[180:183], v[84:87], v[244:247], v[180:183]
    v_mfma_f32_16x16x32_bf16 v[184:187], v[76:79], a[248:251], v[184:187]
    buffer_load_dwordx4 a[120:123], v3, s[36:39], s47 offen offset:3072 sc1
    v_mfma_f32_16x16x32_bf16 v[184:187], v[80:83], v[232:235], v[184:187]
    v_mfma_f32_16x16x32_bf16 v[184:187], v[84:87], v[248:251], v[184:187]
    v_mfma_f32_16x16x32_bf16 v[188:191], v[76:79], a[252:255], v[188:191]
    ds_read_b128 v[76:79], v4 offset:35840
    v_mfma_f32_16x16x32_bf16 v[188:191], v[80:83], v[236:239], v[188:191]
    ds_read_b128 v[80:83], v8 offset:0
    v_mfma_f32_16x16x32_bf16 v[188:191], v[84:87], v[252:255], v[188:191]
    ds_read_b128 v[84:87], v8 offset:9216
    s_waitcnt lgkmcnt(7)
    v_mfma_f32_16x16x32_bf16 v[192:195], v[88:91], a[240:243], v[192:195]
    s_waitcnt lgkmcnt(6)
    v_mfma_f32_16x16x32_bf16 v[192:195], v[92:95], v[224:227], v[192:195]
    s_waitcnt lgkmcnt(5)
    v_mfma_f32_16x16x32_bf16 v[192:195], v[64:67], v[240:243], v[192:195]
    buffer_load_dwordx4 a[124:127], v11, s[36:39], s47 offen offset:3072 sc1
    v_mfma_f32_16x16x32_bf16 v[196:199], v[88:91], a[244:247], v[196:199]
    v_mfma_f32_16x16x32_bf16 v[196:199], v[92:95], v[228:231], v[196:199]
    buffer_load_dwordx4 v3, s[12:15], s30 offen offset:2048 sc1 lds
    v_mfma_f32_16x16x32_bf16 v[196:199], v[64:67], v[244:247], v[196:199]
    s_add_u32 s47, s47, 4096
    v_mfma_f32_16x16x32_bf16 v[200:203], v[88:91], a[248:251], v[200:203]
    buffer_load_dwordx4 a[128:131], v3, s[36:39], s47 offen offset:0 sc1
    v_mfma_f32_16x16x32_bf16 v[200:203], v[92:95], v[232:235], v[200:203]
    v_mfma_f32_16x16x32_bf16 v[200:203], v[64:67], v[248:251], v[200:203]
    v_mfma_f32_16x16x32_bf16 v[204:207], v[88:91], a[252:255], v[204:207]
    ds_read_b128 v[88:91], v8 offset:1024
    v_mfma_f32_16x16x32_bf16 v[204:207], v[92:95], v[236:239], v[204:207]
    ds_read_b128 v[92:95], v8 offset:10240
    v_mfma_f32_16x16x32_bf16 v[204:207], v[64:67], v[252:255], v[204:207]
    ds_read_b128 v[64:67], v8 offset:2048
    s_waitcnt lgkmcnt(7)
    v_mfma_f32_16x16x32_bf16 v[208:211], v[68:71], a[240:243], v[208:211]
    s_waitcnt lgkmcnt(6)
    v_mfma_f32_16x16x32_bf16 v[208:211], v[72:75], v[224:227], v[208:211]
    s_waitcnt lgkmcnt(5)
    v_mfma_f32_16x16x32_bf16 v[208:211], v[76:79], v[240:243], v[208:211]
    buffer_load_dwordx4 a[132:135], v11, s[36:39], s47 offen offset:0 sc1
    v_mfma_f32_16x16x32_bf16 v[212:215], v[68:71], a[244:247], v[212:215]
    v_mfma_f32_16x16x32_bf16 v[212:215], v[72:75], v[228:231], v[212:215]
    v_mfma_f32_16x16x32_bf16 v[212:215], v[76:79], v[244:247], v[212:215]
    v_mfma_f32_16x16x32_bf16 v[216:219], v[68:71], a[248:251], v[216:219]
    v_mfma_f32_16x16x32_bf16 v[216:219], v[72:75], v[232:235], v[216:219]
    v_mfma_f32_16x16x32_bf16 v[216:219], v[76:79], v[248:251], v[216:219]
    s_barrier
    v_mfma_f32_16x16x32_bf16 v[220:223], v[68:71], a[252:255], v[220:223]
    ds_read_b128 v[68:71], v8 offset:11264
    v_mfma_f32_16x16x32_bf16 v[220:223], v[72:75], v[236:239], v[220:223]
    ds_read_b128 v[72:75], v8 offset:3072
    v_mfma_f32_16x16x32_bf16 v[220:223], v[76:79], v[252:255], v[220:223]
    ds_read_b128 v[76:79], v8 offset:12288
    s_waitcnt vmcnt(45) lgkmcnt(6)
    v_mfma_f32_16x16x32_bf16 v[96:99], v[80:83], a[0:3], 0
    s_add_u32 m0, s25, 12288
    s_add_u32 s30, s30, 12288
    s_waitcnt vmcnt(42)
    v_mfma_f32_16x16x32_bf16 v[96:99], v[84:87], a[8:11], v[96:99]
    buffer_load_dwordx4 v3, s[12:15], s30 offen offset:0 sc1 lds
    v_mfma_f32_16x16x32_bf16 v[100:103], v[80:83], a[4:7], 0
    ds_read_b128 v[80:83], v8 offset:4096
    v_mfma_f32_16x16x32_bf16 v[100:103], v[84:87], a[12:15], v[100:103]
    ds_read_b128 v[84:87], v8 offset:13312
    s_waitcnt lgkmcnt(6)
    v_mfma_f32_16x16x32_bf16 v[104:107], v[88:91], a[0:3], 0
    v_mfma_f32_16x16x32_bf16 v[104:107], v[92:95], a[8:11], v[104:107]
    v_mfma_f32_16x16x32_bf16 v[108:111], v[88:91], a[4:7], 0
    ds_read_b128 v[88:91], v8 offset:5120
    v_mfma_f32_16x16x32_bf16 v[108:111], v[92:95], a[12:15], v[108:111]
    ds_read_b128 v[92:95], v8 offset:14336
    s_waitcnt lgkmcnt(6)
    v_mfma_f32_16x16x32_bf16 v[112:115], v[64:67], a[0:3], 0
    buffer_load_dwordx4 v3, s[12:15], s30 offen offset:1024 sc1 lds
    v_max_f32 v160, 0, v160
    v_mfma_f32_16x16x32_bf16 v[112:115], v[68:71], a[8:11], v[112:115]
    v_max_f32 v161, 0, v161
    v_max_f32 v162, 0, v162
    v_max_f32 v163, 0, v163
    v_mfma_f32_16x16x32_bf16 v[116:119], v[64:67], a[4:7], 0
    ds_read_b128 v[64:67], v8 offset:6144
    v_mul_f32 v160, v160, v176
    v_mul_f32 v161, v161, v177
    v_mfma_f32_16x16x32_bf16 v[116:119], v[68:71], a[12:15], v[116:119]
    ds_read_b128 v[68:71], v8 offset:15360
    v_mul_f32 v162, v162, v178
    s_waitcnt lgkmcnt(6)
    v_mfma_f32_16x16x32_bf16 v[120:123], v[72:75], a[0:3], 0
    v_mul_f32 v163, v163, v179
    v_cvt_pk_bf16_f32 v50, v160, v161
    v_cvt_pk_bf16_f32 v51, v162, v163
    v_mfma_f32_16x16x32_bf16 v[120:123], v[76:79], a[8:11], v[120:123]
    buffer_store_dwordx4 v[48:51], v3, s[36:39], s35 offen sc1
    v_max_f32 v164, 0, v164
    v_mfma_f32_16x16x32_bf16 v[124:127], v[72:75], a[4:7], 0
    ds_read_b128 v[72:75], v8 offset:7168
    v_max_f32 v165, 0, v165
    v_max_f32 v166, 0, v166
    v_mfma_f32_16x16x32_bf16 v[124:127], v[76:79], a[12:15], v[124:127]
    ds_read_b128 v[76:79], v8 offset:16384
    v_max_f32 v167, 0, v167
    s_waitcnt lgkmcnt(6)
    v_mfma_f32_16x16x32_bf16 v[128:131], v[80:83], a[0:3], 0
    buffer_load_dwordx4 v3, s[12:15], s30 offen offset:2048 sc1 lds
    v_mul_f32 v164, v164, v180
    v_mfma_f32_16x16x32_bf16 v[128:131], v[84:87], a[8:11], v[128:131]
    v_mul_f32 v165, v165, v181
    v_mul_f32 v166, v166, v182
    v_mul_f32 v167, v167, v183
    v_mfma_f32_16x16x32_bf16 v[132:135], v[80:83], a[4:7], 0
    ds_read_b128 v[80:83], v8 offset:8192
    v_cvt_pk_bf16_f32 v54, v164, v165
    v_cvt_pk_bf16_f32 v55, v166, v167
    v_mfma_f32_16x16x32_bf16 v[132:135], v[84:87], a[12:15], v[132:135]
    ds_read_b128 v[84:87], v8 offset:17408
    s_waitcnt lgkmcnt(6)
    v_mfma_f32_16x16x32_bf16 v[136:139], v[88:91], a[0:3], 0
    buffer_store_dwordx4 v[52:55], v11, s[36:39], s35 offen sc1
    v_max_f32 v168, 0, v168
    v_mfma_f32_16x16x32_bf16 v[136:139], v[92:95], a[8:11], v[136:139]
    v_max_f32 v169, 0, v169
    v_max_f32 v170, 0, v170
    v_max_f32 v171, 0, v171
    v_mfma_f32_16x16x32_bf16 v[140:143], v[88:91], a[4:7], 0
    ds_read_b128 v[88:91], v8 offset:18432
    v_mul_f32 v168, v168, v184
    v_mul_f32 v169, v169, v185
    v_mfma_f32_16x16x32_bf16 v[140:143], v[92:95], a[12:15], v[140:143]
    ds_read_b128 v[92:95], v8 offset:27648
    v_mul_f32 v170, v170, v186
    s_waitcnt lgkmcnt(6)
    v_mfma_f32_16x16x32_bf16 v[144:147], v[64:67], a[0:3], 0
    v_mul_f32 v171, v171, v187
    v_cvt_pk_bf16_f32 v58, v168, v169
    v_cvt_pk_bf16_f32 v59, v170, v171
    v_mfma_f32_16x16x32_bf16 v[144:147], v[68:71], a[8:11], v[144:147]
    s_add_u32 m0, s25, 24576
    s_add_u32 s30, s30, 12288
    v_mfma_f32_16x16x32_bf16 v[148:151], v[64:67], a[4:7], 0
    ds_read_b128 v[64:67], v8 offset:19456
    v_mfma_f32_16x16x32_bf16 v[148:151], v[68:71], a[12:15], v[148:151]
    ds_read_b128 v[68:71], v8 offset:28672
    s_waitcnt lgkmcnt(6)
    v_mfma_f32_16x16x32_bf16 v[152:155], v[72:75], a[0:3], 0
    buffer_load_dwordx4 v3, s[12:15], s30 offen offset:0 sc1 lds
    v_mfma_f32_16x16x32_bf16 v[152:155], v[76:79], a[8:11], v[152:155]
    buffer_store_dwordx4 v[56:59], v12, s[36:39], s35 offen sc1
    v_max_f32 v172, 0, v172
    v_mfma_f32_16x16x32_bf16 v[156:159], v[72:75], a[4:7], 0
    ds_read_b128 v[72:75], v8 offset:20480
    v_max_f32 v173, 0, v173
    v_max_f32 v174, 0, v174
    v_mfma_f32_16x16x32_bf16 v[156:159], v[76:79], a[12:15], v[156:159]
    ds_read_b128 v[76:79], v8 offset:29696
    v_max_f32 v175, 0, v175
    s_waitcnt lgkmcnt(6)
    v_mfma_f32_16x16x32_bf16 v[40:43], v[80:83], a[0:3], 0
    v_mul_f32 v172, v172, v188
    v_mul_f32 v173, v173, v189
    v_mul_f32 v174, v174, v190
    v_mfma_f32_16x16x32_bf16 v[40:43], v[84:87], a[8:11], v[40:43]
    v_mul_f32 v175, v175, v191
    v_cvt_pk_bf16_f32 v62, v172, v173
    v_cvt_pk_bf16_f32 v63, v174, v175
    v_mfma_f32_16x16x32_bf16 v[44:47], v[80:83], a[4:7], 0
    ds_read_b128 v[80:83], v8 offset:21504
    v_mfma_f32_16x16x32_bf16 v[44:47], v[84:87], a[12:15], v[44:47]
    ds_read_b128 v[84:87], v8 offset:30720
    s_waitcnt vmcnt(47) lgkmcnt(6)
    v_mfma_f32_16x16x32_bf16 v[96:99], v[88:91], a[16:19], v[96:99]
    buffer_load_dwordx4 v3, s[12:15], s30 offen offset:1024 sc1 lds
    s_waitcnt vmcnt(46)
    v_mfma_f32_16x16x32_bf16 v[96:99], v[92:95], a[24:27], v[96:99]
    buffer_store_dwordx4 v[60:63], v13, s[36:39], s35 offen sc1
    v_max_f32 v192, 0, v192
    v_mfma_f32_16x16x32_bf16 v[100:103], v[88:91], a[20:23], v[100:103]
    ds_read_b128 v[88:91], v8 offset:22528
    v_max_f32 v193, 0, v193
    v_max_f32 v194, 0, v194
    v_mfma_f32_16x16x32_bf16 v[100:103], v[92:95], a[28:31], v[100:103]
    ds_read_b128 v[92:95], v8 offset:31744
    v_max_f32 v195, 0, v195
    s_waitcnt lgkmcnt(6)
    v_mfma_f32_16x16x32_bf16 v[104:107], v[64:67], a[16:19], v[104:107]
    v_mul_f32 v192, v192, v208
    v_mul_f32 v193, v193, v209
    v_mul_f32 v194, v194, v210
    v_mfma_f32_16x16x32_bf16 v[104:107], v[68:71], a[24:27], v[104:107]
    v_mul_f32 v195, v195, v211
    v_cvt_pk_bf16_f32 v48, v192, v193
    v_cvt_pk_bf16_f32 v49, v194, v195
    v_mfma_f32_16x16x32_bf16 v[108:111], v[64:67], a[20:23], v[108:111]
    ds_read_b128 v[64:67], v8 offset:23552
    v_mfma_f32_16x16x32_bf16 v[108:111], v[68:71], a[28:31], v[108:111]
    ds_read_b128 v[68:71], v8 offset:32768
    s_waitcnt lgkmcnt(6)
    v_mfma_f32_16x16x32_bf16 v[112:115], v[72:75], a[16:19], v[112:115]
    buffer_load_dwordx4 v3, s[12:15], s30 offen offset:2048 sc1 lds
    v_mfma_f32_16x16x32_bf16 v[112:115], v[76:79], a[24:27], v[112:115]
    buffer_store_dwordx2 v[48:49], v14, s[36:39], s44 offen sc1
    v_max_f32 v196, 0, v196
    v_mfma_f32_16x16x32_bf16 v[116:119], v[72:75], a[20:23], v[116:119]
    ds_read_b128 v[72:75], v8 offset:24576
    v_max_f32 v197, 0, v197
    v_max_f32 v198, 0, v198
    v_mfma_f32_16x16x32_bf16 v[116:119], v[76:79], a[28:31], v[116:119]
    ds_read_b128 v[76:79], v8 offset:33792
    v_max_f32 v199, 0, v199
    s_waitcnt lgkmcnt(6)
    v_mfma_f32_16x16x32_bf16 v[120:123], v[80:83], a[16:19], v[120:123]
    v_mul_f32 v196, v196, v212
    v_mul_f32 v197, v197, v213
    v_mul_f32 v198, v198, v214
    v_mfma_f32_16x16x32_bf16 v[120:123], v[84:87], a[24:27], v[120:123]
    v_mul_f32 v199, v199, v215
    v_cvt_pk_bf16_f32 v52, v196, v197
    v_cvt_pk_bf16_f32 v53, v198, v199
    v_mfma_f32_16x16x32_bf16 v[124:127], v[80:83], a[20:23], v[124:127]
    ds_read_b128 v[80:83], v8 offset:25600
    v_mfma_f32_16x16x32_bf16 v[124:127], v[84:87], a[28:31], v[124:127]
    ds_read_b128 v[84:87], v8 offset:34816
    s_waitcnt lgkmcnt(6)
    v_mfma_f32_16x16x32_bf16 v[128:131], v[88:91], a[16:19], v[128:131]
    buffer_store_dwordx2 v[52:53], v15, s[36:39], s44 offen sc1
    v_max_f32 v200, 0, v200
    v_mfma_f32_16x16x32_bf16 v[128:131], v[92:95], a[24:27], v[128:131]
    v_max_f32 v201, 0, v201
    v_max_f32 v202, 0, v202
    v_max_f32 v203, 0, v203
    v_mfma_f32_16x16x32_bf16 v[132:135], v[88:91], a[20:23], v[132:135]
    ds_read_b128 v[88:91], v8 offset:26624
    v_mul_f32 v200, v200, v216
    v_mul_f32 v201, v201, v217
    v_mfma_f32_16x16x32_bf16 v[132:135], v[92:95], a[28:31], v[132:135]
    ds_read_b128 v[92:95], v8 offset:35840
    v_mul_f32 v202, v202, v218
    s_waitcnt lgkmcnt(6)
    v_mfma_f32_16x16x32_bf16 v[136:139], v[64:67], a[16:19], v[136:139]
    v_mul_f32 v203, v203, v219
    v_cvt_pk_bf16_f32 v56, v200, v201
    v_cvt_pk_bf16_f32 v57, v202, v203
    v_mfma_f32_16x16x32_bf16 v[136:139], v[68:71], a[24:27], v[136:139]
    s_barrier
    v_mfma_f32_16x16x32_bf16 v[140:143], v[64:67], a[20:23], v[140:143]
    ds_read_b128 v[64:67], v9 offset:0
    s_add_u32 m0, s25, 36864
    v_mfma_f32_16x16x32_bf16 v[140:143], v[68:71], a[28:31], v[140:143]
    ds_read_b128 v[68:71], v9 offset:9216
    s_waitcnt lgkmcnt(6)
    v_mfma_f32_16x16x32_bf16 v[144:147], v[72:75], a[16:19], v[144:147]
    s_add_u32 s30, s30, 12288
    v_mfma_f32_16x16x32_bf16 v[144:147], v[76:79], a[24:27], v[144:147]
    buffer_load_dwordx4 v3, s[12:15], s30 offen offset:0 sc1 lds
    v_mfma_f32_16x16x32_bf16 v[148:151], v[72:75], a[20:23], v[148:151]
    ds_read_b128 v[72:75], v9 offset:1024
    v_mfma_f32_16x16x32_bf16 v[148:151], v[76:79], a[28:31], v[148:151]
    ds_read_b128 v[76:79], v9 offset:10240
    s_waitcnt lgkmcnt(6)
    v_mfma_f32_16x16x32_bf16 v[152:155], v[80:83], a[16:19], v[152:155]
    buffer_store_dwordx2 v[56:57], v16, s[36:39], s44 offen sc1
    v_max_f32 v204, 0, v204
    v_mfma_f32_16x16x32_bf16 v[152:155], v[84:87], a[24:27], v[152:155]
    buffer_load_dwordx4 v3, s[12:15], s30 offen offset:1024 sc1 lds
    v_max_f32 v205, 0, v205
    v_mfma_f32_16x16x32_bf16 v[156:159], v[80:83], a[20:23], v[156:159]
    ds_read_b128 v[80:83], v9 offset:2048
    v_max_f32 v206, 0, v206
    v_max_f32 v207, 0, v207
    v_mfma_f32_16x16x32_bf16 v[156:159], v[84:87], a[28:31], v[156:159]
    ds_read_b128 v[84:87], v9 offset:11264
    v_mul_f32 v204, v204, v220
    s_waitcnt lgkmcnt(6)
    v_mfma_f32_16x16x32_bf16 v[40:43], v[88:91], a[16:19], v[40:43]
    v_mul_f32 v205, v205, v221
    v_mul_f32 v206, v206, v222
    v_mul_f32 v207, v207, v223
    v_mfma_f32_16x16x32_bf16 v[40:43], v[92:95], a[24:27], v[40:43]
    buffer_load_dwordx4 v3, s[12:15], s30 offen offset:2048 sc1 lds
    v_cvt_pk_bf16_f32 v60, v204, v205
    v_mfma_f32_16x16x32_bf16 v[44:47], v[88:91], a[20:23], v[44:47]
    ds_read_b128 v[88:91], v9 offset:3072
    v_cvt_pk_bf16_f32 v61, v206, v207
    v_mfma_f32_16x16x32_bf16 v[44:47], v[92:95], a[28:31], v[44:47]
    ds_read_b128 v[92:95], v9 offset:12288
    s_waitcnt vmcnt(51) lgkmcnt(6)
    v_mfma_f32_16x16x32_bf16 v[96:99], v[64:67], a[32:35], v[96:99]
    buffer_store_dwordx2 v[60:61], v17, s[36:39], s44 offen sc1
    s_waitcnt vmcnt(49)
    v_mfma_f32_16x16x32_bf16 v[96:99], v[68:71], a[40:43], v[96:99]
    v_mfma_f32_16x16x32_bf16 v[100:103], v[64:67], a[36:39], v[100:103]
    ds_read_b128 v[64:67], v9 offset:4096
    v_mfma_f32_16x16x32_bf16 v[100:103], v[68:71], a[44:47], v[100:103]
    ds_read_b128 v[68:71], v9 offset:13312
    s_waitcnt lgkmcnt(6)
    v_mfma_f32_16x16x32_bf16 v[104:107], v[72:75], a[32:35], v[104:107]
    s_add_u32 m0, s25, 49152
    s_add_u32 s30, s30, 12288
    v_mfma_f32_16x16x32_bf16 v[104:107], v[76:79], a[40:43], v[104:107]
    buffer_load_dwordx4 v3, s[12:15], s30 offen offset:0 sc1 lds
    v_mfma_f32_16x16x32_bf16 v[108:111], v[72:75], a[36:39], v[108:111]
    ds_read_b128 v[72:75], v9 offset:5120
    v_mfma_f32_16x16x32_bf16 v[108:111], v[76:79], a[44:47], v[108:111]
    ds_read_b128 v[76:79], v9 offset:14336
    s_waitcnt lgkmcnt(6)
    v_mfma_f32_16x16x32_bf16 v[112:115], v[80:83], a[32:35], v[112:115]
    v_mfma_f32_16x16x32_bf16 v[112:115], v[84:87], a[40:43], v[112:115]
    v_mfma_f32_16x16x32_bf16 v[116:119], v[80:83], a[36:39], v[116:119]
    ds_read_b128 v[80:83], v9 offset:6144
    v_mfma_f32_16x16x32_bf16 v[116:119], v[84:87], a[44:47], v[116:119]
    ds_read_b128 v[84:87], v9 offset:15360
    s_waitcnt lgkmcnt(6)
    v_mfma_f32_16x16x32_bf16 v[120:123], v[88:91], a[32:35], v[120:123]
    buffer_load_dwordx4 v3, s[12:15], s30 offen offset:1024 sc1 lds
    v_mfma_f32_16x16x32_bf16 v[120:123], v[92:95], a[40:43], v[120:123]
    v_mfma_f32_16x16x32_bf16 v[124:127], v[88:91], a[36:39], v[124:127]
    ds_read_b128 v[88:91], v9 offset:7168
    v_mfma_f32_16x16x32_bf16 v[124:127], v[92:95], a[44:47], v[124:127]
    ds_read_b128 v[92:95], v9 offset:16384
    s_waitcnt lgkmcnt(6)
    v_mfma_f32_16x16x32_bf16 v[128:131], v[64:67], a[32:35], v[128:131]
    v_mfma_f32_16x16x32_bf16 v[128:131], v[68:71], a[40:43], v[128:131]
    v_mfma_f32_16x16x32_bf16 v[132:135], v[64:67], a[36:39], v[132:135]
    ds_read_b128 v[64:67], v9 offset:8192
    v_mfma_f32_16x16x32_bf16 v[132:135], v[68:71], a[44:47], v[132:135]
    ds_read_b128 v[68:71], v9 offset:17408
    s_waitcnt lgkmcnt(6)
    v_mfma_f32_16x16x32_bf16 v[136:139], v[72:75], a[32:35], v[136:139]
    buffer_load_dwordx4 v3, s[12:15], s30 offen offset:2048 sc1 lds
    v_mfma_f32_16x16x32_bf16 v[136:139], v[76:79], a[40:43], v[136:139]
    s_waitcnt vmcnt(50)
    s_barrier
    v_mfma_f32_16x16x32_bf16 v[140:143], v[72:75], a[36:39], v[140:143]
    ds_read_b128 v[72:75], v9 offset:18432
    v_mfma_f32_16x16x32_bf16 v[140:143], v[76:79], a[44:47], v[140:143]
    ds_read_b128 v[76:79], v9 offset:27648
    s_waitcnt lgkmcnt(6)
    v_mfma_f32_16x16x32_bf16 v[144:147], v[80:83], a[32:35], v[144:147]
    v_mfma_f32_16x16x32_bf16 v[144:147], v[84:87], a[40:43], v[144:147]
    v_mfma_f32_16x16x32_bf16 v[148:151], v[80:83], a[36:39], v[148:151]
    ds_read_b128 v[80:83], v9 offset:19456
    v_mfma_f32_16x16x32_bf16 v[148:151], v[84:87], a[44:47], v[148:151]
    ds_read_b128 v[84:87], v9 offset:28672
    s_waitcnt lgkmcnt(6)
    v_mfma_f32_16x16x32_bf16 v[152:155], v[88:91], a[32:35], v[152:155]
    v_mfma_f32_16x16x32_bf16 v[152:155], v[92:95], a[40:43], v[152:155]
    s_add_u32 m0, s25, 61440
    s_add_u32 s30, s30, 12288
    v_mfma_f32_16x16x32_bf16 v[156:159], v[88:91], a[36:39], v[156:159]
    ds_read_b128 v[88:91], v9 offset:20480
    v_mfma_f32_16x16x32_bf16 v[156:159], v[92:95], a[44:47], v[156:159]
    ds_read_b128 v[92:95], v9 offset:29696
    s_waitcnt lgkmcnt(6)
    v_mfma_f32_16x16x32_bf16 v[40:43], v[64:67], a[32:35], v[40:43]
    buffer_load_dwordx4 v3, s[12:15], s30 offen offset:0 sc1 lds
    v_mfma_f32_16x16x32_bf16 v[40:43], v[68:71], a[40:43], v[40:43]
    v_mfma_f32_16x16x32_bf16 v[44:47], v[64:67], a[36:39], v[44:47]
    ds_read_b128 v[64:67], v9 offset:21504
    v_mfma_f32_16x16x32_bf16 v[44:47], v[68:71], a[44:47], v[44:47]
    ds_read_b128 v[68:71], v9 offset:30720
    s_waitcnt vmcnt(49) lgkmcnt(6)
    v_mfma_f32_16x16x32_bf16 v[96:99], v[72:75], a[48:51], v[96:99]
    s_waitcnt vmcnt(46)
    v_mfma_f32_16x16x32_bf16 v[96:99], v[76:79], a[56:59], v[96:99]
    v_mfma_f32_16x16x32_bf16 v[100:103], v[72:75], a[52:55], v[100:103]
    ds_read_b128 v[72:75], v9 offset:22528
    v_mfma_f32_16x16x32_bf16 v[100:103], v[76:79], a[60:63], v[100:103]
    ds_read_b128 v[76:79], v9 offset:31744
    s_waitcnt lgkmcnt(6)
    v_mfma_f32_16x16x32_bf16 v[104:107], v[80:83], a[48:51], v[104:107]
    buffer_load_dwordx4 v3, s[12:15], s30 offen offset:1024 sc1 lds
    v_mfma_f32_16x16x32_bf16 v[104:107], v[84:87], a[56:59], v[104:107]
    buffer_load_dwordx4 a[136:139], v3, s[36:39], s47 offen offset:1024 sc1
    v_mfma_f32_16x16x32_bf16 v[108:111], v[80:83], a[52:55], v[108:111]
    ds_read_b128 v[80:83], v9 offset:23552
    v_mfma_f32_16x16x32_bf16 v[108:111], v[84:87], a[60:63], v[108:111]
    ds_read_b128 v[84:87], v9 offset:32768
    s_waitcnt lgkmcnt(6)
    v_mfma_f32_16x16x32_bf16 v[112:115], v[88:91], a[48:51], v[112:115]
    v_mfma_f32_16x16x32_bf16 v[112:115], v[92:95], a[56:59], v[112:115]
    v_mfma_f32_16x16x32_bf16 v[116:119], v[88:91], a[52:55], v[116:119]
    ds_read_b128 v[88:91], v9 offset:24576
    v_mfma_f32_16x16x32_bf16 v[116:119], v[92:95], a[60:63], v[116:119]
    ds_read_b128 v[92:95], v9 offset:33792
    s_waitcnt lgkmcnt(6)
    v_mfma_f32_16x16x32_bf16 v[120:123], v[64:67], a[48:51], v[120:123]
    buffer_load_dwordx4 v3, s[12:15], s30 offen offset:2048 sc1 lds
    v_mfma_f32_16x16x32_bf16 v[120:123], v[68:71], a[56:59], v[120:123]
    buffer_load_dwordx4 a[140:143], v11, s[36:39], s47 offen offset:1024 sc1
    v_mfma_f32_16x16x32_bf16 v[124:127], v[64:67], a[52:55], v[124:127]
    ds_read_b128 v[64:67], v9 offset:25600
    v_mfma_f32_16x16x32_bf16 v[124:127], v[68:71], a[60:63], v[124:127]
    ds_read_b128 v[68:71], v9 offset:34816
    s_waitcnt lgkmcnt(6)
    v_mfma_f32_16x16x32_bf16 v[128:131], v[72:75], a[48:51], v[128:131]
    v_mfma_f32_16x16x32_bf16 v[128:131], v[76:79], a[56:59], v[128:131]
    v_mfma_f32_16x16x32_bf16 v[132:135], v[72:75], a[52:55], v[132:135]
    ds_read_b128 v[72:75], v9 offset:26624
    v_mfma_f32_16x16x32_bf16 v[132:135], v[76:79], a[60:63], v[132:135]
    ds_read_b128 v[76:79], v9 offset:35840
    s_waitcnt lgkmcnt(6)
    v_mfma_f32_16x16x32_bf16 v[136:139], v[80:83], a[48:51], v[136:139]
    v_mfma_f32_16x16x32_bf16 v[136:139], v[84:87], a[56:59], v[136:139]
    buffer_load_dwordx4 a[144:147], v3, s[36:39], s47 offen offset:2048 sc1
    v_mfma_f32_16x16x32_bf16 v[140:143], v[80:83], a[52:55], v[140:143]
    ds_read_b128 v[80:83], v10 offset:0
    v_mfma_f32_16x16x32_bf16 v[140:143], v[84:87], a[60:63], v[140:143]
    ds_read_b128 v[84:87], v10 offset:9216
    s_waitcnt lgkmcnt(6)
    v_mfma_f32_16x16x32_bf16 v[144:147], v[88:91], a[48:51], v[144:147]
    v_mfma_f32_16x16x32_bf16 v[144:147], v[92:95], a[56:59], v[144:147]
    v_mfma_f32_16x16x32_bf16 v[148:151], v[88:91], a[52:55], v[148:151]
    ds_read_b128 v[88:91], v10 offset:1024
    v_mfma_f32_16x16x32_bf16 v[148:151], v[92:95], a[60:63], v[148:151]
    ds_read_b128 v[92:95], v10 offset:10240
    s_waitcnt lgkmcnt(6)
    v_mfma_f32_16x16x32_bf16 v[152:155], v[64:67], a[48:51], v[152:155]
    v_mfma_f32_16x16x32_bf16 v[152:155], v[68:71], a[56:59], v[152:155]
    buffer_load_dwordx4 a[148:151], v11, s[36:39], s47 offen offset:2048 sc1
    v_mfma_f32_16x16x32_bf16 v[156:159], v[64:67], a[52:55], v[156:159]
    ds_read_b128 v[64:67], v10 offset:2048
    v_mfma_f32_16x16x32_bf16 v[156:159], v[68:71], a[60:63], v[156:159]
    ds_read_b128 v[68:71], v10 offset:11264
    s_waitcnt lgkmcnt(6)
    v_mfma_f32_16x16x32_bf16 v[40:43], v[72:75], a[48:51], v[40:43]
    v_mfma_f32_16x16x32_bf16 v[40:43], v[76:79], a[56:59], v[40:43]
    s_waitcnt vmcnt(36)
    s_barrier
    v_mfma_f32_16x16x32_bf16 v[44:47], v[72:75], a[52:55], v[44:47]
    ds_read_b128 v[72:75], v10 offset:3072
    s_add_u32 m0, s26, 0
    v_mfma_f32_16x16x32_bf16 v[44:47], v[76:79], a[60:63], v[44:47]
    ds_read_b128 v[76:79], v10 offset:12288
    s_waitcnt lgkmcnt(6)
    v_mfma_f32_16x16x32_bf16 v[96:99], v[80:83], a[64:67], v[96:99]
    s_add_u32 s30, s30, 12288
    v_mfma_f32_16x16x32_bf16 v[96:99], v[84:87], a[72:75], v[96:99]
    buffer_load_dwordx4 v3, s[12:15], s30 offen offset:0 sc1 lds
    v_mfma_f32_16x16x32_bf16 v[100:103], v[80:83], a[68:71], v[100:103]
    ds_read_b128 v[80:83], v10 offset:4096
    v_mfma_f32_16x16x32_bf16 v[100:103], v[84:87], a[76:79], v[100:103]
    ds_read_b128 v[84:87], v10 offset:13312
    s_waitcnt vmcnt(11)
    s_mov_b64 exec, 1
    buffer_store_dword v21, off, s[40:43], s52 offset:128 sc1
    s_mov_b64 exec, -1
    s_waitcnt lgkmcnt(6)
    v_mfma_f32_16x16x32_bf16 v[104:107], v[88:91], a[64:67], v[104:107]
    buffer_load_dwordx4 v3, s[12:15], s30 offen offset:1024 sc1 lds
    v_mfma_f32_16x16x32_bf16 v[104:107], v[92:95], a[72:75], v[104:107]
    buffer_load_dwordx4 a[152:155], v3, s[36:39], s47 offen offset:3072 sc1
    v_mfma_f32_16x16x32_bf16 v[108:111], v[88:91], a[68:71], v[108:111]
    ds_read_b128 v[88:91], v10 offset:5120
    v_mfma_f32_16x16x32_bf16 v[108:111], v[92:95], a[76:79], v[108:111]
    ds_read_b128 v[92:95], v10 offset:14336
    s_waitcnt lgkmcnt(6)
    v_mfma_f32_16x16x32_bf16 v[112:115], v[64:67], a[64:67], v[112:115]
    buffer_load_dwordx4 v3, s[12:15], s30 offen offset:2048 sc1 lds
    v_mfma_f32_16x16x32_bf16 v[112:115], v[68:71], a[72:75], v[112:115]
    s_add_u32 m0, s26, 12288
    s_add_u32 s30, s30, 12288
    v_mfma_f32_16x16x32_bf16 v[116:119], v[64:67], a[68:71], v[116:119]
    ds_read_b128 v[64:67], v10 offset:6144
    v_mfma_f32_16x16x32_bf16 v[116:119], v[68:71], a[76:79], v[116:119]
    ds_read_b128 v[68:71], v10 offset:15360
    s_waitcnt lgkmcnt(6)
    v_mfma_f32_16x16x32_bf16 v[120:123], v[72:75], a[64:67], v[120:123]
    buffer_load_dwordx4 v3, s[12:15], s30 offen offset:0 sc1 lds
    v_mfma_f32_16x16x32_bf16 v[120:123], v[76:79], a[72:75], v[120:123]
    buffer_load_dwordx4 a[156:159], v11, s[36:39], s47 offen offset:3072 sc1
    v_mfma_f32_16x16x32_bf16 v[124:127], v[72:75], a[68:71], v[124:127]
    ds_read_b128 v[72:75], v10 offset:7168
    v_mfma_f32_16x16x32_bf16 v[124:127], v[76:79], a[76:79], v[124:127]
    ds_read_b128 v[76:79], v10 offset:16384
    s_waitcnt lgkmcnt(6)
    v_mfma_f32_16x16x32_bf16 v[128:131], v[80:83], a[64:67], v[128:131]
    v_mfma_f32_16x16x32_bf16 v[128:131], v[84:87], a[72:75], v[128:131]
    v_mfma_f32_16x16x32_bf16 v[132:135], v[80:83], a[68:71], v[132:135]
    ds_read_b128 v[80:83], v10 offset:8192
    v_mfma_f32_16x16x32_bf16 v[132:135], v[84:87], a[76:79], v[132:135]
    ds_read_b128 v[84:87], v10 offset:17408
    s_waitcnt lgkmcnt(6)
    v_mfma_f32_16x16x32_bf16 v[136:139], v[88:91], a[64:67], v[136:139]
    buffer_load_dwordx4 v3, s[12:15], s30 offen offset:1024 sc1 lds
    v_mfma_f32_16x16x32_bf16 v[136:139], v[92:95], a[72:75], v[136:139]
    s_add_u32 s47, s47, 4096
    v_mfma_f32_16x16x32_bf16 v[140:143], v[88:91], a[68:71], v[140:143]
    ds_read_b128 v[88:91], v10 offset:18432
    v_mfma_f32_16x16x32_bf16 v[140:143], v[92:95], a[76:79], v[140:143]
    ds_read_b128 v[92:95], v10 offset:27648
    s_waitcnt lgkmcnt(6)
    v_mfma_f32_16x16x32_bf16 v[144:147], v[64:67], a[64:67], v[144:147]
    buffer_load_dwordx4 a[160:163], v3, s[36:39], s47 offen offset:0 sc1
    v_mfma_f32_16x16x32_bf16 v[144:147], v[68:71], a[72:75], v[144:147]
    v_mfma_f32_16x16x32_bf16 v[148:151], v[64:67], a[68:71], v[148:151]
    ds_read_b128 v[64:67], v10 offset:19456
    v_mfma_f32_16x16x32_bf16 v[148:151], v[68:71], a[76:79], v[148:151]
    ds_read_b128 v[68:71], v10 offset:28672
    s_waitcnt lgkmcnt(6)
    v_mfma_f32_16x16x32_bf16 v[152:155], v[72:75], a[64:67], v[152:155]
    buffer_load_dwordx4 v3, s[12:15], s30 offen offset:2048 sc1 lds
    v_mfma_f32_16x16x32_bf16 v[152:155], v[76:79], a[72:75], v[152:155]
    v_mfma_f32_16x16x32_bf16 v[156:159], v[72:75], a[68:71], v[156:159]
    ds_read_b128 v[72:75], v10 offset:20480
    v_mfma_f32_16x16x32_bf16 v[156:159], v[76:79], a[76:79], v[156:159]
    ds_read_b128 v[76:79], v10 offset:29696
    s_waitcnt lgkmcnt(6)
    v_mfma_f32_16x16x32_bf16 v[40:43], v[80:83], a[64:67], v[40:43]
    s_add_u32 m0, s26, 24576
    s_add_u32 s30, s30, 12288
    v_mfma_f32_16x16x32_bf16 v[40:43], v[84:87], a[72:75], v[40:43]
    buffer_load_dwordx4 v3, s[12:15], s30 offen offset:0 sc1 lds
    v_mfma_f32_16x16x32_bf16 v[44:47], v[80:83], a[68:71], v[44:47]
    ds_read_b128 v[80:83], v10 offset:21504
    v_mfma_f32_16x16x32_bf16 v[44:47], v[84:87], a[76:79], v[44:47]
    ds_read_b128 v[84:87], v10 offset:30720
    s_waitcnt lgkmcnt(6)
    v_mfma_f32_16x16x32_bf16 v[96:99], v[88:91], a[80:83], v[96:99]
    buffer_load_dwordx4 a[164:167], v11, s[36:39], s47 offen offset:0 sc1
    v_mfma_f32_16x16x32_bf16 v[96:99], v[92:95], a[88:91], v[96:99]
    v_mfma_f32_16x16x32_bf16 v[100:103], v[88:91], a[84:87], v[100:103]
    ds_read_b128 v[88:91], v10 offset:22528
    v_mfma_f32_16x16x32_bf16 v[100:103], v[92:95], a[92:95], v[100:103]
    ds_read_b128 v[92:95], v10 offset:31744
    s_waitcnt lgkmcnt(6)
    v_mfma_f32_16x16x32_bf16 v[104:107], v[64:67], a[80:83], v[104:107]
    buffer_load_dwordx4 v3, s[12:15], s30 offen offset:1024 sc1 lds
    v_mfma_f32_16x16x32_bf16 v[104:107], v[68:71], a[88:91], v[104:107]
    v_mfma_f32_16x16x32_bf16 v[108:111], v[64:67], a[84:87], v[108:111]
    ds_read_b128 v[64:67], v10 offset:23552
    v_mfma_f32_16x16x32_bf16 v[108:111], v[68:71], a[92:95], v[108:111]
    ds_read_b128 v[68:71], v10 offset:32768
    s_waitcnt lgkmcnt(6)
    v_mfma_f32_16x16x32_bf16 v[112:115], v[72:75], a[80:83], v[112:115]
    buffer_load_dwordx4 a[168:171], v3, s[36:39], s47 offen offset:1024 sc1
    v_mfma_f32_16x16x32_bf16 v[112:115], v[76:79], a[88:91], v[112:115]
    v_mfma_f32_16x16x32_bf16 v[116:119], v[72:75], a[84:87], v[116:119]
    ds_read_b128 v[72:75], v10 offset:24576
    v_mfma_f32_16x16x32_bf16 v[116:119], v[76:79], a[92:95], v[116:119]
    ds_read_b128 v[76:79], v10 offset:33792
    s_waitcnt lgkmcnt(6)
    v_mfma_f32_16x16x32_bf16 v[120:123], v[80:83], a[80:83], v[120:123]
    buffer_load_dwordx4 v3, s[12:15], s30 offen offset:2048 sc1 lds
    v_mfma_f32_16x16x32_bf16 v[120:123], v[84:87], a[88:91], v[120:123]
    v_mfma_f32_16x16x32_bf16 v[124:127], v[80:83], a[84:87], v[124:127]
    ds_read_b128 v[80:83], v10 offset:25600
    v_mfma_f32_16x16x32_bf16 v[124:127], v[84:87], a[92:95], v[124:127]
    ds_read_b128 v[84:87], v10 offset:34816
    s_waitcnt lgkmcnt(6)
    v_mfma_f32_16x16x32_bf16 v[128:131], v[88:91], a[80:83], v[128:131]
    buffer_load_dwordx4 a[172:175], v11, s[36:39], s47 offen offset:1024 sc1
    v_mfma_f32_16x16x32_bf16 v[128:131], v[92:95], a[88:91], v[128:131]
    v_mfma_f32_16x16x32_bf16 v[132:135], v[88:91], a[84:87], v[132:135]
    ds_read_b128 v[88:91], v10 offset:26624
    v_mfma_f32_16x16x32_bf16 v[132:135], v[92:95], a[92:95], v[132:135]
    ds_read_b128 v[92:95], v10 offset:35840
    s_waitcnt lgkmcnt(6)
    v_mfma_f32_16x16x32_bf16 v[136:139], v[64:67], a[80:83], v[136:139]
    v_mfma_f32_16x16x32_bf16 v[136:139], v[68:71], a[88:91], v[136:139]
    s_barrier
    v_mfma_f32_16x16x32_bf16 v[140:143], v[64:67], a[84:87], v[140:143]
    ds_read_b128 v[64:67], v4 offset:0
    s_add_u32 m0, s26, 36864
    v_mfma_f32_16x16x32_bf16 v[140:143], v[68:71], a[92:95], v[140:143]
    ds_read_b128 v[68:71], v4 offset:9216
    s_waitcnt lgkmcnt(6)
    v_mfma_f32_16x16x32_bf16 v[144:147], v[72:75], a[80:83], v[144:147]
    s_add_u32 s30, s30, 12288
    v_mfma_f32_16x16x32_bf16 v[144:147], v[76:79], a[88:91], v[144:147]
    buffer_load_dwordx4 v3, s[12:15], s30 offen offset:0 sc1 lds
    v_mfma_f32_16x16x32_bf16 v[148:151], v[72:75], a[84:87], v[148:151]
    ds_read_b128 v[72:75], v4 offset:1024
    v_mfma_f32_16x16x32_bf16 v[148:151], v[76:79], a[92:95], v[148:151]
    ds_read_b128 v[76:79], v4 offset:10240
    s_waitcnt lgkmcnt(6)
    v_mfma_f32_16x16x32_bf16 v[152:155], v[80:83], a[80:83], v[152:155]
    buffer_load_dwordx4 a[176:179], v3, s[36:39], s47 offen offset:2048 sc1
    v_mfma_f32_16x16x32_bf16 v[152:155], v[84:87], a[88:91], v[152:155]
    v_mfma_f32_16x16x32_bf16 v[156:159], v[80:83], a[84:87], v[156:159]
    ds_read_b128 v[80:83], v4 offset:2048
    v_mfma_f32_16x16x32_bf16 v[156:159], v[84:87], a[92:95], v[156:159]
    ds_read_b128 v[84:87], v4 offset:11264
    s_waitcnt lgkmcnt(6)
    v_mfma_f32_16x16x32_bf16 v[40:43], v[88:91], a[80:83], v[40:43]
    buffer_load_dwordx4 v3, s[12:15], s30 offen offset:1024 sc1 lds
    v_mfma_f32_16x16x32_bf16 v[40:43], v[92:95], a[88:91], v[40:43]
    v_mfma_f32_16x16x32_bf16 v[44:47], v[88:91], a[84:87], v[44:47]
    ds_read_b128 v[88:91], v4 offset:3072
    v_mfma_f32_16x16x32_bf16 v[44:47], v[92:95], a[92:95], v[44:47]
    ds_read_b128 v[92:95], v4 offset:12288
    s_waitcnt lgkmcnt(6)
    v_mfma_f32_16x16x32_bf16 v[96:99], v[64:67], a[96:99], v[96:99]
    buffer_load_dwordx4 a[180:183], v11, s[36:39], s47 offen offset:2048 sc1
    v_mfma_f32_16x16x32_bf16 v[96:99], v[68:71], a[104:107], v[96:99]
    v_mfma_f32_16x16x32_bf16 v[100:103], v[64:67], a[100:103], v[100:103]
    ds_read_b128 v[64:67], v4 offset:4096
    v_mfma_f32_16x16x32_bf16 v[100:103], v[68:71], a[108:111], v[100:103]
    ds_read_b128 v[68:71], v4 offset:13312
    s_waitcnt lgkmcnt(6)
    v_mfma_f32_16x16x32_bf16 v[104:107], v[72:75], a[96:99], v[104:107]
    buffer_load_dwordx4 v3, s[12:15], s30 offen offset:2048 sc1 lds
    v_mfma_f32_16x16x32_bf16 v[104:107], v[76:79], a[104:107], v[104:107]
    buffer_load_dword v22, v19, s[40:43], s53 offen offset:128 sc1
    v_mfma_f32_16x16x32_bf16 v[108:111], v[72:75], a[100:103], v[108:111]
    ds_read_b128 v[72:75], v4 offset:5120
    v_mfma_f32_16x16x32_bf16 v[108:111], v[76:79], a[108:111], v[108:111]
    ds_read_b128 v[76:79], v4 offset:14336
    s_waitcnt lgkmcnt(6)
    v_mfma_f32_16x16x32_bf16 v[112:115], v[80:83], a[96:99], v[112:115]
    buffer_load_dwordx4 a[184:187], v3, s[36:39], s47 offen offset:3072 sc1
    v_mfma_f32_16x16x32_bf16 v[112:115], v[84:87], a[104:107], v[112:115]
    v_mfma_f32_16x16x32_bf16 v[116:119], v[80:83], a[100:103], v[116:119]
    ds_read_b128 v[80:83], v4 offset:6144
    v_mfma_f32_16x16x32_bf16 v[116:119], v[84:87], a[108:111], v[116:119]
    ds_read_b128 v[84:87], v4 offset:15360
    s_waitcnt lgkmcnt(6)
    v_mfma_f32_16x16x32_bf16 v[120:123], v[88:91], a[96:99], v[120:123]
    s_add_u32 m0, s26, 49152
    s_add_u32 s30, s30, 12288
    v_mfma_f32_16x16x32_bf16 v[120:123], v[92:95], a[104:107], v[120:123]
    buffer_load_dwordx4 v3, s[12:15], s30 offen offset:0 sc1 lds
    v_mfma_f32_16x16x32_bf16 v[124:127], v[88:91], a[100:103], v[124:127]
    ds_read_b128 v[88:91], v4 offset:7168
    v_mfma_f32_16x16x32_bf16 v[124:127], v[92:95], a[108:111], v[124:127]
    ds_read_b128 v[92:95], v4 offset:16384
    s_waitcnt lgkmcnt(6)
    v_mfma_f32_16x16x32_bf16 v[128:131], v[64:67], a[96:99], v[128:131]
    buffer_load_dwordx4 a[188:191], v11, s[36:39], s47 offen offset:3072 sc1
    v_mfma_f32_16x16x32_bf16 v[128:131], v[68:71], a[104:107], v[128:131]
    v_mfma_f32_16x16x32_bf16 v[132:135], v[64:67], a[100:103], v[132:135]
    ds_read_b128 v[64:67], v4 offset:8192
    v_mfma_f32_16x16x32_bf16 v[132:135], v[68:71], a[108:111], v[132:135]
    ds_read_b128 v[68:71], v4 offset:17408
    s_waitcnt lgkmcnt(6)
    v_mfma_f32_16x16x32_bf16 v[136:139], v[72:75], a[96:99], v[136:139]
    buffer_load_dwordx4 v3, s[12:15], s30 offen offset:1024 sc1 lds
    v_mfma_f32_16x16x32_bf16 v[136:139], v[76:79], a[104:107], v[136:139]
    s_barrier
    v_mfma_f32_16x16x32_bf16 v[140:143], v[72:75], a[100:103], v[140:143]
    ds_read_b128 v[72:75], v4 offset:18432
    s_add_u32 s47, s47, 4096
    v_mfma_f32_16x16x32_bf16 v[140:143], v[76:79], a[108:111], v[140:143]
    ds_read_b128 v[76:79], v4 offset:27648
    s_waitcnt lgkmcnt(6)
    v_mfma_f32_16x16x32_bf16 v[144:147], v[80:83], a[96:99], v[144:147]
    v_mfma_f32_16x16x32_bf16 v[144:147], v[84:87], a[104:107], v[144:147]
    v_mfma_f32_16x16x32_bf16 v[148:151], v[80:83], a[100:103], v[148:151]
    ds_read_b128 v[80:83], v4 offset:19456
    v_mfma_f32_16x16x32_bf16 v[148:151], v[84:87], a[108:111], v[148:151]
    ds_read_b128 v[84:87], v4 offset:28672
    s_waitcnt lgkmcnt(6)
    v_mfma_f32_16x16x32_bf16 v[152:155], v[88:91], a[96:99], v[152:155]
    buffer_load_dwordx4 v3, s[12:15], s30 offen offset:2048 sc1 lds
    v_mfma_f32_16x16x32_bf16 v[152:155], v[92:95], a[104:107], v[152:155]
    v_mfma_f32_16x16x32_bf16 v[156:159], v[88:91], a[100:103], v[156:159]
    ds_read_b128 v[88:91], v4 offset:20480
    v_mfma_f32_16x16x32_bf16 v[156:159], v[92:95], a[108:111], v[156:159]
    ds_read_b128 v[92:95], v4 offset:29696
    s_waitcnt lgkmcnt(6)
    v_mfma_f32_16x16x32_bf16 v[40:43], v[64:67], a[96:99], v[40:43]
    v_mfma_f32_16x16x32_bf16 v[40:43], v[68:71], a[104:107], v[40:43]
    v_mfma_f32_16x16x32_bf16 v[44:47], v[64:67], a[100:103], v[44:47]
    ds_read_b128 v[64:67], v4 offset:21504
    v_mfma_f32_16x16x32_bf16 v[44:47], v[68:71], a[108:111], v[44:47]
    ds_read_b128 v[68:71], v4 offset:30720
    s_waitcnt lgkmcnt(6)
    v_mfma_f32_16x16x32_bf16 v[96:99], v[72:75], a[112:115], v[96:99]
    s_add_u32 m0, s26, 61440
    s_add_u32 s30, s30, 12288
    v_mfma_f32_16x16x32_bf16 v[96:99], v[76:79], a[120:123], v[96:99]
    buffer_load_dwordx4 v3, s[12:15], s30 offen offset:0 sc1 lds
    v_mfma_f32_16x16x32_bf16 v[100:103], v[72:75], a[116:119], v[100:103]
    ds_read_b128 v[72:75], v4 offset:22528
    v_mfma_f32_16x16x32_bf16 v[100:103], v[76:79], a[124:127], v[100:103]
    ds_read_b128 v[76:79], v4 offset:31744
    s_waitcnt lgkmcnt(6)
    v_mfma_f32_16x16x32_bf16 v[104:107], v[80:83], a[112:115], v[104:107]
    v_mfma_f32_16x16x32_bf16 v[104:107], v[84:87], a[120:123], v[104:107]
    v_mfma_f32_16x16x32_bf16 v[108:111], v[80:83], a[116:119], v[108:111]
    ds_read_b128 v[80:83], v4 offset:23552
    v_mfma_f32_16x16x32_bf16 v[108:111], v[84:87], a[124:127], v[108:111]
    ds_read_b128 v[84:87], v4 offset:32768
    s_waitcnt lgkmcnt(6)
    v_mfma_f32_16x16x32_bf16 v[112:115], v[88:91], a[112:115], v[112:115]
    buffer_load_dwordx4 v3, s[12:15], s30 offen offset:1024 sc1 lds
    v_mfma_f32_16x16x32_bf16 v[112:115], v[92:95], a[120:123], v[112:115]
    v_mfma_f32_16x16x32_bf16 v[116:119], v[88:91], a[116:119], v[116:119]
    ds_read_b128 v[88:91], v4 offset:24576
    v_mfma_f32_16x16x32_bf16 v[116:119], v[92:95], a[124:127], v[116:119]
    ds_read_b128 v[92:95], v4 offset:33792
    s_waitcnt lgkmcnt(6)
    v_mfma_f32_16x16x32_bf16 v[120:123], v[64:67], a[112:115], v[120:123]
    v_mfma_f32_16x16x32_bf16 v[120:123], v[68:71], a[120:123], v[120:123]
    v_mfma_f32_16x16x32_bf16 v[124:127], v[64:67], a[116:119], v[124:127]
    ds_read_b128 v[64:67], v4 offset:25600
    v_mfma_f32_16x16x32_bf16 v[124:127], v[68:71], a[124:127], v[124:127]
    ds_read_b128 v[68:71], v4 offset:34816
    s_waitcnt lgkmcnt(6)
    v_mfma_f32_16x16x32_bf16 v[128:131], v[72:75], a[112:115], v[128:131]
    buffer_load_dwordx4 v3, s[12:15], s30 offen offset:2048 sc1 lds
    v_mfma_f32_16x16x32_bf16 v[128:131], v[76:79], a[120:123], v[128:131]
    v_mfma_f32_16x16x32_bf16 v[132:135], v[72:75], a[116:119], v[132:135]
    ds_read_b128 v[72:75], v4 offset:26624
    s_waitcnt vmcnt(8)
    v_cmp_ne_u32 vcc, v21, v22
    s_cbranch_vccnz f_slow1
f_back1:
    v_mfma_f32_16x16x32_bf16 v[132:135], v[76:79], a[124:127], v[132:135]
    ds_read_b128 v[76:79], v4 offset:35840
    s_waitcnt lgkmcnt(6)
    v_mfma_f32_16x16x32_bf16 v[136:139], v[80:83], a[112:115], v[136:139]
    buffer_load_dwordx4 a[192:195], v3, s[36:39], s47 offen offset:0 sc1
    v_mfma_f32_16x16x32_bf16 v[136:139], v[84:87], a[120:123], v[136:139]
    v_mfma_f32_16x16x32_bf16 v[140:143], v[80:83], a[116:119], v[140:143]
    ds_read_b128 v[80:83], v8 offset:0
    v_mfma_f32_16x16x32_bf16 v[140:143], v[84:87], a[124:127], v[140:143]
    ds_read_b128 v[84:87], v8 offset:9216
    s_waitcnt lgkmcnt(6)
    v_mfma_f32_16x16x32_bf16 v[144:147], v[88:91], a[112:115], v[144:147]
    v_mfma_f32_16x16x32_bf16 v[144:147], v[92:95], a[120:123], v[144:147]
    buffer_load_dwordx4 a[196:199], v11, s[36:39], s47 offen offset:0 sc1
    v_mfma_f32_16x16x32_bf16 v[148:151], v[88:91], a[116:119], v[148:151]
    ds_read_b128 v[88:91], v8 offset:1024
    v_mfma_f32_16x16x32_bf16 v[148:151], v[92:95], a[124:127], v[148:151]
    ds_read_b128 v[92:95], v8 offset:10240
    s_waitcnt lgkmcnt(6)
    v_mfma_f32_16x16x32_bf16 v[152:155], v[64:67], a[112:115], v[152:155]
    v_mfma_f32_16x16x32_bf16 v[152:155], v[68:71], a[120:123], v[152:155]
    v_mfma_f32_16x16x32_bf16 v[156:159], v[64:67], a[116:119], v[156:159]
    ds_read_b128 v[64:67], v8 offset:2048
    v_mfma_f32_16x16x32_bf16 v[156:159], v[68:71], a[124:127], v[156:159]
    ds_read_b128 v[68:71], v8 offset:11264
    s_waitcnt lgkmcnt(6)
    v_mfma_f32_16x16x32_bf16 v[40:43], v[72:75], a[112:115], v[40:43]
    buffer_load_dwordx4 a[200:203], v3, s[36:39], s47 offen offset:1024 sc1
    v_mfma_f32_16x16x32_bf16 v[40:43], v[76:79], a[120:123], v[40:43]
    s_barrier
    v_mfma_f32_16x16x32_bf16 v[44:47], v[72:75], a[116:119], v[44:47]
    ds_read_b128 v[72:75], v8 offset:3072
    s_add_u32 m0, s25, 0
    v_mfma_f32_16x16x32_bf16 v[44:47], v[76:79], a[124:127], v[44:47]
    ds_read_b128 v[76:79], v8 offset:12288
    s_waitcnt lgkmcnt(6)
    v_mfma_f32_16x16x32_bf16 v[96:99], v[80:83], a[128:131], v[96:99]
    s_add_u32 s30, s30, 12288
    v_mfma_f32_16x16x32_bf16 v[96:99], v[84:87], a[136:139], v[96:99]
    buffer_load_dwordx4 v3, s[12:15], s30 offen offset:0 sc1 lds
    v_mfma_f32_16x16x32_bf16 v[100:103], v[80:83], a[132:135], v[100:103]
    ds_read_b128 v[80:83], v8 offset:4096
    v_mfma_f32_16x16x32_bf16 v[100:103], v[84:87], a[140:143], v[100:103]
    ds_read_b128 v[84:87], v8 offset:13312
    s_waitcnt lgkmcnt(6)
    v_mfma_f32_16x16x32_bf16 v[104:107], v[88:91], a[128:131], v[104:107]
    buffer_load_dwordx4 a[204:207], v11, s[36:39], s47 offen offset:1024 sc1
    v_mfma_f32_16x16x32_bf16 v[104:107], v[92:95], a[136:139], v[104:107]
    buffer_load_dwordx4 v3, s[12:15], s30 offen offset:1024 sc1 lds
    v_mfma_f32_16x16x32_bf16 v[108:111], v[88:91], a[132:135], v[108:111]
    ds_read_b128 v[88:91], v8 offset:5120
    v_mfma_f32_16x16x32_bf16 v[108:111], v[92:95], a[140:143], v[108:111]
    ds_read_b128 v[92:95], v8 offset:14336
    s_waitcnt lgkmcnt(6)
    v_mfma_f32_16x16x32_bf16 v[112:115], v[64:67], a[128:131], v[112:115]
    v_mfma_f32_16x16x32_bf16 v[112:115], v[68:71], a[136:139], v[112:115]
    buffer_load_dwordx4 v3, s[12:15], s30 offen offset:2048 sc1 lds
    v_mfma_f32_16x16x32_bf16 v[116:119], v[64:67], a[132:135], v[116:119]
    ds_read_b128 v[64:67], v8 offset:6144
    v_mfma_f32_16x16x32_bf16 v[116:119], v[68:71], a[140:143], v[116:119]
    ds_read_b128 v[68:71], v8 offset:15360
    s_waitcnt lgkmcnt(6)
    v_mfma_f32_16x16x32_bf16 v[120:123], v[72:75], a[128:131], v[120:123]
    buffer_load_dwordx4 a[208:211], v3, s[36:39], s47 offen offset:2048 sc1
    v_mfma_f32_16x16x32_bf16 v[120:123], v[76:79], a[136:139], v[120:123]
    v_mfma_f32_16x16x32_bf16 v[124:127], v[72:75], a[132:135], v[124:127]
    ds_read_b128 v[72:75], v8 offset:7168
    v_mfma_f32_16x16x32_bf16 v[124:127], v[76:79], a[140:143], v[124:127]
    ds_read_b128 v[76:79], v8 offset:16384
    s_waitcnt lgkmcnt(6)
    v_mfma_f32_16x16x32_bf16 v[128:131], v[80:83], a[128:131], v[128:131]
    s_add_u32 m0, s25, 12288
    s_add_u32 s30, s30, 12288
    v_mfma_f32_16x16x32_bf16 v[128:131], v[84:87], a[136:139], v[128:131]
    buffer_load_dwordx4 v3, s[12:15], s30 offen offset:0 sc1 lds
    v_mfma_f32_16x16x32_bf16 v[132:135], v[80:83], a[132:135], v[132:135]
    ds_read_b128 v[80:83], v8 offset:8192
    v_mfma_f32_16x16x32_bf16 v[132:135], v[84:87], a[140:143], v[132:135]
    ds_read_b128 v[84:87], v8 offset:17408
    s_waitcnt lgkmcnt(6)
    v_mfma_f32_16x16x32_bf16 v[136:139], v[88:91], a[128:131], v[136:139]
    buffer_load_dwordx4 a[212:215], v11, s[36:39], s47 offen offset:2048 sc1
    v_mfma_f32_16x16x32_bf16 v[136:139], v[92:95], a[136:139], v[136:139]
    v_mfma_f32_16x16x32_bf16 v[140:143], v[88:91], a[132:135], v[140:143]
    ds_read_b128 v[88:91], v8 offset:18432
    v_mfma_f32_16x16x32_bf16 v[140:143], v[92:95], a[140:143], v[140:143]
    ds_read_b128 v[92:95], v8 offset:27648
    s_waitcnt lgkmcnt(6)
    v_mfma_f32_16x16x32_bf16 v[144:147], v[64:67], a[128:131], v[144:147]
    buffer_load_dwordx4 v3, s[12:15], s30 offen offset:1024 sc1 lds
    v_mfma_f32_16x16x32_bf16 v[144:147], v[68:71], a[136:139], v[144:147]
    buffer_load_dwordx4 a[216:219], v3, s[36:39], s47 offen offset:3072 sc1
    v_mfma_f32_16x16x32_bf16 v[148:151], v[64:67], a[132:135], v[148:151]
    ds_read_b128 v[64:67], v8 offset:19456
    v_mfma_f32_16x16x32_bf16 v[148:151], v[68:71], a[140:143], v[148:151]
    ds_read_b128 v[68:71], v8 offset:28672
    s_waitcnt lgkmcnt(6)
    v_mfma_f32_16x16x32_bf16 v[152:155], v[72:75], a[128:131], v[152:155]
    v_mfma_f32_16x16x32_bf16 v[152:155], v[76:79], a[136:139], v[152:155]
    v_mfma_f32_16x16x32_bf16 v[156:159], v[72:75], a[132:135], v[156:159]
    ds_read_b128 v[72:75], v8 offset:20480
    v_mfma_f32_16x16x32_bf16 v[156:159], v[76:79], a[140:143], v[156:159]
    ds_read_b128 v[76:79], v8 offset:29696
    s_waitcnt lgkmcnt(6)
    v_mfma_f32_16x16x32_bf16 v[40:43], v[80:83], a[128:131], v[40:43]
    buffer_load_dwordx4 v3, s[12:15], s30 offen offset:2048 sc1 lds
    v_mfma_f32_16x16x32_bf16 v[40:43], v[84:87], a[136:139], v[40:43]
    buffer_load_dwordx4 a[220:223], v11, s[36:39], s47 offen offset:3072 sc1
    v_mfma_f32_16x16x32_bf16 v[44:47], v[80:83], a[132:135], v[44:47]
    ds_read_b128 v[80:83], v8 offset:21504
    v_mfma_f32_16x16x32_bf16 v[44:47], v[84:87], a[140:143], v[44:47]
    ds_read_b128 v[84:87], v8 offset:30720
    s_waitcnt lgkmcnt(6)
    v_mfma_f32_16x16x32_bf16 v[96:99], v[88:91], a[144:147], v[96:99]
    s_add_u32 s47, s47, 4096
    v_mfma_f32_16x16x32_bf16 v[96:99], v[92:95], a[152:155], v[96:99]
    buffer_load_dwordx4 a[224:227], v3, s[36:39], s47 offen offset:0 sc1
    v_mfma_f32_16x16x32_bf16 v[100:103], v[88:91], a[148:151], v[100:103]
    ds_read_b128 v[88:91], v8 offset:22528
    v_mfma_f32_16x16x32_bf16 v[100:103], v[92:95], a[156:159], v[100:103]
    ds_read_b128 v[92:95], v8 offset:31744
    s_waitcnt lgkmcnt(6)
    v_mfma_f32_16x16x32_bf16 v[104:107], v[64:67], a[144:147], v[104:107]
    s_add_u32 m0, s25, 24576
    s_add_u32 s30, s30, 12288
    v_mfma_f32_16x16x32_bf16 v[104:107], v[68:71], a[152:155], v[104:107]
    buffer_load_dwordx4 v3, s[12:15], s30 offen offset:0 sc1 lds
    v_mfma_f32_16x16x32_bf16 v[108:111], v[64:67], a[148:151], v[108:111]
    ds_read_b128 v[64:67], v8 offset:23552
    v_mfma_f32_16x16x32_bf16 v[108:111], v[68:71], a[156:159], v[108:111]
    ds_read_b128 v[68:71], v8 offset:32768
    s_waitcnt lgkmcnt(6)
    v_mfma_f32_16x16x32_bf16 v[112:115], v[72:75], a[144:147], v[112:115]
    buffer_load_dwordx4 a[228:231], v11, s[36:39], s47 offen offset:0 sc1
    v_mfma_f32_16x16x32_bf16 v[112:115], v[76:79], a[152:155], v[112:115]
    v_mfma_f32_16x16x32_bf16 v[116:119], v[72:75], a[148:151], v[116:119]
    ds_read_b128 v[72:75], v8 offset:24576
    v_mfma_f32_16x16x32_bf16 v[116:119], v[76:79], a[156:159], v[116:119]
    ds_read_b128 v[76:79], v8 offset:33792
    s_waitcnt lgkmcnt(6)
    v_mfma_f32_16x16x32_bf16 v[120:123], v[80:83], a[144:147], v[120:123]
    buffer_load_dwordx4 v3, s[12:15], s30 offen offset:1024 sc1 lds
    v_mfma_f32_16x16x32_bf16 v[120:123], v[84:87], a[152:155], v[120:123]
    buffer_load_dwordx4 a[232:235], v3, s[36:39], s47 offen offset:1024 sc1
    v_mfma_f32_16x16x32_bf16 v[124:127], v[80:83], a[148:151], v[124:127]
    ds_read_b128 v[80:83], v8 offset:25600
    v_mfma_f32_16x16x32_bf16 v[124:127], v[84:87], a[156:159], v[124:127]
    ds_read_b128 v[84:87], v8 offset:34816
    s_waitcnt lgkmcnt(6)
    v_mfma_f32_16x16x32_bf16 v[128:131], v[88:91], a[144:147], v[128:131]
    v_mfma_f32_16x16x32_bf16 v[128:131], v[92:95], a[152:155], v[128:131]
    v_mfma_f32_16x16x32_bf16 v[132:135], v[88:91], a[148:151], v[132:135]
    ds_read_b128 v[88:91], v8 offset:26624
    v_mfma_f32_16x16x32_bf16 v[132:135], v[92:95], a[156:159], v[132:135]
    ds_read_b128 v[92:95], v8 offset:35840
    s_waitcnt lgkmcnt(6)
    v_mfma_f32_16x16x32_bf16 v[136:139], v[64:67], a[144:147], v[136:139]
    buffer_load_dwordx4 v3, s[12:15], s30 offen offset:2048 sc1 lds
    v_mfma_f32_16x16x32_bf16 v[136:139], v[68:71], a[152:155], v[136:139]
    s_barrier
    v_mfma_f32_16x16x32_bf16 v[140:143], v[64:67], a[148:151], v[140:143]
    ds_read_b128 v[64:67], v9 offset:0
    v_mfma_f32_16x16x32_bf16 v[140:143], v[68:71], a[156:159], v[140:143]
    ds_read_b128 v[68:71], v9 offset:9216
    s_waitcnt lgkmcnt(6)
    v_mfma_f32_16x16x32_bf16 v[144:147], v[72:75], a[144:147], v[144:147]
    buffer_load_dwordx4 a[236:239], v11, s[36:39], s47 offen offset:1024 sc1
    v_mfma_f32_16x16x32_bf16 v[144:147], v[76:79], a[152:155], v[144:147]
    v_mfma_f32_16x16x32_bf16 v[148:151], v[72:75], a[148:151], v[148:151]
    ds_read_b128 v[72:75], v9 offset:1024
    v_mfma_f32_16x16x32_bf16 v[148:151], v[76:79], a[156:159], v[148:151]
    ds_read_b128 v[76:79], v9 offset:10240
    s_waitcnt lgkmcnt(6)
    v_mfma_f32_16x16x32_bf16 v[152:155], v[80:83], a[144:147], v[152:155]
    v_mfma_f32_16x16x32_bf16 v[152:155], v[84:87], a[152:155], v[152:155]
    s_add_u32 m0, s25, 36864
    s_add_u32 s30, s30, 12288
    v_mfma_f32_16x16x32_bf16 v[156:159], v[80:83], a[148:151], v[156:159]
    ds_read_b128 v[80:83], v9 offset:2048
    v_mfma_f32_16x16x32_bf16 v[156:159], v[84:87], a[156:159], v[156:159]
    ds_read_b128 v[84:87], v9 offset:11264
    s_waitcnt lgkmcnt(6)
    v_mfma_f32_16x16x32_bf16 v[40:43], v[88:91], a[144:147], v[40:43]
    buffer_load_dwordx4 v3, s[12:15], s30 offen offset:0 sc1 lds
    v_mfma_f32_16x16x32_bf16 v[40:43], v[92:95], a[152:155], v[40:43]
    buffer_load_dwordx4 a[240:243], v3, s[36:39], s47 offen offset:2048 sc1
    v_mfma_f32_16x16x32_bf16 v[44:47], v[88:91], a[148:151], v[44:47]
    ds_read_b128 v[88:91], v9 offset:3072
    v_mfma_f32_16x16x32_bf16 v[44:47], v[92:95], a[156:159], v[44:47]
    ds_read_b128 v[92:95], v9 offset:12288
    s_waitcnt lgkmcnt(6)
    v_mfma_f32_16x16x32_bf16 v[96:99], v[64:67], a[160:163], v[96:99]
    v_mfma_f32_16x16x32_bf16 v[96:99], v[68:71], a[168:171], v[96:99]
    v_mfma_f32_16x16x32_bf16 v[100:103], v[64:67], a[164:167], v[100:103]
    ds_read_b128 v[64:67], v9 offset:4096
    v_mfma_f32_16x16x32_bf16 v[100:103], v[68:71], a[172:175], v[100:103]
    ds_read_b128 v[68:71], v9 offset:13312
    s_waitcnt lgkmcnt(6)
    v_mfma_f32_16x16x32_bf16 v[104:107], v[72:75], a[160:163], v[104:107]
    buffer_load_dwordx4 v3, s[12:15], s30 offen offset:1024 sc1 lds
    v_mfma_f32_16x16x32_bf16 v[104:107], v[76:79], a[168:171], v[104:107]
    buffer_load_dwordx4 a[244:247], v11, s[36:39], s47 offen offset:2048 sc1
    v_mfma_f32_16x16x32_bf16 v[108:111], v[72:75], a[164:167], v[108:111]
    ds_read_b128 v[72:75], v9 offset:5120
    v_mfma_f32_16x16x32_bf16 v[108:111], v[76:79], a[172:175], v[108:111]
    ds_read_b128 v[76:79], v9 offset:14336
    s_waitcnt lgkmcnt(6)
    v_mfma_f32_16x16x32_bf16 v[112:115], v[80:83], a[160:163], v[112:115]
    v_mfma_f32_16x16x32_bf16 v[112:115], v[84:87], a[168:171], v[112:115]
    v_mfma_f32_16x16x32_bf16 v[116:119], v[80:83], a[164:167], v[116:119]
    ds_read_b128 v[80:83], v9 offset:6144
    v_mfma_f32_16x16x32_bf16 v[116:119], v[84:87], a[172:175], v[116:119]
    ds_read_b128 v[84:87], v9 offset:15360
    s_waitcnt lgkmcnt(6)
    v_mfma_f32_16x16x32_bf16 v[120:123], v[88:91], a[160:163], v[120:123]
    buffer_load_dwordx4 v3, s[12:15], s30 offen offset:2048 sc1 lds
    v_mfma_f32_16x16x32_bf16 v[120:123], v[92:95], a[168:171], v[120:123]
    buffer_load_dwordx4 a[248:251], v3, s[36:39], s47 offen offset:3072 sc1
    v_mfma_f32_16x16x32_bf16 v[124:127], v[88:91], a[164:167], v[124:127]
    ds_read_b128 v[88:91], v9 offset:7168
    v_mfma_f32_16x16x32_bf16 v[124:127], v[92:95], a[172:175], v[124:127]
    ds_read_b128 v[92:95], v9 offset:16384
    s_waitcnt lgkmcnt(6)
    v_mfma_f32_16x16x32_bf16 v[128:131], v[64:67], a[160:163], v[128:131]
    v_mfma_f32_16x16x32_bf16 v[128:131], v[68:71], a[168:171], v[128:131]
    v_mfma_f32_16x16x32_bf16 v[132:135], v[64:67], a[164:167], v[132:135]
    ds_read_b128 v[64:67], v9 offset:8192
    s_add_u32 m0, s25, 49152
    s_barrier
    v_mfma_f32_16x16x32_bf16 v[132:135], v[68:71], a[172:175], v[132:135]
    ds_read_b128 v[68:71], v9 offset:17408
    s_waitcnt lgkmcnt(6)
    v_mfma_f32_16x16x32_bf16 v[136:139], v[72:75], a[160:163], v[136:139]
    s_add_u32 s30, s30, 12288
    v_mfma_f32_16x16x32_bf16 v[136:139], v[76:79], a[168:171], v[136:139]
    buffer_load_dwordx4 v3, s[12:15], s30 offen offset:0 sc1 lds
    v_mfma_f32_16x16x32_bf16 v[140:143], v[72:75], a[164:167], v[140:143]
    ds_read_b128 v[72:75], v9 offset:18432
    v_mfma_f32_16x16x32_bf16 v[140:143], v[76:79], a[172:175], v[140:143]
    ds_read_b128 v[76:79], v9 offset:27648
    s_waitcnt lgkmcnt(6)
    v_mfma_f32_16x16x32_bf16 v[144:147], v[80:83], a[160:163], v[144:147]
    buffer_load_dwordx4 a[252:255], v11, s[36:39], s47 offen offset:3072 sc1
    v_mfma_f32_16x16x32_bf16 v[144:147], v[84:87], a[168:171], v[144:147]
    v_mfma_f32_16x16x32_bf16 v[148:151], v[80:83], a[164:167], v[148:151]
    ds_read_b128 v[80:83], v9 offset:19456
    v_mfma_f32_16x16x32_bf16 v[148:151], v[84:87], a[172:175], v[148:151]
    ds_read_b128 v[84:87], v9 offset:28672
    s_waitcnt lgkmcnt(6)
    v_mfma_f32_16x16x32_bf16 v[152:155], v[88:91], a[160:163], v[152:155]
    buffer_load_dwordx4 v3, s[12:15], s30 offen offset:1024 sc1 lds
    v_mfma_f32_16x16x32_bf16 v[152:155], v[92:95], a[168:171], v[152:155]
    s_add_u32 s47, s47, 4096
    v_mfma_f32_16x16x32_bf16 v[156:159], v[88:91], a[164:167], v[156:159]
    ds_read_b128 v[88:91], v9 offset:20480
    v_mfma_f32_16x16x32_bf16 v[156:159], v[92:95], a[172:175], v[156:159]
    ds_read_b128 v[92:95], v9 offset:29696
    s_waitcnt lgkmcnt(6)
    v_mfma_f32_16x16x32_bf16 v[40:43], v[64:67], a[160:163], v[40:43]
    buffer_load_dwordx2 v[224:225], v14, s[36:39], s47 offen offset:0 sc1
    v_mfma_f32_16x16x32_bf16 v[40:43], v[68:71], a[168:171], v[40:43]
    v_mfma_f32_16x16x32_bf16 v[44:47], v[64:67], a[164:167], v[44:47]
    ds_read_b128 v[64:67], v9 offset:21504
    v_mfma_f32_16x16x32_bf16 v[44:47], v[68:71], a[172:175], v[44:47]
    ds_read_b128 v[68:71], v9 offset:30720
    s_waitcnt lgkmcnt(6)
    v_mfma_f32_16x16x32_bf16 v[96:99], v[72:75], a[176:179], v[96:99]
    buffer_load_dwordx4 v3, s[12:15], s30 offen offset:2048 sc1 lds
    s_waitcnt vmcnt(37)
    v_mfma_f32_16x16x32_bf16 v[96:99], v[76:79], a[184:187], v[96:99]
    buffer_load_dwordx2 v[226:227], v14, s[36:39], s47 offen offset:512 sc1
    v_mfma_f32_16x16x32_bf16 v[100:103], v[72:75], a[180:183], v[100:103]
    ds_read_b128 v[72:75], v9 offset:22528
    v_mfma_f32_16x16x32_bf16 v[100:103], v[76:79], a[188:191], v[100:103]
    ds_read_b128 v[76:79], v9 offset:31744
    s_waitcnt lgkmcnt(6)
    v_mfma_f32_16x16x32_bf16 v[104:107], v[80:83], a[176:179], v[104:107]
    buffer_load_dwordx2 v[228:229], v15, s[36:39], s47 offen offset:0 sc1
    v_mfma_f32_16x16x32_bf16 v[104:107], v[84:87], a[184:187], v[104:107]
    v_mfma_f32_16x16x32_bf16 v[108:111], v[80:83], a[180:183], v[108:111]
    ds_read_b128 v[80:83], v9 offset:23552
    v_mfma_f32_16x16x32_bf16 v[108:111], v[84:87], a[188:191], v[108:111]
    ds_read_b128 v[84:87], v9 offset:32768
    s_waitcnt lgkmcnt(6)
    v_mfma_f32_16x16x32_bf16 v[112:115], v[88:91], a[176:179], v[112:115]
    s_add_u32 m0, s25, 61440
    s_add_u32 s30, s30, 12288
    v_mfma_f32_16x16x32_bf16 v[112:115], v[92:95], a[184:187], v[112:115]
    buffer_load_dwordx4 v3, s[12:15], s30 offen offset:0 sc1 lds
    v_mfma_f32_16x16x32_bf16 v[116:119], v[88:91], a[180:183], v[116:119]
    ds_read_b128 v[88:91], v9 offset:24576
    v_mfma_f32_16x16x32_bf16 v[116:119], v[92:95], a[188:191], v[116:119]
    ds_read_b128 v[92:95], v9 offset:33792
    s_waitcnt lgkmcnt(6)
    v_mfma_f32_16x16x32_bf16 v[120:123], v[64:67], a[176:179], v[120:123]
    buffer_load_dwordx2 v[230:231], v15, s[36:39], s47 offen offset:512 sc1
    v_mfma_f32_16x16x32_bf16 v[120:123], v[68:71], a[184:187], v[120:123]
    v_mfma_f32_16x16x32_bf16 v[124:127], v[64:67], a[180:183], v[124:127]
    ds_read_b128 v[64:67], v9 offset:25600
    v_mfma_f32_16x16x32_bf16 v[124:127], v[68:71], a[188:191], v[124:127]
    ds_read_b128 v[68:71], v9 offset:34816
    s_waitcnt lgkmcnt(6)
    v_mfma_f32_16x16x32_bf16 v[128:131], v[72:75], a[176:179], v[128:131]
    buffer_load_dwordx2 v[232:233], v14, s[36:39], s47 offen offset:1024 sc1
    v_mfma_f32_16x16x32_bf16 v[128:131], v[76:79], a[184:187], v[128:131]
    v_mfma_f32_16x16x32_bf16 v[132:135], v[72:75], a[180:183], v[132:135]
    ds_read_b128 v[72:75], v9 offset:26624
    v_mfma_f32_16x16x32_bf16 v[132:135], v[76:79], a[188:191], v[132:135]
    ds_read_b128 v[76:79], v9 offset:35840
    s_waitcnt lgkmcnt(6)
    v_mfma_f32_16x16x32_bf16 v[136:139], v[80:83], a[176:179], v[136:139]
    buffer_load_dwordx2 v[234:235], v14, s[36:39], s47 offen offset:1536 sc1
    v_mfma_f32_16x16x32_bf16 v[136:139], v[84:87], a[184:187], v[136:139]
    buffer_load_dwordx4 v3, s[12:15], s30 offen offset:1024 sc1 lds
    v_mfma_f32_16x16x32_bf16 v[140:143], v[80:83], a[180:183], v[140:143]
    ds_read_b128 v[80:83], v10 offset:0
    v_mfma_f32_16x16x32_bf16 v[140:143], v[84:87], a[188:191], v[140:143]
    ds_read_b128 v[84:87], v10 offset:9216
    s_waitcnt lgkmcnt(6)
    v_mfma_f32_16x16x32_bf16 v[144:147], v[88:91], a[176:179], v[144:147]
    buffer_load_dwordx2 v[236:237], v15, s[36:39], s47 offen offset:1024 sc1
    v_mfma_f32_16x16x32_bf16 v[144:147], v[92:95], a[184:187], v[144:147]
    v_mfma_f32_16x16x32_bf16 v[148:151], v[88:91], a[180:183], v[148:151]
    ds_read_b128 v[88:91], v10 offset:1024
    v_mfma_f32_16x16x32_bf16 v[148:151], v[92:95], a[188:191], v[148:151]
    ds_read_b128 v[92:95], v10 offset:10240
    s_waitcnt lgkmcnt(6)
    v_mfma_f32_16x16x32_bf16 v[152:155], v[64:67], a[176:179], v[152:155]
    buffer_load_dwordx2 v[238:239], v15, s[36:39], s47 offen offset:1536 sc1
    v_mfma_f32_16x16x32_bf16 v[152:155], v[68:71], a[184:187], v[152:155]
    v_mfma_f32_16x16x32_bf16 v[156:159], v[64:67], a[180:183], v[156:159]
    ds_read_b128 v[64:67], v10 offset:2048
    v_mfma_f32_16x16x32_bf16 v[156:159], v[68:71], a[188:191], v[156:159]
    ds_read_b128 v[68:71], v10 offset:11264
    s_waitcnt lgkmcnt(6)
    v_mfma_f32_16x16x32_bf16 v[40:43], v[72:75], a[176:179], v[40:43]
    s_waitcnt vmcnt(41)
    s_barrier
    v_mfma_f32_16x16x32_bf16 v[40:43], v[76:79], a[184:187], v[40:43]
    buffer_load_dwordx4 v3, s[12:15], s30 offen offset:2048 sc1 lds
    v_mfma_f32_16x16x32_bf16 v[44:47], v[72:75], a[180:183], v[44:47]
    ds_read_b128 v[72:75], v10 offset:3072
    v_mfma_f32_16x16x32_bf16 v[44:47], v[76:79], a[188:191], v[44:47]
    ds_read_b128 v[76:79], v10 offset:12288
    s_waitcnt vmcnt(40) lgkmcnt(6)
    v_mfma_f32_16x16x32_bf16 v[96:99], v[80:83], a[192:195], v[96:99]
    buffer_load_dwordx2 v[240:241], v14, s[36:39], s47 offen offset:2048 sc1
    s_waitcnt vmcnt(38)
    v_mfma_f32_16x16x32_bf16 v[96:99], v[84:87], a[200:203], v[96:99]
    v_mfma_f32_16x16x32_bf16 v[100:103], v[80:83], a[196:199], v[100:103]
    ds_read_b128 v[80:83], v10 offset:4096
    v_mfma_f32_16x16x32_bf16 v[100:103], v[84:87], a[204:207], v[100:103]
    ds_read_b128 v[84:87], v10 offset:13312
    s_waitcnt lgkmcnt(6)
    v_mfma_f32_16x16x32_bf16 v[104:107], v[88:91], a[192:195], v[104:107]
    buffer_load_dwordx2 v[242:243], v14, s[36:39], s47 offen offset:2560 sc1
    v_mfma_f32_16x16x32_bf16 v[104:107], v[92:95], a[200:203], v[104:107]
    v_mfma_f32_16x16x32_bf16 v[108:111], v[88:91], a[196:199], v[108:111]
    ds_read_b128 v[88:91], v10 offset:5120
    v_mfma_f32_16x16x32_bf16 v[108:111], v[92:95], a[204:207], v[108:111]
    ds_read_b128 v[92:95], v10 offset:14336
    s_waitcnt lgkmcnt(6)
    v_mfma_f32_16x16x32_bf16 v[112:115], v[64:67], a[192:195], v[112:115]
    buffer_load_dwordx2 v[244:245], v15, s[36:39], s47 offen offset:2048 sc1
    v_mfma_f32_16x16x32_bf16 v[112:115], v[68:71], a[200:203], v[112:115]
    v_mfma_f32_16x16x32_bf16 v[116:119], v[64:67], a[196:199], v[116:119]
    ds_read_b128 v[64:67], v10 offset:6144
    v_mfma_f32_16x16x32_bf16 v[116:119], v[68:71], a[204:207], v[116:119]
    ds_read_b128 v[68:71], v10 offset:15360
    s_waitcnt lgkmcnt(6)
    v_mfma_f32_16x16x32_bf16 v[120:123], v[72:75], a[192:195], v[120:123]
    buffer_load_dwordx2 v[246:247], v15, s[36:39], s47 offen offset:2560 sc1
    v_mfma_f32_16x16x32_bf16 v[120:123], v[76:79], a[200:203], v[120:123]
    v_mfma_f32_16x16x32_bf16 v[124:127], v[72:75], a[196:199], v[124:127]
    ds_read_b128 v[72:75], v10 offset:7168
    v_mfma_f32_16x16x32_bf16 v[124:127], v[76:79], a[204:207], v[124:127]
    ds_read_b128 v[76:79], v10 offset:16384
    s_waitcnt lgkmcnt(6)
    v_mfma_f32_16x16x32_bf16 v[128:131], v[80:83], a[192:195], v[128:131]
    buffer_load_dwordx2 v[248:249], v14, s[36:39], s47 offen offset:3072 sc1
    v_mfma_f32_16x16x32_bf16 v[128:131], v[84:87], a[200:203], v[128:131]
    v_mfma_f32_16x16x32_bf16 v[132:135], v[80:83], a[196:199], v[132:135]
    ds_read_b128 v[80:83], v10 offset:8192
    v_mfma_f32_16x16x32_bf16 v[132:135], v[84:87], a[204:207], v[132:135]
    ds_read_b128 v[84:87], v10 offset:17408
    s_waitcnt lgkmcnt(6)
    v_mfma_f32_16x16x32_bf16 v[136:139], v[88:91], a[192:195], v[136:139]
    buffer_load_dwordx2 v[250:251], v14, s[36:39], s47 offen offset:3584 sc1
    v_mfma_f32_16x16x32_bf16 v[136:139], v[92:95], a[200:203], v[136:139]
    v_mfma_f32_16x16x32_bf16 v[140:143], v[88:91], a[196:199], v[140:143]
    ds_read_b128 v[88:91], v10 offset:18432
    v_mfma_f32_16x16x32_bf16 v[140:143], v[92:95], a[204:207], v[140:143]
    ds_read_b128 v[92:95], v10 offset:27648
    s_waitcnt lgkmcnt(6)
    v_mfma_f32_16x16x32_bf16 v[144:147], v[64:67], a[192:195], v[144:147]
    buffer_load_dwordx2 v[252:253], v15, s[36:39], s47 offen offset:3072 sc1
    v_mfma_f32_16x16x32_bf16 v[144:147], v[68:71], a[200:203], v[144:147]
    v_mfma_f32_16x16x32_bf16 v[148:151], v[64:67], a[196:199], v[148:151]
    ds_read_b128 v[64:67], v10 offset:19456
    v_mfma_f32_16x16x32_bf16 v[148:151], v[68:71], a[204:207], v[148:151]
    ds_read_b128 v[68:71], v10 offset:28672
    s_waitcnt lgkmcnt(6)
    v_mfma_f32_16x16x32_bf16 v[152:155], v[72:75], a[192:195], v[152:155]
    buffer_load_dwordx2 v[254:255], v15, s[36:39], s47 offen offset:3584 sc1
    v_mfma_f32_16x16x32_bf16 v[152:155], v[76:79], a[200:203], v[152:155]
    s_add_u32 s47, s47, 4096
    v_mfma_f32_16x16x32_bf16 v[156:159], v[72:75], a[196:199], v[156:159]
    ds_read_b128 v[72:75], v10 offset:20480
    v_mfma_f32_16x16x32_bf16 v[156:159], v[76:79], a[204:207], v[156:159]
    ds_read_b128 v[76:79], v10 offset:29696
    s_waitcnt lgkmcnt(6)
    v_mfma_f32_16x16x32_bf16 v[40:43], v[80:83], a[192:195], v[40:43]
    s_add_u32 m0, s26, 0
    s_add_u32 s30, s31, s29
    s_cmp_eq_u32 s28, 1
    s_cselect_b32 s14, 0, s14
    v_mfma_f32_16x16x32_bf16 v[40:43], v[84:87], a[200:203], v[40:43]
    buffer_load_dwordx4 v3, s[12:15], s30 offen offset:0 sc1 lds
    v_mfma_f32_16x16x32_bf16 v[44:47], v[80:83], a[196:199], v[44:47]
    ds_read_b128 v[80:83], v10 offset:21504
    v_mfma_f32_16x16x32_bf16 v[44:47], v[84:87], a[204:207], v[44:47]
    ds_read_b128 v[84:87], v10 offset:30720
    s_waitcnt vmcnt(41) lgkmcnt(6)
    v_mfma_f32_16x16x32_bf16 v[96:99], v[88:91], a[208:211], v[96:99]
    s_waitcnt vmcnt(37)
    v_mfma_f32_16x16x32_bf16 v[96:99], v[92:95], a[216:219], v[96:99]
    v_mfma_f32_16x16x32_bf16 v[100:103], v[88:91], a[212:215], v[100:103]
    ds_read_b128 v[88:91], v10 offset:22528
    v_mfma_f32_16x16x32_bf16 v[100:103], v[92:95], a[220:223], v[100:103]
    ds_read_b128 v[92:95], v10 offset:31744
    s_waitcnt lgkmcnt(6)
    v_mfma_f32_16x16x32_bf16 v[104:107], v[64:67], a[208:211], v[104:107]
    buffer_load_dwordx4 v3, s[12:15], s30 offen offset:1024 sc1 lds
    v_mfma_f32_16x16x32_bf16 v[104:107], v[68:71], a[216:219], v[104:107]
    v_mfma_f32_16x16x32_bf16 v[108:111], v[64:67], a[212:215], v[108:111]
    ds_read_b128 v[64:67], v10 offset:23552
    v_mfma_f32_16x16x32_bf16 v[108:111], v[68:71], a[220:223], v[108:111]
    ds_read_b128 v[68:71], v10 offset:32768
    s_waitcnt lgkmcnt(6)
    v_mfma_f32_16x16x32_bf16 v[112:115], v[72:75], a[208:211], v[112:115]
    v_mfma_f32_16x16x32_bf16 v[112:115], v[76:79], a[216:219], v[112:115]
    buffer_load_dwordx4 v3, s[12:15], s30 offen offset:2048 sc1 lds
    v_mfma_f32_16x16x32_bf16 v[116:119], v[72:75], a[212:215], v[116:119]
    ds_read_b128 v[72:75], v10 offset:24576
    v_mfma_f32_16x16x32_bf16 v[116:119], v[76:79], a[220:223], v[116:119]
    ds_read_b128 v[76:79], v10 offset:33792
    s_waitcnt lgkmcnt(6)
    v_mfma_f32_16x16x32_bf16 v[120:123], v[80:83], a[208:211], v[120:123]
    v_mfma_f32_16x16x32_bf16 v[120:123], v[84:87], a[216:219], v[120:123]
    v_mfma_f32_16x16x32_bf16 v[124:127], v[80:83], a[212:215], v[124:127]
    ds_read_b128 v[80:83], v10 offset:25600
    s_add_u32 m0, s26, 12288
    v_mfma_f32_16x16x32_bf16 v[124:127], v[84:87], a[220:223], v[124:127]
    ds_read_b128 v[84:87], v10 offset:34816
    s_waitcnt lgkmcnt(6)
    v_mfma_f32_16x16x32_bf16 v[128:131], v[88:91], a[208:211], v[128:131]
    s_add_u32 s30, s30, 12288
    v_mfma_f32_16x16x32_bf16 v[128:131], v[92:95], a[216:219], v[128:131]
    buffer_load_dwordx4 v3, s[12:15], s30 offen offset:0 sc1 lds
    v_mfma_f32_16x16x32_bf16 v[132:135], v[88:91], a[212:215], v[132:135]
    ds_read_b128 v[88:91], v10 offset:26624
    v_mfma_f32_16x16x32_bf16 v[132:135], v[92:95], a[220:223], v[132:135]
    ds_read_b128 v[92:95], v10 offset:35840
    s_waitcnt lgkmcnt(6)
    v_mfma_f32_16x16x32_bf16 v[136:139], v[64:67], a[208:211], v[136:139]
    v_mfma_f32_16x16x32_bf16 v[136:139], v[68:71], a[216:219], v[136:139]
    s_waitcnt vmcnt(28)
    s_barrier
    v_mfma_f32_16x16x32_bf16 v[140:143], v[64:67], a[212:215], v[140:143]
    ds_read_b128 v[64:67], v4 offset:0
    v_mfma_f32_16x16x32_bf16 v[140:143], v[68:71], a[220:223], v[140:143]
    ds_read_b128 v[68:71], v4 offset:9216
    s_waitcnt lgkmcnt(6)
    v_mfma_f32_16x16x32_bf16 v[144:147], v[72:75], a[208:211], v[144:147]
    buffer_load_dwordx4 v3, s[12:15], s30 offen offset:1024 sc1 lds
    v_mfma_f32_16x16x32_bf16 v[144:147], v[76:79], a[216:219], v[144:147]
    v_mfma_f32_16x16x32_bf16 v[148:151], v[72:75], a[212:215], v[148:151]
    ds_read_b128 v[72:75], v4 offset:1024
    v_mfma_f32_16x16x32_bf16 v[148:151], v[76:79], a[220:223], v[148:151]
    ds_read_b128 v[76:79], v4 offset:10240
    s_waitcnt lgkmcnt(6)
    v_mfma_f32_16x16x32_bf16 v[152:155], v[80:83], a[208:211], v[152:155]
    v_mfma_f32_16x16x32_bf16 v[152:155], v[84:87], a[216:219], v[152:155]
    buffer_load_dwordx4 v3, s[12:15], s30 offen offset:2048 sc1 lds
    v_mfma_f32_16x16x32_bf16 v[156:159], v[80:83], a[212:215], v[156:159]
    ds_read_b128 v[80:83], v4 offset:18432
    v_mfma_f32_16x16x32_bf16 v[156:159], v[84:87], a[220:223], v[156:159]
    ds_read_b128 v[84:87], v4 offset:27648
    s_waitcnt lgkmcnt(6)
    v_mfma_f32_16x16x32_bf16 v[40:43], v[88:91], a[208:211], v[40:43]
    s_add_u32 m0, s26, 24576
    s_add_u32 s30, s30, 12288
    v_mfma_f32_16x16x32_bf16 v[40:43], v[92:95], a[216:219], v[40:43]
    buffer_load_dwordx4 v3, s[12:15], s30 offen offset:0 sc1 lds
    v_mfma_f32_16x16x32_bf16 v[44:47], v[88:91], a[212:215], v[44:47]
    ds_read_b128 v[88:91], v4 offset:19456
    v_mfma_f32_16x16x32_bf16 v[44:47], v[92:95], a[220:223], v[44:47]
    ds_read_b128 v[92:95], v4 offset:28672
    s_waitcnt lgkmcnt(6)
    v_mfma_f32_16x16x32_bf16 v[96:99], v[64:67], a[224:227], v[96:99]
    v_mfma_f32_16x16x32_bf16 v[96:99], v[68:71], a[232:235], v[96:99]
    v_mfma_f32_16x16x32_bf16 v[100:103], v[64:67], a[228:231], v[100:103]
    ds_read_b128 v[64:67], v8 offset:0
    v_mfma_f32_16x16x32_bf16 v[100:103], v[68:71], a[236:239], v[100:103]
    ds_read_b128 v[68:71], v8 offset:9216
    s_waitcnt lgkmcnt(6)
    v_mfma_f32_16x16x32_bf16 v[104:107], v[72:75], a[224:227], v[104:107]
    buffer_load_dwordx4 v3, s[12:15], s30 offen offset:1024 sc1 lds
    v_mfma_f32_16x16x32_bf16 v[104:107], v[76:79], a[232:235], v[104:107]
    v_mfma_f32_16x16x32_bf16 v[108:111], v[72:75], a[228:231], v[108:111]
    ds_read_b128 v[72:75], v8 offset:1024
    v_mfma_f32_16x16x32_bf16 v[108:111], v[76:79], a[236:239], v[108:111]
    ds_read_b128 v[76:79], v8 offset:10240
    s_waitcnt lgkmcnt(6)
    v_mfma_f32_16x16x32_bf16 v[96:99], v[80:83], a[240:243], v[96:99]
    s_waitcnt vmcnt(16)
    s_barrier
    v_mfma_f32_16x16x32_bf16 v[96:99], v[84:87], a[248:251], v[96:99]
    buffer_load_dwordx4 v3, s[12:15], s30 offen offset:2048 sc1 lds
    v_mfma_f32_16x16x32_bf16 v[100:103], v[80:83], a[244:247], v[100:103]
    ds_read_b128 v[80:83], v8 offset:18432
    v_mfma_f32_16x16x32_bf16 v[100:103], v[84:87], a[252:255], v[100:103]
    ds_read_b128 v[84:87], v8 offset:27648
    s_waitcnt lgkmcnt(6)
    v_mfma_f32_16x16x32_bf16 v[104:107], v[88:91], a[240:243], v[104:107]
    v_mfma_f32_16x16x32_bf16 v[104:107], v[92:95], a[248:251], v[104:107]
    v_mfma_f32_16x16x32_bf16 v[108:111], v[88:91], a[244:247], v[108:111]
    ds_read_b128 v[88:91], v8 offset:19456
    s_add_u32 m0, s26, 36864
    v_mfma_f32_16x16x32_bf16 v[108:111], v[92:95], a[252:255], v[108:111]
    ds_read_b128 v[92:95], v8 offset:28672
    s_waitcnt lgkmcnt(6)
    v_mfma_f32_16x16x32_bf16 v[96:99], v[64:67], v[224:227], v[96:99]
    s_add_u32 s30, s30, 12288
    v_mfma_f32_16x16x32_bf16 v[96:99], v[68:71], v[232:235], v[96:99]
    buffer_load_dwordx4 v3, s[12:15], s30 offen offset:0 sc1 lds
    v_mfma_f32_16x16x32_bf16 v[100:103], v[64:67], v[228:231], v[100:103]
    ds_read_b128 v[64:67], v4 offset:2048
    v_mfma_f32_16x16x32_bf16 v[100:103], v[68:71], v[236:239], v[100:103]
    ds_read_b128 v[68:71], v4 offset:11264
    s_waitcnt lgkmcnt(6)
    v_mfma_f32_16x16x32_bf16 v[104:107], v[72:75], v[224:227], v[104:107]
    v_mfma_f32_16x16x32_bf16 v[104:107], v[76:79], v[232:235], v[104:107]
    v_mfma_f32_16x16x32_bf16 v[108:111], v[72:75], v[228:231], v[108:111]
    ds_read_b128 v[72:75], v4 offset:3072
    v_mfma_f32_16x16x32_bf16 v[108:111], v[76:79], v[236:239], v[108:111]
    ds_read_b128 v[76:79], v4 offset:12288
    s_waitcnt vmcnt(14) lgkmcnt(6)
    v_mfma_f32_16x16x32_bf16 v[96:99], v[80:83], v[240:243], v[96:99]
    buffer_load_dwordx4 v3, s[12:15], s30 offen offset:1024 sc1 lds
    s_waitcnt vmcnt(11)
    v_mfma_f32_16x16x32_bf16 v[96:99], v[84:87], v[248:251], v[96:99]
    v_mfma_f32_16x16x32_bf16 v[100:103], v[80:83], v[244:247], v[100:103]
    ds_read_b128 v[80:83], v4 offset:20480
    v_mfma_f32_16x16x32_bf16 v[100:103], v[84:87], v[252:255], v[100:103]
    ds_read_b128 v[84:87], v4 offset:29696
    s_waitcnt lgkmcnt(6)
    v_mfma_f32_16x16x32_bf16 v[104:107], v[88:91], v[240:243], v[104:107]
    v_mfma_f32_16x16x32_bf16 v[104:107], v[92:95], v[248:251], v[104:107]
    buffer_load_dwordx4 v3, s[12:15], s30 offen offset:2048 sc1 lds
    v_mfma_f32_16x16x32_bf16 v[108:111], v[88:91], v[244:247], v[108:111]
    ds_read_b128 v[88:91], v4 offset:21504
    v_mfma_f32_16x16x32_bf16 v[108:111], v[92:95], v[252:255], v[108:111]
    ds_read_b128 v[92:95], v4 offset:30720
    s_waitcnt lgkmcnt(6)
    v_mfma_f32_16x16x32_bf16 v[112:115], v[64:67], a[224:227], v[112:115]
    s_add_u32 m0, s26, 49152
    s_add_u32 s30, s30, 12288
    v_mfma_f32_16x16x32_bf16 v[112:115], v[68:71], a[232:235], v[112:115]
    buffer_load_dwordx4 v3, s[12:15], s30 offen offset:0 sc1 lds
    v_mfma_f32_16x16x32_bf16 v[116:119], v[64:67], a[228:231], v[116:119]
    ds_read_b128 v[64:67], v8 offset:2048
    v_mfma_f32_16x16x32_bf16 v[116:119], v[68:71], a[236:239], v[116:119]
    ds_read_b128 v[68:71], v8 offset:11264
    s_waitcnt lgkmcnt(6)
    v_mfma_f32_16x16x32_bf16 v[120:123], v[72:75], a[224:227], v[120:123]
    v_cvt_pk_bf16_f32 v192, v96, v97
    v_cvt_pk_bf16_f32 v193, v98, v99
    v_mfma_f32_16x16x32_bf16 v[120:123], v[76:79], a[232:235], v[120:123]
    v_cvt_pk_bf16_f32 v194, v104, v105
    v_cvt_pk_bf16_f32 v195, v106, v107
    v_mfma_f32_16x16x32_bf16 v[124:127], v[72:75], a[228:231], v[124:127]
    ds_read_b128 v[72:75], v8 offset:3072
    v_mfma_f32_16x16x32_bf16 v[124:127], v[76:79], a[236:239], v[124:127]
    ds_read_b128 v[76:79], v8 offset:12288
    s_waitcnt lgkmcnt(6)
    v_mfma_f32_16x16x32_bf16 v[112:115], v[80:83], a[240:243], v[112:115]
    buffer_load_dwordx4 v3, s[12:15], s30 offen offset:1024 sc1 lds
    v_mfma_f32_16x16x32_bf16 v[112:115], v[84:87], a[248:251], v[112:115]
    buffer_store_dwordx4 v[192:195], v3, s[16:19], s48 offen offset:0 sc1
    v_mfma_f32_16x16x32_bf16 v[116:119], v[80:83], a[244:247], v[116:119]
    ds_read_b128 v[80:83], v8 offset:20480
    v_cvt_pk_bf16_f32 v208, v100, v101
    v_mfma_f32_16x16x32_bf16 v[116:119], v[84:87], a[252:255], v[116:119]
    ds_read_b128 v[84:87], v8 offset:29696
    s_waitcnt lgkmcnt(6)
    v_mfma_f32_16x16x32_bf16 v[120:123], v[88:91], a[240:243], v[120:123]
    v_cvt_pk_bf16_f32 v209, v102, v103
    v_cvt_pk_bf16_f32 v210, v108, v109
    v_mfma_f32_16x16x32_bf16 v[120:123], v[92:95], a[248:251], v[120:123]
    buffer_load_dwordx4 v3, s[12:15], s30 offen offset:2048 sc1 lds
    v_mfma_f32_16x16x32_bf16 v[124:127], v[88:91], a[244:247], v[124:127]
    ds_read_b128 v[88:91], v8 offset:21504
    v_cvt_pk_bf16_f32 v211, v110, v111
    v_mfma_f32_16x16x32_bf16 v[124:127], v[92:95], a[252:255], v[124:127]
    ds_read_b128 v[92:95], v8 offset:30720
    s_waitcnt lgkmcnt(6)
    v_mfma_f32_16x16x32_bf16 v[112:115], v[64:67], v[224:227], v[112:115]
    buffer_store_dwordx4 v[208:211], v5, s[16:19], s48 offen offset:0 sc1
    v_mfma_f32_16x16x32_bf16 v[112:115], v[68:71], v[232:235], v[112:115]
    v_mfma_f32_16x16x32_bf16 v[116:119], v[64:67], v[228:231], v[116:119]
    ds_read_b128 v[64:67], v4 offset:4096
    s_add_u32 m0, s26, 61440
    v_mfma_f32_16x16x32_bf16 v[116:119], v[68:71], v[236:239], v[116:119]
    ds_read_b128 v[68:71], v4 offset:13312
    s_waitcnt lgkmcnt(6)
    v_mfma_f32_16x16x32_bf16 v[120:123], v[72:75], v[224:227], v[120:123]
    s_add_u32 s30, s30, 12288
    v_mfma_f32_16x16x32_bf16 v[120:123], v[76:79], v[232:235], v[120:123]
    buffer_load_dwordx4 v3, s[12:15], s30 offen offset:0 sc1 lds
    v_mfma_f32_16x16x32_bf16 v[124:127], v[72:75], v[228:231], v[124:127]
    ds_read_b128 v[72:75], v4 offset:5120
    v_mfma_f32_16x16x32_bf16 v[124:127], v[76:79], v[236:239], v[124:127]
    ds_read_b128 v[76:79], v4 offset:14336
    s_waitcnt lgkmcnt(6)
    v_mfma_f32_16x16x32_bf16 v[112:115], v[80:83], v[240:243], v[112:115]
    v_mfma_f32_16x16x32_bf16 v[112:115], v[84:87], v[248:251], v[112:115]
    v_mfma_f32_16x16x32_bf16 v[116:119], v[80:83], v[244:247], v[116:119]
    ds_read_b128 v[80:83], v4 offset:22528
    v_mfma_f32_16x16x32_bf16 v[116:119], v[84:87], v[252:255], v[116:119]
    ds_read_b128 v[84:87], v4 offset:31744
    s_waitcnt lgkmcnt(6)
    v_mfma_f32_16x16x32_bf16 v[120:123], v[88:91], v[240:243], v[120:123]
    buffer_load_dwordx4 v3, s[12:15], s30 offen offset:1024 sc1 lds
    v_mfma_f32_16x16x32_bf16 v[120:123], v[92:95], v[248:251], v[120:123]
    v_mfma_f32_16x16x32_bf16 v[124:127], v[88:91], v[244:247], v[124:127]
    ds_read_b128 v[88:91], v4 offset:23552
    v_mfma_f32_16x16x32_bf16 v[124:127], v[92:95], v[252:255], v[124:127]
    ds_read_b128 v[92:95], v4 offset:32768
    s_waitcnt lgkmcnt(6)
    v_mfma_f32_16x16x32_bf16 v[128:131], v[64:67], a[224:227], v[128:131]
    v_mfma_f32_16x16x32_bf16 v[128:131], v[68:71], a[232:235], v[128:131]
    buffer_load_dwordx4 v3, s[12:15], s30 offen offset:2048 sc1 lds
    v_mfma_f32_16x16x32_bf16 v[132:135], v[64:67], a[228:231], v[132:135]
    ds_read_b128 v[64:67], v8 offset:4096
    v_mfma_f32_16x16x32_bf16 v[132:135], v[68:71], a[236:239], v[132:135]
    ds_read_b128 v[68:71], v8 offset:13312
    s_waitcnt lgkmcnt(6)
    v_mfma_f32_16x16x32_bf16 v[136:139], v[72:75], a[224:227], v[136:139]
    v_cvt_pk_bf16_f32 v196, v112, v113
    v_cvt_pk_bf16_f32 v197, v114, v115
    v_mfma_f32_16x16x32_bf16 v[136:139], v[76:79], a[232:235], v[136:139]
    v_cvt_pk_bf16_f32 v198, v120, v121
    v_cvt_pk_bf16_f32 v199, v122, v123
    v_mfma_f32_16x16x32_bf16 v[140:143], v[72:75], a[228:231], v[140:143]
    ds_read_b128 v[72:75], v8 offset:5120
    v_mfma_f32_16x16x32_bf16 v[140:143], v[76:79], a[236:239], v[140:143]
    ds_read_b128 v[76:79], v8 offset:14336
    s_waitcnt lgkmcnt(6)
    v_mfma_f32_16x16x32_bf16 v[128:131], v[80:83], a[240:243], v[128:131]
    buffer_store_dwordx4 v[196:199], v3, s[16:19], s48 offen offset:1024 sc1
    v_mfma_f32_16x16x32_bf16 v[128:131], v[84:87], a[248:251], v[128:131]
    v_cvt_pk_bf16_f32 v212, v116, v117
    v_cvt_pk_bf16_f32 v213, v118, v119
    v_mfma_f32_16x16x32_bf16 v[132:135], v[80:83], a[244:247], v[132:135]
    ds_read_b128 v[80:83], v8 offset:22528
    v_cvt_pk_bf16_f32 v214, v124, v125
    v_mfma_f32_16x16x32_bf16 v[132:135], v[84:87], a[252:255], v[132:135]
    ds_read_b128 v[84:87], v8 offset:31744
    s_waitcnt lgkmcnt(6)
    v_mfma_f32_16x16x32_bf16 v[136:139], v[88:91], a[240:243], v[136:139]
    v_cvt_pk_bf16_f32 v215, v126, v127
    v_mfma_f32_16x16x32_bf16 v[136:139], v[92:95], a[248:251], v[136:139]
    buffer_store_dwordx4 v[212:215], v5, s[16:19], s48 offen offset:1024 sc1
    v_mfma_f32_16x16x32_bf16 v[140:143], v[88:91], a[244:247], v[140:143]
    ds_read_b128 v[88:91], v8 offset:23552
    v_mfma_f32_16x16x32_bf16 v[140:143], v[92:95], a[252:255], v[140:143]
    ds_read_b128 v[92:95], v8 offset:32768
    s_waitcnt lgkmcnt(6)
    v_mfma_f32_16x16x32_bf16 v[128:131], v[64:67], v[224:227], v[128:131]
    v_mfma_f32_16x16x32_bf16 v[128:131], v[68:71], v[232:235], v[128:131]
    v_mfma_f32_16x16x32_bf16 v[132:135], v[64:67], v[228:231], v[132:135]
    ds_read_b128 v[64:67], v4 offset:6144
    v_mfma_f32_16x16x32_bf16 v[132:135], v[68:71], v[236:239], v[132:135]
    ds_read_b128 v[68:71], v4 offset:15360
    s_waitcnt lgkmcnt(6)
    v_mfma_f32_16x16x32_bf16 v[136:139], v[72:75], v[224:227], v[136:139]
    v_mfma_f32_16x16x32_bf16 v[136:139], v[76:79], v[232:235], v[136:139]
    v_mfma_f32_16x16x32_bf16 v[140:143], v[72:75], v[228:231], v[140:143]
    ds_read_b128 v[72:75], v4 offset:7168
    v_mfma_f32_16x16x32_bf16 v[140:143], v[76:79], v[236:239], v[140:143]
    ds_read_b128 v[76:79], v4 offset:16384
    s_waitcnt lgkmcnt(6)
    v_mfma_f32_16x16x32_bf16 v[128:131], v[80:83], v[240:243], v[128:131]
    v_mfma_f32_16x16x32_bf16 v[128:131], v[84:87], v[248:251], v[128:131]
    v_mfma_f32_16x16x32_bf16 v[132:135], v[80:83], v[244:247], v[132:135]
    ds_read_b128 v[80:83], v4 offset:24576
    v_mfma_f32_16x16x32_bf16 v[132:135], v[84:87], v[252:255], v[132:135]
    ds_read_b128 v[84:87], v4 offset:33792
    s_waitcnt lgkmcnt(6)
    v_mfma_f32_16x16x32_bf16 v[136:139], v[88:91], v[240:243], v[136:139]
    v_mfma_f32_16x16x32_bf16 v[136:139], v[92:95], v[248:251], v[136:139]
    v_mfma_f32_16x16x32_bf16 v[140:143], v[88:91], v[244:247], v[140:143]
    ds_read_b128 v[88:91], v4 offset:25600
    v_mfma_f32_16x16x32_bf16 v[140:143], v[92:95], v[252:255], v[140:143]
    ds_read_b128 v[92:95], v4 offset:34816
    s_waitcnt lgkmcnt(6)
    v_mfma_f32_16x16x32_bf16 v[144:147], v[64:67], a[224:227], v[144:147]
    v_mfma_f32_16x16x32_bf16 v[144:147], v[68:71], a[232:235], v[144:147]
    v_mfma_f32_16x16x32_bf16 v[148:151], v[64:67], a[228:231], v[148:151]
    ds_read_b128 v[64:67], v8 offset:6144
    v_mfma_f32_16x16x32_bf16 v[148:151], v[68:71], a[236:239], v[148:151]
    ds_read_b128 v[68:71], v8 offset:15360
    s_waitcnt lgkmcnt(6)
    v_mfma_f32_16x16x32_bf16 v[152:155], v[72:75], a[224:227], v[152:155]
    v_cvt_pk_bf16_f32 v200, v128, v129
    v_cvt_pk_bf16_f32 v201, v130, v131
    v_mfma_f32_16x16x32_bf16 v[152:155], v[76:79], a[232:235], v[152:155]
    v_cvt_pk_bf16_f32 v202, v136, v137
    v_cvt_pk_bf16_f32 v203, v138, v139
    v_mfma_f32_16x16x32_bf16 v[156:159], v[72:75], a[228:231], v[156:159]
    ds_read_b128 v[72:75], v8 offset:7168
    v_mfma_f32_16x16x32_bf16 v[156:159], v[76:79], a[236:239], v[156:159]
    ds_read_b128 v[76:79], v8 offset:16384
    s_waitcnt lgkmcnt(6)
    v_mfma_f32_16x16x32_bf16 v[144:147], v[80:83], a[240:243], v[144:147]
    buffer_store_dwordx4 v[200:203], v3, s[16:19], s48 offen offset:2048 sc1
    v_mfma_f32_16x16x32_bf16 v[144:147], v[84:87], a[248:251], v[144:147]
    v_cvt_pk_bf16_f32 v216, v132, v133
    v_cvt_pk_bf16_f32 v217, v134, v135
    v_mfma_f32_16x16x32_bf16 v[148:151], v[80:83], a[244:247], v[148:151]
    ds_read_b128 v[80:83], v8 offset:24576
    v_cvt_pk_bf16_f32 v218, v140, v141
    v_mfma_f32_16x16x32_bf16 v[148:151], v[84:87], a[252:255], v[148:151]
    ds_read_b128 v[84:87], v8 offset:33792
    s_waitcnt lgkmcnt(6)
    v_mfma_f32_16x16x32_bf16 v[152:155], v[88:91], a[240:243], v[152:155]
    v_cvt_pk_bf16_f32 v219, v142, v143
    v_mfma_f32_16x16x32_bf16 v[152:155], v[92:95], a[248:251], v[152:155]
    buffer_store_dwordx4 v[216:219], v5, s[16:19], s48 offen offset:2048 sc1
    v_mfma_f32_16x16x32_bf16 v[156:159], v[88:91], a[244:247], v[156:159]
    ds_read_b128 v[88:91], v8 offset:25600
    v_mfma_f32_16x16x32_bf16 v[156:159], v[92:95], a[252:255], v[156:159]
    ds_read_b128 v[92:95], v8 offset:34816
    s_waitcnt lgkmcnt(6)
    v_mfma_f32_16x16x32_bf16 v[144:147], v[64:67], v[224:227], v[144:147]
    v_mfma_f32_16x16x32_bf16 v[144:147], v[68:71], v[232:235], v[144:147]
    v_mfma_f32_16x16x32_bf16 v[148:151], v[64:67], v[228:231], v[148:151]
    ds_read_b128 v[64:67], v4 offset:8192
    v_mfma_f32_16x16x32_bf16 v[148:151], v[68:71], v[236:239], v[148:151]
    ds_read_b128 v[68:71], v4 offset:17408
    s_waitcnt lgkmcnt(6)
    v_mfma_f32_16x16x32_bf16 v[152:155], v[72:75], v[224:227], v[152:155]
    v_mfma_f32_16x16x32_bf16 v[152:155], v[76:79], v[232:235], v[152:155]
    v_mfma_f32_16x16x32_bf16 v[156:159], v[72:75], v[228:231], v[156:159]
    ds_read_b128 v[72:75], v4 offset:26624
    v_mfma_f32_16x16x32_bf16 v[156:159], v[76:79], v[236:239], v[156:159]
    ds_read_b128 v[76:79], v4 offset:35840
    s_waitcnt lgkmcnt(6)
    v_mfma_f32_16x16x32_bf16 v[144:147], v[80:83], v[240:243], v[144:147]
    v_mfma_f32_16x16x32_bf16 v[144:147], v[84:87], v[248:251], v[144:147]
    v_mfma_f32_16x16x32_bf16 v[148:151], v[80:83], v[244:247], v[148:151]
    ds_read_b128 v[80:83], v8 offset:8192
    v_mfma_f32_16x16x32_bf16 v[148:151], v[84:87], v[252:255], v[148:151]
    ds_read_b128 v[84:87], v8 offset:17408
    s_waitcnt lgkmcnt(6)
    v_mfma_f32_16x16x32_bf16 v[152:155], v[88:91], v[240:243], v[152:155]
    v_mfma_f32_16x16x32_bf16 v[152:155], v[92:95], v[248:251], v[152:155]
    v_mfma_f32_16x16x32_bf16 v[156:159], v[88:91], v[244:247], v[156:159]
    ds_read_b128 v[88:91], v8 offset:26624
    v_mfma_f32_16x16x32_bf16 v[156:159], v[92:95], v[252:255], v[156:159]
    ds_read_b128 v[92:95], v8 offset:35840
    s_waitcnt lgkmcnt(6)
    v_mfma_f32_16x16x32_bf16 v[40:43], v[64:67], a[224:227], v[40:43]
    v_mfma_f32_16x16x32_bf16 v[40:43], v[68:71], a[232:235], v[40:43]
    v_mfma_f32_16x16x32_bf16 v[44:47], v[64:67], a[228:231], v[44:47]
    v_mfma_f32_16x16x32_bf16 v[44:47], v[68:71], a[236:239], v[44:47]
    v_cvt_pk_bf16_f32 v204, v144, v145
    s_waitcnt lgkmcnt(4)
    v_mfma_f32_16x16x32_bf16 v[40:43], v[72:75], a[240:243], v[40:43]
    v_cvt_pk_bf16_f32 v205, v146, v147
    v_cvt_pk_bf16_f32 v206, v152, v153
    v_mfma_f32_16x16x32_bf16 v[40:43], v[76:79], a[248:251], v[40:43]
    v_cvt_pk_bf16_f32 v207, v154, v155
    v_mfma_f32_16x16x32_bf16 v[44:47], v[72:75], a[244:247], v[44:47]
    buffer_store_dwordx4 v[204:207], v3, s[16:19], s48 offen offset:3072 sc1
    v_mfma_f32_16x16x32_bf16 v[44:47], v[76:79], a[252:255], v[44:47]
    v_cvt_pk_bf16_f32 v220, v148, v149
    s_waitcnt lgkmcnt(2)
    v_mfma_f32_16x16x32_bf16 v[40:43], v[80:83], v[224:227], v[40:43]
    v_cvt_pk_bf16_f32 v221, v150, v151
    v_cvt_pk_bf16_f32 v222, v156, v157
    v_mfma_f32_16x16x32_bf16 v[40:43], v[84:87], v[232:235], v[40:43]
    v_cvt_pk_bf16_f32 v223, v158, v159
    v_mfma_f32_16x16x32_bf16 v[44:47], v[80:83], v[228:231], v[44:47]
    buffer_store_dwordx4 v[220:223], v5, s[16:19], s48 offen offset:3072 sc1
    v_mfma_f32_16x16x32_bf16 v[44:47], v[84:87], v[236:239], v[44:47]
    s_waitcnt lgkmcnt(0)
    v_mfma_f32_16x16x32_bf16 v[40:43], v[88:91], v[240:243], v[40:43]
    v_mfma_f32_16x16x32_bf16 v[40:43], v[92:95], v[248:251], v[40:43]
    v_mfma_f32_16x16x32_bf16 v[44:47], v[88:91], v[244:247], v[44:47]
    v_mfma_f32_16x16x32_bf16 v[44:47], v[92:95], v[252:255], v[44:47]
    s_nop 5
    v_cvt_pk_bf16_f32 v48, v40, v41
    v_cvt_pk_bf16_f32 v49, v42, v43
    buffer_store_dwordx2 v[48:49], v14, s[16:19], s50 offen sc1
    v_cvt_pk_bf16_f32 v52, v44, v45
    v_cvt_pk_bf16_f32 v53, v46, v47
    buffer_store_dwordx2 v[52:53], v1, s[16:19], s50 offen sc1
    s_waitcnt vmcnt(0)
    s_mov_b64 exec, 1
    buffer_store_dword v21, off, s[40:43], s54 sc1
    s_mov_b64 exec, -1
    v_bfe_u32 v23, v0, 2, 2
    v_lshlrev_b32 v23, 7, v23
    v_and_b32 v41, 3, v0
    v_lshl_add_u32 v23, v41, 2, v23
    s_lshl_b32 s3, s24, 3
    v_bfe_u32 v40, v0, 4, 1
    v_lshl_add_u32 v40, v40, 2, v39
    v_add_u32 v40, s3, v40
    v_lshlrev_b32 v41, 3, v19
    v_and_b32 v42, 63, v0
    v_min_u32 v42, 26, v42
    s_and_b32 s3, s2, 3
    s_mul_i32 s3, s3, 27
    s_add_u32 s3, s3, 144
    v_add_u32 v42, s3, v42
    v_lshlrev_b32 v42, 5, v42
    v_add_u32 v42, 24576, v42
    s_cmp_ge_u32 s24, 2
    s_cselect_b32 s100, -1, 2
    s_lshl_b32 s3, s100, 7
    v_add_u32 v44, s3, v37
    s_lshl_b32 s3, s100, 11
    v_add_u32 v45, s3, v36
    s_and_b32 s3, s49, 128
    v_and_b32 v46, 1023, v45
    v_add_u32 v46, s3, v46
    v_lshrrev_b32 v46, 1, v46
    v_subrev_u32 v46, s3, v46
    v_and_b32 v47, 0xfffffc00, v45
    v_add_u32 v46, v46, v47
    v_cmp_eq_u32 vcc, 4096, v47
    s_mov_b32 s3, 13312
    v_cmp_eq_u32 s[100:101], s3, v47
    s_nop 0
    s_or_b64 vcc, vcc, s[100:101]
    v_add_u32 v47, 512, v46
    v_add_u32 v43, 8, v45
    v_cndmask_b32 v46, v45, v46, vcc
    v_cndmask_b32 v47, v43, v47, vcc
    s_lshl_b32 s3, s28, 2
    s_add_u32 s3, s3, 160256
    v_mov_b32 v43, s3
    s_cmp_lg_u32 s24, 3
    s_cbranch_scc1 m_red
m_p3:
    buffer_load_dword v22, v23, s[40:43], s96 offen sc1
    s_waitcnt vmcnt(0)
    v_cmp_ne_u32 vcc, v21, v22
    s_sub_i32 s55, s55, 1
    s_cmp_lt_i32 s55, 0
    s_cselect_b32 s51, 0, vcc_lo
    v_mov_b32 v22, s51
    ds_write_b32 v43, v22
    s_cmp_lg_u32 s51, 0
    s_cbranch_scc1 m_p3
    s_branch m_next
m_red:
    v_lshlrev_b32 v96, 16, v24
    v_and_b32 v97, 0xffff0000, v24
    v_lshlrev_b32 v98, 16, v25
    v_and_b32 v99, 0xffff0000, v25
    v_lshlrev_b32 v100, 16, v26
    v_and_b32 v101, 0xffff0000, v26
    v_lshlrev_b32 v102, 16, v27
    v_and_b32 v103, 0xffff0000, v27
    v_lshlrev_b32 v104, 16, v28
    v_and_b32 v105, 0xffff0000, v28
    v_lshlrev_b32 v106, 16, v29
    v_and_b32 v107, 0xffff0000, v29
    v_lshlrev_b32 v108, 16, v30
    v_and_b32 v109, 0xffff0000, v30
    v_lshlrev_b32 v110, 16, v31
    v_and_b32 v111, 0xffff0000, v31
    v_lshlrev_b32 v112, 16, v32
    v_and_b32 v113, 0xffff0000, v32
    v_lshlrev_b32 v114, 16, v33
    v_and_b32 v115, 0xffff0000, v33
    v_lshlrev_b32 v116, 16, v34
    v_and_b32 v117, 0xffff0000, v34
    v_lshlrev_b32 v118, 16, v35
    v_and_b32 v119, 0xffff0000, v35
    ds_read_b64_tr_b16 v[160:161], v38 offset:0
    ds_read_b64_tr_b16 v[162:163], v38 offset:64
    ds_read_b64_tr_b16 v[164:165], v38 offset:1024
    ds_read_b64_tr_b16 v[166:167], v38 offset:1088
    ds_read_b64_tr_b16 v[168:169], v38 offset:2048
    ds_read_b64_tr_b16 v[170:171], v38 offset:2112
    s_waitcnt lgkmcnt(0)
    v_lshlrev_b32 v64, 16, v160
    v_and_b32 v65, 0xffff0000, v160
    v_lshlrev_b32 v66, 16, v161
    v_and_b32 v67, 0xffff0000, v161
    v_lshlrev_b32 v68, 16, v162
    v_and_b32 v69, 0xffff0000, v162
    v_lshlrev_b32 v70, 16, v163
    v_and_b32 v71, 0xffff0000, v163
    v_lshlrev_b32 v72, 16, v164
    v_and_b32 v73, 0xffff0000, v164
    v_lshlrev_b32 v74, 16, v165
    v_and_b32 v75, 0xffff0000, v165
    v_lshlrev_b32 v76, 16, v166
    v_and_b32 v77, 0xffff0000, v166
    v_lshlrev_b32 v78, 16, v167
    v_and_b32 v79, 0xffff0000, v167
    v_lshlrev_b32 v80, 16, v168
    v_and_b32 v81, 0xffff0000, v168
    v_lshlrev_b32 v82, 16, v169
    v_and_b32 v83, 0xffff0000, v169
    v_lshlrev_b32 v84, 16, v170
    v_and_b32 v85, 0xffff0000, v170
    v_lshlrev_b32 v86, 16, v171
    v_and_b32 v87, 0xffff0000, v171
    v_and_b32 v92, 7, v0
    v_bfe_u32 v93, v0, 3, 3
    s_mul_i32 s3, s24, 4096
    s_add_u32 s3, s3, 147456
    v_mul_u32_u24 v88, 144, v92
    v_lshl_add_u32 v88, v93, 4, v88
    v_add_u32 v88, s3, v88
    v_mul_u32_u24 v89, 144, v93
    v_lshl_add_u32 v89, v92, 4, v89
    v_add_u32 v89, s3, v89
    v_sub_u32 v94, v93, v92
    v_mul_i32_i24 v94, 1136, v94
    v_add_u32 v90, v37, v94
    v_add_u32 v91, v44, v94
    s_mov_b32 s100, 0x3f80
    s_mov_b32 s101, 0x3f800000
    s_mov_b32 s27, 0
m_pp:
    ds_read_b32 v22, v43
    s_waitcnt lgkmcnt(0)
    v_readfirstlane_b32 s51, v22
    s_nop 0
    s_or_b32 s51, s51, s27
    s_and_b32 s3, s51, 0xf
    s_cbranch_scc1 m_pn0
    s_add_u32 s3, s49, 0
    buffer_load_dwordx4 v[176:179], v36, s[16:19], s3 offen offset:0 sc1
    buffer_load_dwordx4 v[192:195], v36, s[16:19], s3 offen offset:2048 sc1
    buffer_load_dwordx2 v[208:209], v46, s[16:19], s3 offen sc1
    buffer_load_dwordx2 v[210:211], v47, s[16:19], s3 offen sc1
    s_or_b32 s27, s27, 0xf
m_pn0:
    s_and_b32 s3, s51, 0xf0
    s_cbranch_scc1 m_pn1
    s_add_u32 s3, s49, 2359296
    buffer_load_dwordx4 v[180:183], v36, s[16:19], s3 offen offset:0 sc1
    buffer_load_dwordx4 v[196:199], v36, s[16:19], s3 offen offset:2048 sc1
    buffer_load_dwordx2 v[212:213], v46, s[16:19], s3 offen sc1
    buffer_load_dwordx2 v[214:215], v47, s[16:19], s3 offen sc1
    s_or_b32 s27, s27, 0xf0
m_pn1:
    s_and_b32 s3, s51, 0xf00
    s_cbranch_scc1 m_pn2
    s_add_u32 s3, s49, 4718592
    buffer_load_dwordx4 v[184:187], v36, s[16:19], s3 offen offset:0 sc1
    buffer_load_dwordx4 v[200:203], v36, s[16:19], s3 offen offset:2048 sc1
    buffer_load_dwordx2 v[216:217], v46, s[16:19], s3 offen sc1
    buffer_load_dwordx2 v[218:219], v47, s[16:19], s3 offen sc1
    s_or_b32 s27, s27, 0xf00
m_pn2:
    s_and_b32 s3, s51, 0xf000
    s_cbranch_scc1 m_pn3
    s_add_u32 s3, s49, 7077888
    buffer_load_dwordx4 v[188:191], v36, s[16:19], s3 offen offset:0 sc1
    buffer_load_dwordx4 v[204:207], v36, s[16:19], s3 offen offset:2048 sc1
    buffer_load_dwordx2 v[220:221], v46, s[16:19], s3 offen sc1
    buffer_load_dwordx2 v[222:223], v47, s[16:19], s3 offen sc1
    s_or_b32 s27, s27, 0xf000
m_pn3:
    s_cmp_lg_u32 s27, 0xffff
    s_cbranch_scc1 m_pp
    s_branch m_psum
m_pre:
    s_add_u32 s3, s49, 0
    buffer_load_dwordx4 v[176:179], v36, s[16:19], s3 offen offset:0 sc1
    buffer_load_dwordx4 v[192:195], v36, s[16:19], s3 offen offset:2048 sc1
    buffer_load_dwordx2 v[208:209], v46, s[16:19], s3 offen sc1
    buffer_load_dwordx2 v[210:211], v47, s[16:19], s3 offen sc1
    s_add_u32 s3, s49, 2359296
    buffer_load_dwordx4 v[180:183], v36, s[16:19], s3 offen offset:0 sc1
    buffer_load_dwordx4 v[196:199], v36, s[16:19], s3 offen offset:2048 sc1
    buffer_load_dwordx2 v[212:213], v46, s[16:19], s3 offen sc1
    buffer_load_dwordx2 v[214:215], v47, s[16:19], s3 offen sc1
    s_add_u32 s3, s49, 4718592
    buffer_load_dwordx4 v[184:187], v36, s[16:19], s3 offen offset:0 sc1
    buffer_load_dwordx4 v[200:203], v36, s[16:19], s3 offen offset:2048 sc1
    buffer_load_dwordx2 v[216:217], v46, s[16:19], s3 offen sc1
    buffer_load_dwordx2 v[218:219], v47, s[16:19], s3 offen sc1
    s_add_u32 s3, s49, 7077888
    buffer_load_dwordx4 v[188:191], v36, s[16:19], s3 offen offset:0 sc1
    buffer_load_dwordx4 v[204:207], v36, s[16:19], s3 offen offset:2048 sc1
    buffer_load_dwordx2 v[220:221], v46, s[16:19], s3 offen sc1
    buffer_load_dwordx2 v[222:223], v47, s[16:19], s3 offen sc1
m_psum:
    s_waitcnt vmcnt(0)
    v_dot2_f32_bf16 v120, s100, v176, v96
    v_dot2_f32_bf16 v121, s101, v176, v97
    v_dot2_f32_bf16 v122, s100, v177, v98
    v_dot2_f32_bf16 v123, s101, v177, v99
    v_dot2_f32_bf16 v124, s100, v178, v100
    v_dot2_f32_bf16 v125, s101, v178, v101
    v_dot2_f32_bf16 v126, s100, v179, v102
    v_dot2_f32_bf16 v127, s101, v179, v103
    v_dot2_f32_bf16 v128, s100, v192, v104
    v_dot2_f32_bf16 v129, s101, v192, v105
    v_dot2_f32_bf16 v130, s100, v193, v106
    v_dot2_f32_bf16 v131, s101, v193, v107
    v_dot2_f32_bf16 v132, s100, v194, v108
    v_dot2_f32_bf16 v133, s101, v194, v109
    v_dot2_f32_bf16 v134, s100, v195, v110
    v_dot2_f32_bf16 v135, s101, v195, v111
    v_dot2_f32_bf16 v136, s100, v208, v112
    v_dot2_f32_bf16 v137, s101, v208, v113
    v_dot2_f32_bf16 v138, s100, v209, v114
    v_dot2_f32_bf16 v139, s101, v209, v115
    v_dot2_f32_bf16 v140, s100, v210, v116
    v_dot2_f32_bf16 v141, s101, v210, v117
    v_dot2_f32_bf16 v142, s100, v211, v118
    v_dot2_f32_bf16 v143, s101, v211, v119
    v_dot2c_f32_bf16 v120, s100, v180
    v_dot2c_f32_bf16 v121, s101, v180
    v_dot2c_f32_bf16 v122, s100, v181
    v_dot2c_f32_bf16 v123, s101, v181
    v_dot2c_f32_bf16 v124, s100, v182
    v_dot2c_f32_bf16 v125, s101, v182
    v_dot2c_f32_bf16 v126, s100, v183
    v_dot2c_f32_bf16 v127, s101, v183
    v_dot2c_f32_bf16 v128, s100, v196
    v_dot2c_f32_bf16 v129, s101, v196
    v_dot2c_f32_bf16 v130, s100, v197
    v_dot2c_f32_bf16 v131, s101, v197
    v_dot2c_f32_bf16 v132, s100, v198
    v_dot2c_f32_bf16 v133, s101, v198
    v_dot2c_f32_bf16 v134, s100, v199
    v_dot2c_f32_bf16 v135, s101, v199
    v_dot2c_f32_bf16 v136, s100, v212
    v_dot2c_f32_bf16 v137, s101, v212
    v_dot2c_f32_bf16 v138, s100, v213
    v_dot2c_f32_bf16 v139, s101, v213
    v_dot2c_f32_bf16 v140, s100, v214
    v_dot2c_f32_bf16 v141, s101, v214
    v_dot2c_f32_bf16 v142, s100, v215
    v_dot2c_f32_bf16 v143, s101, v215
    v_dot2c_f32_bf16 v120, s100, v184
    v_dot2c_f32_bf16 v121, s101, v184
    v_dot2c_f32_bf16 v122, s100, v185
    v_dot2c_f32_bf16 v123, s101, v185
    v_dot2c_f32_bf16 v124, s100, v186
    v_dot2c_f32_bf16 v125, s101, v186
    v_dot2c_f32_bf16 v126, s100, v187
    v_dot2c_f32_bf16 v127, s101, v187
    v_dot2c_f32_bf16 v128, s100, v200
    v_dot2c_f32_bf16 v129, s101, v200
    v_dot2c_f32_bf16 v130, s100, v201
    v_dot2c_f32_bf16 v131, s101, v201
    v_dot2c_f32_bf16 v132, s100, v202
    v_dot2c_f32_bf16 v133, s101, v202
    v_dot2c_f32_bf16 v134, s100, v203
    v_dot2c_f32_bf16 v135, s101, v203
    v_dot2c_f32_bf16 v136, s100, v216
    v_dot2c_f32_bf16 v137, s101, v216
    v_dot2c_f32_bf16 v138, s100, v217
    v_dot2c_f32_bf16 v139, s101, v217
    v_dot2c_f32_bf16 v140, s100, v218
    v_dot2c_f32_bf16 v141, s101, v218
    v_dot2c_f32_bf16 v142, s100, v219
    v_dot2c_f32_bf16 v143, s101, v219
    v_dot2c_f32_bf16 v120, s100, v188
    v_dot2c_f32_bf16 v121, s101, v188
    v_dot2c_f32_bf16 v122, s100, v189
    v_dot2c_f32_bf16 v123, s101, v189
    v_dot2c_f32_bf16 v124, s100, v190
    v_dot2c_f32_bf16 v125, s101, v190
    v_dot2c_f32_bf16 v126, s100, v191
    v_dot2c_f32_bf16 v127, s101, v191
    v_dot2c_f32_bf16 v128, s100, v204
    v_dot2c_f32_bf16 v129, s101, v204
    v_dot2c_f32_bf16 v130, s100, v205
    v_dot2c_f32_bf16 v131, s101, v205
    v_dot2c_f32_bf16 v132, s100, v206
    v_dot2c_f32_bf16 v133, s101, v206
    v_dot2c_f32_bf16 v134, s100, v207
    v_dot2c_f32_bf16 v135, s101, v207
    v_dot2c_f32_bf16 v136, s100, v220
    v_dot2c_f32_bf16 v137, s101, v220
    v_dot2c_f32_bf16 v138, s100, v221
    v_dot2c_f32_bf16 v139, s101, v221
    v_dot2c_f32_bf16 v140, s100, v222
    v_dot2c_f32_bf16 v141, s101, v222
    v_dot2c_f32_bf16 v142, s100, v223
    v_dot2c_f32_bf16 v143, s101, v223
    s_cmp_eq_u32 s28, 1
    s_cbranch_scc1 m_out
    v_cvt_pk_bf16_f32 v96, 0, v120
    v_cvt_pk_bf16_f32 v97, 0, v121
    v_cvt_pk_bf16_f32 v98, 0, v122
    v_cvt_pk_bf16_f32 v99, 0, v123
    v_cvt_pk_bf16_f32 v100, 0, v124
    v_cvt_pk_bf16_f32 v101, 0, v125
    v_cvt_pk_bf16_f32 v102, 0, v126
    v_cvt_pk_bf16_f32 v103, 0, v127
    v_cvt_pk_bf16_f32 v104, 0, v128
    v_cvt_pk_bf16_f32 v105, 0, v129
    v_cvt_pk_bf16_f32 v106, 0, v130
    v_cvt_pk_bf16_f32 v107, 0, v131
    v_cvt_pk_bf16_f32 v108, 0, v132
    v_cvt_pk_bf16_f32 v109, 0, v133
    v_cvt_pk_bf16_f32 v110, 0, v134
    v_cvt_pk_bf16_f32 v111, 0, v135
    v_cvt_pk_bf16_f32 v112, 0, v136
    v_cvt_pk_bf16_f32 v113, 0, v137
    v_cvt_pk_bf16_f32 v114, 0, v138
    v_cvt_pk_bf16_f32 v115, 0, v139
    v_cvt_pk_bf16_f32 v116, 0, v140
    v_cvt_pk_bf16_f32 v117, 0, v141
    v_cvt_pk_bf16_f32 v118, 0, v142
    v_cvt_pk_bf16_f32 v119, 0, v143
m_next:
    s_cmp_eq_u32 s28, 1
    s_cbranch_scc1 m_fin
    s_mov_b32 s28, 1
    v_add_u32 v39, 512, v39
    v_add_u32 v40, 512, v40
    v_swap_b32 v4, v9
    v_swap_b32 v8, v10
    s_mov_b32 s25, s26
    s_mov_b32 s26, s29
    s_add_u32 s8, s8, 0x0
    s_addc_u32 s9, s9, 0
    s_add_u32 s16, s16, 0x0
    s_addc_u32 s17, s17, 0
    s_add_u32 s36, s36, 0x0
    s_addc_u32 s37, s37, 0
    s_add_u32 s40, s40, 0x20000
    s_addc_u32 s41, s41, 0
    s_branch m_loop
m_out:
    s_mov_b32 s4, s20
    s_mov_b32 s5, s21
    s_mov_b32 s6, 0x240000
    s_mov_b32 s7, 0x20000
    v_cvt_pk_bf16_f32 v176, v120, v121
    v_cvt_pk_bf16_f32 v177, v122, v123
    v_cvt_pk_bf16_f32 v178, v124, v125
    v_cvt_pk_bf16_f32 v179, v126, v127
    ds_write_b128 v88, v[176:179] offset:0
    ds_read_b128 v[192:195], v89 offset:0
    v_cvt_pk_bf16_f32 v180, v128, v129
    v_cvt_pk_bf16_f32 v181, v130, v131
    v_cvt_pk_bf16_f32 v182, v132, v133
    v_cvt_pk_bf16_f32 v183, v134, v135
    ds_write_b128 v88, v[180:183] offset:1152
    ds_read_b128 v[196:199], v89 offset:1152
    v_cvt_pk_bf16_f32 v184, v136, v137
    v_cvt_pk_bf16_f32 v185, v138, v139
    v_cvt_pk_bf16_f32 v186, v140, v141
    v_cvt_pk_bf16_f32 v187, v142, v143
    ds_write_b128 v88, v[184:187] offset:2304
    ds_read_b128 v[200:203], v89 offset:2304
    s_waitcnt lgkmcnt(4)
    buffer_store_dwordx4 v[192:195], v90, s[4:7], s99 offen offset:0 sc1
    s_waitcnt lgkmcnt(2)
    buffer_store_dwordx4 v[196:199], v90, s[4:7], s99 offen offset:128 sc1
    s_waitcnt lgkmcnt(0)
    buffer_store_dwordx4 v[200:203], v91, s[4:7], s99 offen offset:0 sc1
m_fin:
f_end:
    s_endpgm
cv_slow:
cv_spin:
    buffer_load_dword v251, v250, s[56:59], s48 offen sc1
    s_waitcnt vmcnt(0)
    v_cmp_ne_u32 vcc, v249, v251
    s_cbranch_vccz cv_spin_ok
    s_sub_i32 s55, s55, 1
    s_cmp_lt_i32 s55, 0
    s_cbranch_scc1 cv_spin_ok
    s_sleep 1
    s_branch cv_spin
cv_spin_ok:
    s_branch cv_back
f_slow2:
    s_sleep 1
    buffer_load_dword v22, v42, s[56:59], 0 offen sc1
    s_waitcnt vmcnt(0)
    s_sub_i32 s55, s55, 1
    s_cmp_lt_i32 s55, 0
    s_cbranch_scc1 f_back2
    v_cmp_ne_u32 vcc, v21, v22
    s_cbranch_vccnz f_slow2
    s_branch f_back2
f_slow0:
    s_sleep 1
    buffer_load_dword v22, v19, s[40:43], s53 offen offset:0 sc1
    s_waitcnt vmcnt(0)
    s_sub_i32 s55, s55, 1
    s_cmp_lt_i32 s55, 0
    s_cbranch_scc1 f_back0
    v_cmp_ne_u32 vcc, v21, v22
    s_cbranch_vccnz f_slow0
    s_branch f_back0
f_slow1:
    s_sleep 1
    buffer_load_dword v22, v19, s[40:43], s53 offen offset:128 sc1
    s_waitcnt vmcnt(0)
    s_sub_i32 s55, s55, 1
    s_cmp_lt_i32 s55, 0
    s_cbranch_scc1 f_back1
    v_cmp_ne_u32 vcc, v21, v22
    s_cbranch_vccnz f_slow1
    s_branch f_back1
code_end:
.section .rodata,"a"
.p2align 6
.amdhsa_kernel interleave_layers__ssm_conv_h3__glu_gated_reglu__prompt_kernel
  .amdhsa_next_free_vgpr 512
  .amdhsa_next_free_sgpr 102
  .amdhsa_accum_offset 256
  .amdhsa_group_segment_fixed_size 0
  .amdhsa_kernarg_size 104
  .amdhsa_user_sgpr_count 2
  .amdhsa_user_sgpr_kernarg_segment_ptr 1
  .amdhsa_system_sgpr_workgroup_id_x 1
  .amdhsa_float_denorm_mode_32 3
.end_amdhsa_kernel
```
